```python
import torch

def _softmax(x, axis=-1):
    return torch.softmax(x, dim=axis)
def _gelu(x):
    return torch.nn.functional.gelu(x, approximate="tanh")
def _silu(x):
    return torch.nn.functional.silu(x)
def _sigmoid(x):
    return torch.sigmoid(x)
def _layernorm(x, axis=-1, eps=1e-5):
    m = x.mean(dim=axis, keepdim=True)
    v = x.var(dim=axis, keepdim=True, unbiased=False)
    return (x - m) / torch.sqrt(v + eps)
def _scatter_add(tgt, idx, src, axis=0):
    return tgt.clone().index_add_(axis, idx, src)
def _segment_sum(src, seg, n):
    out = torch.zeros((n,) + src.shape[1:], dtype=src.dtype)
    return out.index_add_(0, seg, src)
def _pad(x, pw):
    flat = tuple(v for pair in reversed(pw) for v in pair)
    return torch.nn.functional.pad(x, flat)

kernel_name = 'interleave_layers__ssm_conv_h3__dense_activation_mish__prompt'

def setup_inputs():

    _w = (lambda a: (lambda t: t.to(torch.bfloat16) if t.is_floating_point() else t)(torch.as_tensor(a)))
    def _A_setup():
        B, S, D = 1, 2048, 512
        ks = 4
        return {
            "q": _w((lambda *s: torch.randn(*s, dtype=torch.bfloat16) * 0.05)(B, S, D)),
            "k": _w((lambda *s: torch.randn(*s, dtype=torch.bfloat16) * 0.2)(B, S, D)),
            "v": _w((lambda *s: torch.randn(*s, dtype=torch.bfloat16) * 0.2)(B, S, D)),
            "shift_k": _w((lambda *s: torch.randn(*s, dtype=torch.bfloat16) * 0.2)(D, ks) * 0.5),
            "ssm_k": _w((lambda *s: torch.randn(*s, dtype=torch.bfloat16) * 0.4)(D, S) * (1.0 / S ** 0.5)),
            "ssm_D": _w((lambda *s: torch.randn(*s, dtype=torch.bfloat16) * 0.2)(D)),
        }
    _A_in = _A_setup()

    def _B_setup():
        B, S, D, F = 1, 2048, 512, 1792
        return {
            "x": _w((lambda *s: torch.randn(*s, dtype=torch.bfloat16) * 0.05)(B, S, D)),
            "w1": _w((lambda *s: torch.randn(*s, dtype=torch.bfloat16) * 0.4)(D, F) * (D ** -0.5)),
            "b1": _w((lambda *s: torch.randn(*s, dtype=torch.bfloat16) * 0.1)(F)),
            "w2": _w((lambda *s: torch.randn(*s, dtype=torch.bfloat16) * 0.1)(F, D) * (F ** -0.5)),
        }
    _B_in = _B_setup()

    return {
        "A_q": _A_in["q"],
        "A_k": _A_in["k"],
        "A_v": _A_in["v"],
        "A_shift_k": _A_in["shift_k"],
        "A_ssm_k": _A_in["ssm_k"],
        "A_ssm_D": _A_in["ssm_D"],
        "B_x": _B_in["x"],
        "B_w1": _B_in["w1"],
        "B_b1": _B_in["b1"],
        "B_w2": _B_in["w2"],
    }

def reference(A_q, A_k, A_v, A_shift_k, A_ssm_k, A_ssm_D, B_x, B_w1, B_b1, B_w2):
    def _A_ref(q, k, v, shift_k, ssm_k, ssm_D):
        B, S, D = q.shape
        ks = shift_k.shape[-1]
        k_pad = _pad(k, ((0, 0), (ks - 1, 0), (0, 0)))
        k_shift = torch.zeros_like(k)
        for t in range(ks):
            k_shift = k_shift + k_pad[:, t:t + S, :] * shift_k[:, ks - 1 - t][None, None, :]
        kv = k_shift * v
        L = 2 * S
        kv_pad = _pad(kv, ((0, 0), (0, S), (0, 0)))
        kf_pad = _pad(ssm_k, ((0, 0), (0, S)))
        kv_f = (lambda x, axes=(-2,-1): torch.fft.rfft2(x.float(), dim=axes))(kv_pad[:, None, :, :], axes=(1, 2))
        kf_f = (lambda x, axes=(-2,-1): torch.fft.rfft2(x.float(), dim=axes))(kf_pad[:, None, :], axes=(1, 2))
        kf_f = (lambda x, *d: x.permute(*d))(kf_f, 1, 2, 0)
        y_f = kv_f * kf_f[None, :, :, :]
        y = (lambda x, s, axes=(-2,-1): torch.fft.irfft2(x, s=s, dim=axes).to(torch.bfloat16))(y_f, (1, L), axes=(1, 2))[:, 0, :S, :]
        y = y + kv * ssm_D[None, None, :]
        return q * y

    def _B_ref(x, w1, b1, w2):
        h = torch.einsum("bsd,df->bsf", x, w1) + b1
        sp = torch.log1p(torch.exp(-torch.abs(h))) + torch.where(h > 0, h, torch.zeros_like(h))
        act = h * torch.tanh(sp)
        return torch.einsum("bsf,fd->bsd", act, w2)

    x = A_q
    x = x + _A_ref(_layernorm(x, axis=-1), A_k, A_v, A_shift_k, A_ssm_k, A_ssm_D)
    x = x + _B_ref(_layernorm(x, axis=-1), B_w1, B_b1, B_w2)
    x = x + _A_ref(_layernorm(x, axis=-1), A_k, A_v, A_shift_k, A_ssm_k, A_ssm_D)
    x = x + _B_ref(_layernorm(x, axis=-1), B_w1, B_b1, B_w2)
    return x
```

```asm
; @launch grid=(256,1,1) block=(256,1,1) lds=131072
.amdgcn_target "amdgcn-amd-amdhsa--gfx950"
.text
.globl interleave_layers__ssm_conv_h3__dense_activation_mish__prompt_kernel
.p2align 8
.type interleave_layers__ssm_conv_h3__dense_activation_mish__prompt_kernel,@function
interleave_layers__ssm_conv_h3__dense_activation_mish__prompt_kernel:
  s_cmp_ge_u32 s2, 256
  s_cbranch_scc1 K_DONE
  s_load_dwordx2 s[60:61], s[0:1], 96
  s_load_dwordx2 s[52:53], s[0:1], 88
  s_memrealtime s[62:63]
  s_waitcnt lgkmcnt(0)
  s_mov_b32 s96, s62
  s_add_u32 s56, s60, 0x1600000
  s_addc_u32 s57, s61, 0
  s_mov_b32 s58, 0x4000
  s_mov_b32 s59, 0x20000
  s_mov_b32 s48, s52
  s_mov_b32 s49, s53
  s_mov_b32 s50, 0x100
  s_mov_b32 s51, 0x20000
  v_lshrrev_b32 v1, 6, v0
  s_nop 0
  v_readfirstlane_b32 s16, v1
  s_nop 1
  s_or_b32 s55, s16, s2
  s_cmp_eq_u32 s55, 0
  s_cbranch_scc0 NONCE_1
  s_or_b32 s62, s62, 1
  v_mov_b32 v1, s62
  v_mov_b32 v2, 0
  buffer_store_dword v1, v2, s[48:51], 0 offen sc1
NONCE_1:
  s_load_dwordx2 s[4:5], s[0:1], 8
  s_load_dwordx2 s[6:7], s[0:1], 16
  s_load_dwordx2 s[8:9], s[0:1], 24
  s_load_dwordx2 s[10:11], s[0:1], 56
  s_load_dwordx2 s[12:13], s[0:1], 72
  s_load_dwordx2 s[14:15], s[0:1], 96
  v_lshrrev_b32 v1, 6, v0
  v_and_b32 v2, 7, v0
  v_lshrrev_b32 v3, 3, v0
  v_readfirstlane_b32 s16, v1
  s_lshr_b32 s17, s2, 3
  s_and_b32 s18, s2, 7
  s_waitcnt lgkmcnt(0)
  s_mov_b32 s20, s4
  s_mov_b32 s21, s5
  s_mov_b32 s22, 0x200000
  s_mov_b32 s23, 0x20000
  s_mov_b32 s24, s6
  s_mov_b32 s25, s7
  s_mov_b32 s26, 0x200000
  s_mov_b32 s27, 0x20000
  s_mov_b32 s28, s8
  s_mov_b32 s29, s9
  s_mov_b32 s30, 0x1000
  s_mov_b32 s31, 0x20000
  s_mov_b32 s36, s14
  s_mov_b32 s37, s15
  s_mov_b32 s38, 0x200000
  s_mov_b32 s39, 0x20000
  s_lshl_b32 s19, s17, 16
  s_lshl_b32 s44, s18, 7
  s_add_u32 s19, s19, s44
  v_lshlrev_b32 v4, 11, v3
  v_lshl_add_u32 v4, v2, 4, v4
  v_add_u32 v4, s19, v4
  v_subrev_u32 v5, 3072, v4
  v_subrev_u32 v6, 2048, v4
  v_subrev_u32 v7, 1024, v4
  buffer_load_dwordx4 v[16:19], v5, s[20:23], 0 offen
  buffer_load_dwordx4 v[20:23], v6, s[20:23], 0 offen
  buffer_load_dwordx4 v[24:27], v7, s[20:23], 0 offen
  buffer_load_dwordx4 v[28:31], v4, s[20:23], 0 offen
  buffer_load_dwordx4 v[32:35], v4, s[20:23], 0 offen offset:1024
  buffer_load_dwordx4 v[36:39], v4, s[24:27], 0 offen
  buffer_load_dwordx4 v[40:43], v4, s[24:27], 0 offen offset:1024
  s_lshl_b32 s44, s18, 9
  v_lshlrev_b32 v8, 6, v2
  v_add_u32 v8, s44, v8
  buffer_load_dwordx4 v[44:47], v8, s[28:31], 0 offen offset:0
  buffer_load_dwordx4 v[48:51], v8, s[28:31], 0 offen offset:16
  buffer_load_dwordx4 v[52:55], v8, s[28:31], 0 offen offset:32
  buffer_load_dwordx4 v[56:59], v8, s[28:31], 0 offen offset:48
  s_add_u32 s40, s14, 0x400000
  s_addc_u32 s41, s15, 0
  s_mov_b32 s42, 0x1c0000
  s_mov_b32 s43, 0x20000
  s_lshl_b32 s45, s2, 2
  s_add_u32 s45, s45, s16
  v_and_b32 v9, 15, v0
  v_bfe_u32 v10, v0, 4, 2
  v_lshlrev_b32 v9, 3, v9
  s_cmp_ge_u32 s45, 896
  s_cbranch_scc1 P0_NOW_4
  s_cmp_ge_u32 s45, 448
  s_cbranch_scc1 P0_W2_2
  s_mov_b32 s32, s10
  s_mov_b32 s33, s11
  s_mov_b32 s34, 0x1c0000
  s_mov_b32 s35, 0x20000
  s_lshr_b32 s46, s45, 4
  s_and_b32 s47, s45, 15
  s_mul_i32 s47, s47, 114688
  s_lshl_b32 s46, s46, 7
  s_add_u32 s47, s47, s46
  s_mov_b32 s4, 3584
  s_lshl_b32 s5, s45, 12
  v_mul_u32_u24 v10, 28672, v10
  s_branch P0_WL_3
P0_W2_2:
  s_mov_b32 s32, s12
  s_mov_b32 s33, s13
  s_mov_b32 s34, 0x1c0000
  s_mov_b32 s35, 0x20000
  s_add_u32 s40, s14, 0x600000
  s_addc_u32 s41, s15, 0
  s_mov_b32 s42, 0x1c0000
  s_mov_b32 s43, 0x20000
  s_sub_u32 s45, s45, 448
  s_mul_i32 s46, s45, 1171
  s_lshr_b32 s46, s46, 16
  s_mul_i32 s47, s46, 56
  s_sub_u32 s47, s45, s47
  s_lshr_b32 s6, s47, 1
  s_and_b32 s47, s47, 1
  s_lshl_b32 s6, s6, 16
  s_lshl_b32 s47, s47, 13
  s_add_u32 s47, s47, s6
  s_lshl_b32 s46, s46, 7
  s_add_u32 s47, s47, s46
  s_mov_b32 s4, 1024
  s_lshl_b32 s5, s45, 12
  v_lshlrev_b32 v10, 14, v10
P0_WL_3:
  v_add_u32 v10, v9, v10
  buffer_load_dwordx2 v[60:61], v10, s[32:35], s47 offen
  s_add_u32 s47, s47, s4
  buffer_load_dwordx2 v[62:63], v10, s[32:35], s47 offen
  s_add_u32 s47, s47, s4
  buffer_load_dwordx2 v[64:65], v10, s[32:35], s47 offen
  s_add_u32 s47, s47, s4
  buffer_load_dwordx2 v[66:67], v10, s[32:35], s47 offen
  s_add_u32 s47, s47, s4
  buffer_load_dwordx2 v[68:69], v10, s[32:35], s47 offen
  s_add_u32 s47, s47, s4
  buffer_load_dwordx2 v[70:71], v10, s[32:35], s47 offen
  s_add_u32 s47, s47, s4
  buffer_load_dwordx2 v[72:73], v10, s[32:35], s47 offen
  s_add_u32 s47, s47, s4
  buffer_load_dwordx2 v[74:75], v10, s[32:35], s47 offen
P0_NOW_4:
  s_mov_b32 s7, 0xffff0000
  s_cmp_ge_u32 s45, 896
  s_cbranch_scc1 P0_NOW_5
  s_waitcnt vmcnt(8)
  s_branch P0_J_6
P0_NOW_5:
  s_waitcnt vmcnt(0)
P0_J_6:
  v_mov_b32 v15, 0
  buffer_load_dword v15, v15, s[48:51], 0 offen sc1
  v_lshlrev_b32 v96, 16, v16
  v_and_b32 v97, s7, v16
  v_lshlrev_b32 v98, 16, v17
  v_and_b32 v99, s7, v17
  v_lshlrev_b32 v100, 16, v18
  v_and_b32 v101, s7, v18
  v_lshlrev_b32 v102, 16, v19
  v_and_b32 v103, s7, v19
  v_lshlrev_b32 v104, 16, v20
  v_and_b32 v105, s7, v20
  v_lshlrev_b32 v106, 16, v21
  v_and_b32 v107, s7, v21
  v_lshlrev_b32 v108, 16, v22
  v_and_b32 v109, s7, v22
  v_lshlrev_b32 v110, 16, v23
  v_and_b32 v111, s7, v23
  v_lshlrev_b32 v112, 16, v24
  v_and_b32 v113, s7, v24
  v_lshlrev_b32 v114, 16, v25
  v_and_b32 v115, s7, v25
  v_lshlrev_b32 v116, 16, v26
  v_and_b32 v117, s7, v26
  v_lshlrev_b32 v118, 16, v27
  v_and_b32 v119, s7, v27
  v_lshlrev_b32 v120, 16, v28
  v_and_b32 v121, s7, v28
  v_lshlrev_b32 v122, 16, v29
  v_and_b32 v123, s7, v29
  v_lshlrev_b32 v124, 16, v30
  v_and_b32 v125, s7, v30
  v_lshlrev_b32 v126, 16, v31
  v_and_b32 v127, s7, v31
  v_lshlrev_b32 v128, 16, v32
  v_and_b32 v129, s7, v32
  v_lshlrev_b32 v130, 16, v33
  v_and_b32 v131, s7, v33
  v_lshlrev_b32 v132, 16, v34
  v_and_b32 v133, s7, v34
  v_lshlrev_b32 v134, 16, v35
  v_and_b32 v135, s7, v35
  v_lshlrev_b32 v136, 16, v44
  v_and_b32 v144, s7, v44
  v_lshlrev_b32 v152, 16, v45
  v_and_b32 v160, s7, v45
  v_lshlrev_b32 v137, 16, v46
  v_and_b32 v145, s7, v46
  v_lshlrev_b32 v153, 16, v47
  v_and_b32 v161, s7, v47
  v_lshlrev_b32 v138, 16, v48
  v_and_b32 v146, s7, v48
  v_lshlrev_b32 v154, 16, v49
  v_and_b32 v162, s7, v49
  v_lshlrev_b32 v139, 16, v50
  v_and_b32 v147, s7, v50
  v_lshlrev_b32 v155, 16, v51
  v_and_b32 v163, s7, v51
  v_lshlrev_b32 v140, 16, v52
  v_and_b32 v148, s7, v52
  v_lshlrev_b32 v156, 16, v53
  v_and_b32 v164, s7, v53
  v_lshlrev_b32 v141, 16, v54
  v_and_b32 v149, s7, v54
  v_lshlrev_b32 v157, 16, v55
  v_and_b32 v165, s7, v55
  v_lshlrev_b32 v142, 16, v56
  v_and_b32 v150, s7, v56
  v_lshlrev_b32 v158, 16, v57
  v_and_b32 v166, s7, v57
  v_lshlrev_b32 v143, 16, v58
  v_and_b32 v151, s7, v58
  v_lshlrev_b32 v159, 16, v59
  v_and_b32 v167, s7, v59
  v_lshlrev_b32 v168, 16, v36
  v_and_b32 v169, s7, v36
  v_lshlrev_b32 v170, 16, v37
  v_and_b32 v171, s7, v37
  v_lshlrev_b32 v172, 16, v38
  v_and_b32 v173, s7, v38
  v_lshlrev_b32 v174, 16, v39
  v_and_b32 v175, s7, v39
  v_lshlrev_b32 v176, 16, v40
  v_and_b32 v177, s7, v40
  v_lshlrev_b32 v178, 16, v41
  v_and_b32 v179, s7, v41
  v_lshlrev_b32 v180, 16, v42
  v_and_b32 v181, s7, v42
  v_lshlrev_b32 v182, 16, v43
  v_and_b32 v183, s7, v43
  v_pk_mul_f32 v[184:185], v[120:121], v[136:137]
  v_pk_mul_f32 v[186:187], v[122:123], v[138:139]
  v_pk_mul_f32 v[188:189], v[124:125], v[140:141]
  v_pk_mul_f32 v[190:191], v[126:127], v[142:143]
  v_pk_fma_f32 v[184:185], v[112:113], v[144:145], v[184:185]
  v_pk_fma_f32 v[186:187], v[114:115], v[146:147], v[186:187]
  v_pk_fma_f32 v[188:189], v[116:117], v[148:149], v[188:189]
  v_pk_fma_f32 v[190:191], v[118:119], v[150:151], v[190:191]
  v_pk_fma_f32 v[184:185], v[104:105], v[152:153], v[184:185]
  v_pk_fma_f32 v[186:187], v[106:107], v[154:155], v[186:187]
  v_pk_fma_f32 v[188:189], v[108:109], v[156:157], v[188:189]
  v_pk_fma_f32 v[190:191], v[110:111], v[158:159], v[190:191]
  v_pk_fma_f32 v[184:185], v[96:97], v[160:161], v[184:185]
  v_pk_fma_f32 v[186:187], v[98:99], v[162:163], v[186:187]
  v_pk_fma_f32 v[188:189], v[100:101], v[164:165], v[188:189]
  v_pk_fma_f32 v[190:191], v[102:103], v[166:167], v[190:191]
  v_pk_mul_f32 v[192:193], v[128:129], v[136:137]
  v_pk_mul_f32 v[194:195], v[130:131], v[138:139]
  v_pk_mul_f32 v[196:197], v[132:133], v[140:141]
  v_pk_mul_f32 v[198:199], v[134:135], v[142:143]
  v_pk_fma_f32 v[192:193], v[120:121], v[144:145], v[192:193]
  v_pk_fma_f32 v[194:195], v[122:123], v[146:147], v[194:195]
  v_pk_fma_f32 v[196:197], v[124:125], v[148:149], v[196:197]
  v_pk_fma_f32 v[198:199], v[126:127], v[150:151], v[198:199]
  v_pk_fma_f32 v[192:193], v[112:113], v[152:153], v[192:193]
  v_pk_fma_f32 v[194:195], v[114:115], v[154:155], v[194:195]
  v_pk_fma_f32 v[196:197], v[116:117], v[156:157], v[196:197]
  v_pk_fma_f32 v[198:199], v[118:119], v[158:159], v[198:199]
  v_pk_fma_f32 v[192:193], v[104:105], v[160:161], v[192:193]
  v_pk_fma_f32 v[194:195], v[106:107], v[162:163], v[194:195]
  v_pk_fma_f32 v[196:197], v[108:109], v[164:165], v[196:197]
  v_pk_fma_f32 v[198:199], v[110:111], v[166:167], v[198:199]
  v_pk_mul_f32 v[184:185], v[184:185], v[168:169]
  v_pk_mul_f32 v[186:187], v[186:187], v[170:171]
  v_pk_mul_f32 v[188:189], v[188:189], v[172:173]
  v_pk_mul_f32 v[190:191], v[190:191], v[174:175]
  v_pk_mul_f32 v[192:193], v[192:193], v[176:177]
  v_pk_mul_f32 v[194:195], v[194:195], v[178:179]
  v_pk_mul_f32 v[196:197], v[196:197], v[180:181]
  v_pk_mul_f32 v[198:199], v[198:199], v[182:183]
  v_cvt_pk_bf16_f32 v16, v192, v184
  v_cvt_pk_bf16_f32 v17, v193, v185
  v_cvt_pk_bf16_f32 v18, v194, v186
  v_cvt_pk_bf16_f32 v19, v195, v187
  v_cvt_pk_bf16_f32 v20, v196, v188
  v_cvt_pk_bf16_f32 v21, v197, v189
  v_cvt_pk_bf16_f32 v22, v198, v190
  v_cvt_pk_bf16_f32 v23, v199, v191
  v_lshrrev_b32 v5, 2, v3
  v_xor_b32 v5, v5, v2
  v_lshlrev_b32 v5, 4, v5
  v_lshl_add_u32 v5, v2, 10, v5
  v_and_b32 v6, 3, v3
  v_sub_u32 v6, 3, v6
  v_lshl_add_u32 v5, v6, 2, v5
  ds_write_b32 v5, v16 offset:0
  ds_write_b32 v5, v17 offset:128
  ds_write_b32 v5, v18 offset:256
  ds_write_b32 v5, v19 offset:384
  ds_write_b32 v5, v20 offset:512
  ds_write_b32 v5, v21 offset:640
  ds_write_b32 v5, v22 offset:768
  ds_write_b32 v5, v23 offset:896
  s_waitcnt lgkmcnt(0)
  s_barrier
  v_and_b32 v5, 7, v0
  v_lshrrev_b32 v6, 3, v0
  v_xor_b32 v7, s16, v5
  v_lshlrev_b32 v7, 4, v7
  v_lshl_add_u32 v7, v6, 7, v7
  v_xor_b32 v8, 64, v7
  ds_read_b128 v[16:19], v7
  ds_read_b128 v[20:23], v8 offset:4096
  s_lshl_b32 s44, s18, 18
  s_lshl_b32 s46, s17, 7
  s_add_u32 s44, s44, s46
  v_lshlrev_b32 v9, 12, v6
  v_lshl_add_u32 v9, v5, 4, v9
  v_add_u32 v9, s44, v9
  v_add_u32 v10, 0x20000, v9
  s_waitcnt lgkmcnt(1)
  buffer_store_dwordx4 v[16:19], v9, s[36:39], 0 offen sc1
  s_waitcnt lgkmcnt(0)
  buffer_store_dwordx4 v[20:23], v10, s[36:39], 0 offen sc1
  s_lshl_b32 s12, s18, 5
  s_add_u32 s12, s12, s17
  s_lshl_b32 s12, s12, 2
  s_add_u32 s12, s12, 0
  s_waitcnt vmcnt(0) lgkmcnt(0)
  s_cmp_eq_u32 s16, 0
  s_cbranch_scc0 NC_8
  v_readfirstlane_b32 s54, v15
  s_nop 1
  s_cmp_lg_u32 s54, 0
  s_cbranch_scc1 NC_8
  s_load_dwordx2 s[52:53], s[0:1], 88
  s_waitcnt lgkmcnt(0)
  s_mov_b32 s48, s52
  s_mov_b32 s49, s53
  s_mov_b32 s50, 0x100
  s_mov_b32 s51, 0x20000
  v_mov_b32 v2, 0
  s_mov_b32 s55, 0x8000
GN_9:
  buffer_load_dword v1, v2, s[48:51], 0 offen sc1
  s_waitcnt vmcnt(0)
  v_readfirstlane_b32 s54, v1
  s_cmp_lg_u32 s54, 0
  s_cbranch_scc1 GND_10
  s_sub_u32 s55, s55, 1
  s_cmp_eq_u32 s55, 0
  s_cbranch_scc1 GND_10
  s_branch GN_9
GND_10:
NC_8:
  s_barrier
  s_cmp_eq_u32 s16, 0
  s_cbranch_scc0 SIG_7
  v_mov_b32 v1, s54
  v_mov_b32 v2, 0
  buffer_store_dword v1, v2, s[56:59], s12 offen sc1
SIG_7:
  s_cmp_ge_u32 s45, 896
  s_cbranch_scc1 P0_NW_11
  s_mov_b32 s52, 0x05040100
  s_mov_b32 s53, 0x07060302
  s_waitcnt vmcnt(0)
  v_perm_b32 v76, v62, v60, s52
  v_perm_b32 v77, v66, v64, s52
  v_perm_b32 v78, v70, v68, s52
  v_perm_b32 v79, v74, v72, s52
  v_perm_b32 v80, v62, v60, s53
  v_perm_b32 v81, v66, v64, s53
  v_perm_b32 v82, v70, v68, s53
  v_perm_b32 v83, v74, v72, s53
  v_perm_b32 v84, v63, v61, s52
  v_perm_b32 v85, v67, v65, s52
  v_perm_b32 v86, v71, v69, s52
  v_perm_b32 v87, v75, v73, s52
  v_perm_b32 v88, v63, v61, s53
  v_perm_b32 v89, v67, v65, s53
  v_perm_b32 v90, v71, v69, s53
  v_perm_b32 v91, v75, v73, s53
  v_and_b32 v11, 63, v0
  v_lshlrev_b32 v11, 4, v11
  buffer_store_dwordx4 v[76:79], v11, s[40:43], s5 offen offset:0 sc1
  buffer_store_dwordx4 v[80:83], v11, s[40:43], s5 offen offset:1024 sc1
  buffer_store_dwordx4 v[84:87], v11, s[40:43], s5 offen offset:2048 sc1
  buffer_store_dwordx4 v[88:91], v11, s[40:43], s5 offen offset:3072 sc1
P0_NW_11:
  s_load_dwordx2 s[4:5], s[0:1], 32
  s_load_dwordx2 s[6:7], s[0:1], 40
  s_load_dwordx2 s[8:9], s[0:1], 96
  v_lshrrev_b32 v1, 6, v0
  v_and_b32 v2, 63, v0
  v_lshlrev_b32 v3, 4, v0
  v_readfirstlane_b32 s16, v1
  s_lshl_b32 s17, s2, 13
  s_lshl_b32 s12, s2, 2
  s_waitcnt lgkmcnt(0)
  s_load_dword s13, s[6:7], s12
  s_add_u32 s20, s4, s17
  s_addc_u32 s21, s5, 0
  s_mov_b32 s22, 0x1000
  s_mov_b32 s23, 0x20000
  s_add_u32 s24, s4, s17
  s_addc_u32 s25, s5, 0
  s_add_u32 s24, s24, 0x1000
  s_addc_u32 s25, s25, 0
  s_mov_b32 s26, 0x1000
  s_mov_b32 s27, 0x20000
  s_add_u32 s28, s8, s17
  s_addc_u32 s29, s9, 0
  s_mov_b32 s30, 0x2000
  s_mov_b32 s31, 0x20000
  s_add_u32 s32, s8, 0x200000
  s_addc_u32 s33, s9, 0
  s_mov_b32 s34, 0x200000
  s_mov_b32 s35, 0x20000
  v_subrev_u32 v4, 16, v3
  buffer_load_dwordx4 v[16:19], v4, s[20:23], 0 offen
  buffer_load_dwordx4 v[20:23], v3, s[20:23], 0 offen
  buffer_load_dwordx4 v[40:43], v4, s[24:27], 0 offen
  buffer_load_dwordx4 v[44:47], v3, s[24:27], 0 offen
  s_lshr_b32 s18, s16, 1
  s_and_b32 s19, s16, 1
  v_mov_b32 v8, 0
  v_mov_b32 v9, 0
  v_mov_b32 v10, 0
  v_mov_b32 v11, 0
  s_cmp_eq_u32 s16, 0
  s_cbranch_scc0 P1_Z1_12
  v_lshrrev_b32 v6, 5, v2
  v_mul_u32_u24 v6, 4608, v6
  v_and_b32 v7, 31, v2
  v_lshl_add_u32 v6, v7, 4, v6
  v_add_u32 v6, 69632, v6
  ds_write_b128 v6, v[8:11]
P1_Z1_12:
  s_cmp_eq_u32 s16, 1
  s_cbranch_scc0 P1_Z2_13
  v_and_b32 v6, 7, v2
  v_lshlrev_b32 v7, 2, v6
  s_mov_b32 s14, 0xCB885411
  v_lshrrev_b32 v7, v7, s14
  v_and_b32 v7, 15, v7
  v_mul_u32_u24 v6, 272, v6
  v_add_u32 v6, v6, v7
  v_lshlrev_b32 v6, 4, v6
  v_bfe_u32 v7, v2, 3, 1
  v_mul_u32_u24 v7, 34816, v7
  v_add_u32 v6, v6, v7
  ds_write_b128 v6, v[8:11]
P1_Z2_13:
  v_and_b32 v4, 15, v2
  v_lshrrev_b32 v5, 4, v2
  v_add_u32 v6, 1, v4
  v_and_b32 v7, 7, v6
  v_lshrrev_b32 v6, 3, v6
  v_lshlrev_b32 v14, 2, v7
  s_mov_b32 s14, 0xCB885410
  v_lshrrev_b32 v14, v14, s14
  v_and_b32 v14, 15, v14
  v_mul_u32_u24 v7, 272, v7
  v_add_u32 v7, v7, v14
  v_add_u32 v7, v7, v6
  v_sub_u32 v7, v7, v5
  v_add_u32 v7, 3, v7
  v_lshlrev_b32 v12, 4, v7
  s_mul_i32 s14, s18, 34816
  s_lshl_b32 s15, s19, 8
  s_add_u32 s14, s14, s15
  v_add_u32 v12, s14, v12
  v_lshlrev_b32 v13, 5, v4
  v_lshl_add_u32 v13, v5, 4, v13
  s_mul_i32 s14, s18, 4608
  s_sub_u32 s14, s14, s15
  s_add_u32 s14, s14, 69920
  v_add_u32 v13, s14, v13
  s_waitcnt lgkmcnt(0)
  s_lshl_b32 s14, s18, 4
  s_lshr_b32 s13, s13, s14
  s_and_b32 s13, s13, 0xffff
  v_lshrrev_b32 v6, 3, v4
  v_add_u32 v6, 2, v6
  v_and_b32 v7, 7, v4
  v_sub_u32 v7, 7, v7
  v_and_b32 v14, 1, v7
  v_lshlrev_b32 v14, 4, v14
  v_lshlrev_b32 v14, v14, s13
  v_lshrrev_b32 v7, 1, v7
  v_cmp_eq_u32 vcc, v6, v5
  s_nop 1
  v_cndmask_b32 v14, 0, v14, vcc
  v_cmp_eq_u32 vcc, 0, v7
  s_nop 1
  v_cndmask_b32 v192, 0, v14, vcc
  v_cmp_eq_u32 vcc, 1, v7
  s_nop 1
  v_cndmask_b32 v193, 0, v14, vcc
  v_cmp_eq_u32 vcc, 2, v7
  s_nop 1
  v_cndmask_b32 v194, 0, v14, vcc
  v_cmp_eq_u32 vcc, 3, v7
  s_nop 1
  v_cndmask_b32 v195, 0, v14, vcc
  s_waitcnt vmcnt(2)
  v_mov_b32 v64, v17
  v_mov_b32 v65, v18
  v_mov_b32 v66, v19
  v_mov_b32 v67, v20
  v_mov_b32 v68, v21
  v_mov_b32 v69, v22
  v_alignbit_b32 v70, v17, v16, 16
  v_alignbit_b32 v71, v18, v17, 16
  v_alignbit_b32 v72, v19, v18, 16
  v_alignbit_b32 v73, v20, v19, 16
  v_alignbit_b32 v74, v21, v20, 16
  v_alignbit_b32 v75, v22, v21, 16
  v_alignbit_b32 v76, v18, v17, 16
  v_alignbit_b32 v77, v19, v18, 16
  v_alignbit_b32 v78, v20, v19, 16
  v_alignbit_b32 v79, v21, v20, 16
  v_alignbit_b32 v80, v22, v21, 16
  v_alignbit_b32 v81, v23, v22, 16
  ds_write_b128 v3, v[20:23] offset:32
  ds_write_b128 v3, v[70:73] offset:4384
  ds_write_b128 v3, v[64:67] offset:8784
  ds_write_b128 v3, v[76:79] offset:13152
  ds_write_b128 v3, v[18:21] offset:17552
  ds_write_b128 v3, v[72:75] offset:21904
  ds_write_b128 v3, v[66:69] offset:26304
  ds_write_b128 v3, v[78:81] offset:30672
  s_waitcnt vmcnt(0)
  v_mov_b32 v84, v41
  v_mov_b32 v85, v42
  v_mov_b32 v86, v43
  v_mov_b32 v87, v44
  v_mov_b32 v88, v45
  v_mov_b32 v89, v46
  v_alignbit_b32 v90, v41, v40, 16
  v_alignbit_b32 v91, v42, v41, 16
  v_alignbit_b32 v92, v43, v42, 16
  v_alignbit_b32 v93, v44, v43, 16
  v_alignbit_b32 v94, v45, v44, 16
  v_alignbit_b32 v95, v46, v45, 16
  v_alignbit_b32 v96, v42, v41, 16
  v_alignbit_b32 v97, v43, v42, 16
  v_alignbit_b32 v98, v44, v43, 16
  v_alignbit_b32 v99, v45, v44, 16
  v_alignbit_b32 v100, v46, v45, 16
  v_alignbit_b32 v101, v47, v46, 16
  ds_write_b128 v3, v[44:47] offset:34848
  ds_write_b128 v3, v[90:93] offset:39200
  ds_write_b128 v3, v[84:87] offset:43600
  ds_write_b128 v3, v[96:99] offset:47968
  ds_write_b128 v3, v[42:45] offset:52368
  ds_write_b128 v3, v[92:95] offset:56720
  ds_write_b128 v3, v[86:89] offset:61120
  ds_write_b128 v3, v[98:101] offset:65488
  v_and_b32 v6, 31, v2
  v_lshlrev_b32 v6, 2, v6
  s_lshr_b32 s14, s2, 5
  s_lshl_b32 s14, s14, 7
  s_add_u32 s14, s14, 0
  s_cmp_eq_u32 s16, 0
  s_cbranch_scc0 WFS_16
  s_mov_b32 s55, 0x4000
  buffer_load_dword v8, v6, s[56:59], s14 offen sc1
WF_14:
  s_waitcnt vmcnt(0)
  v_cmp_ne_u32 vcc, s54, v8
  s_nop 1
  s_cmp_eq_u64 vcc, 0
  s_cbranch_scc1 WFD_15
  buffer_load_dword v8, v6, s[56:59], s14 offen sc1
  s_sub_u32 s55, s55, 1
  s_cmp_eq_u32 s55, 0
  s_cbranch_scc0 WF_14
WFD_15:
WFS_16:
  s_barrier
  s_mul_i32 s14, s18, 4608
  s_lshl_b32 s15, s19, 11
  s_add_u32 s14, s14, s15
  s_add_u32 s14, s14, 70144
  s_mov_b32 m0, s14
  s_lshl_b32 s15, s16, 11
  v_lshlrev_b32 v5, 4, v2
  buffer_load_dwordx4 v5, s[28:31], s15 offen sc1 lds
  s_add_u32 s14, s14, 1024
  s_mov_b32 m0, s14
  s_add_u32 s15, s15, 1024
  buffer_load_dwordx4 v5, s[28:31], s15 offen sc1 lds
  s_waitcnt vmcnt(0) lgkmcnt(0)
  s_barrier
  s_lshl_b32 s12, s2, 2
  s_add_u32 s12, s12, 2048
  s_cmp_eq_u32 s16, 0
  s_cbranch_scc0 SIG_17
  v_mov_b32 v8, s54
  v_mov_b32 v9, 0
  buffer_store_dword v8, v9, s[56:59], s12 offen sc1
SIG_17:
  ds_read_b128 v[112:115], v12 offset:0
  ds_read_b128 v[144:147], v13 offset:192
  ds_read_b128 v[148:151], v13 offset:704
  ds_read_b128 v[152:155], v13 offset:1216
  ds_read_b128 v[156:159], v13 offset:1728
  ds_read_b128 v[160:163], v13 offset:2240
  ds_read_b128 v[164:167], v13 offset:2752
  ds_read_b128 v[168:171], v13 offset:3264
  ds_read_b128 v[172:175], v13 offset:3776
  ds_read_b128 v[116:119], v12 offset:512
  ds_read_b128 v[120:123], v12 offset:1024
  ds_read_b128 v[124:127], v12 offset:1536
  ds_read_b128 v[128:131], v12 offset:2048
  ds_read_b128 v[132:135], v12 offset:2560
  ds_read_b128 v[136:139], v12 offset:3072
  v_mov_b32 v16, 0
  v_mov_b32 v17, 0
  v_mov_b32 v18, 0
  v_mov_b32 v19, 0
  v_mov_b32 v20, 0
  v_mov_b32 v21, 0
  v_mov_b32 v22, 0
  v_mov_b32 v23, 0
  v_mov_b32 v24, 0
  v_mov_b32 v25, 0
  v_mov_b32 v26, 0
  v_mov_b32 v27, 0
  v_mov_b32 v28, 0
  v_mov_b32 v29, 0
  v_mov_b32 v30, 0
  v_mov_b32 v31, 0
  v_mov_b32 v32, 0
  v_mov_b32 v33, 0
  v_mov_b32 v34, 0
  v_mov_b32 v35, 0
  v_mov_b32 v36, 0
  v_mov_b32 v37, 0
  v_mov_b32 v38, 0
  v_mov_b32 v39, 0
  v_mov_b32 v40, 0
  v_mov_b32 v41, 0
  v_mov_b32 v42, 0
  v_mov_b32 v43, 0
  v_mov_b32 v44, 0
  v_mov_b32 v45, 0
  v_mov_b32 v46, 0
  v_mov_b32 v47, 0
  ds_read_b128 v[140:143], v12 offset:3584
  s_waitcnt lgkmcnt(7)
  v_mfma_f32_16x16x32_bf16 v[16:19], v[112:115], v[144:147], v[16:19]
  ds_read_b128 v[48:51], v12 offset:64
  v_mfma_f32_16x16x32_bf16 v[20:23], v[112:115], v[148:151], v[20:23]
  v_mfma_f32_16x16x32_bf16 v[24:27], v[112:115], v[152:155], v[24:27]
  ds_read_b128 v[80:83], v13 offset:128
  v_mfma_f32_16x16x32_bf16 v[28:31], v[112:115], v[156:159], v[28:31]
  v_mfma_f32_16x16x32_bf16 v[32:35], v[112:115], v[160:163], v[32:35]
  ds_read_b128 v[84:87], v13 offset:640
  v_mfma_f32_16x16x32_bf16 v[36:39], v[112:115], v[164:167], v[36:39]
  v_mfma_f32_16x16x32_bf16 v[40:43], v[112:115], v[168:171], v[40:43]
  ds_read_b128 v[88:91], v13 offset:1152
  v_mfma_f32_16x16x32_bf16 v[44:47], v[112:115], v[172:175], v[44:47]
  s_waitcnt lgkmcnt(10)
  v_mfma_f32_16x16x32_bf16 v[20:23], v[116:119], v[144:147], v[20:23]
  ds_read_b128 v[92:95], v13 offset:1664
  v_mfma_f32_16x16x32_bf16 v[24:27], v[116:119], v[148:151], v[24:27]
  v_mfma_f32_16x16x32_bf16 v[28:31], v[116:119], v[152:155], v[28:31]
  ds_read_b128 v[96:99], v13 offset:2176
  v_mfma_f32_16x16x32_bf16 v[32:35], v[116:119], v[156:159], v[32:35]
  v_mfma_f32_16x16x32_bf16 v[36:39], v[116:119], v[160:163], v[36:39]
  ds_read_b128 v[100:103], v13 offset:2688
  v_mfma_f32_16x16x32_bf16 v[40:43], v[116:119], v[164:167], v[40:43]
  v_mfma_f32_16x16x32_bf16 v[44:47], v[116:119], v[168:171], v[44:47]
  ds_read_b128 v[104:107], v13 offset:3200
  s_waitcnt lgkmcnt(13)
  v_mfma_f32_16x16x32_bf16 v[24:27], v[120:123], v[144:147], v[24:27]
  v_mfma_f32_16x16x32_bf16 v[28:31], v[120:123], v[148:151], v[28:31]
  ds_read_b128 v[108:111], v13 offset:3712
  v_mfma_f32_16x16x32_bf16 v[32:35], v[120:123], v[152:155], v[32:35]
  v_mfma_f32_16x16x32_bf16 v[36:39], v[120:123], v[156:159], v[36:39]
  ds_read_b128 v[52:55], v12 offset:576
  v_mfma_f32_16x16x32_bf16 v[40:43], v[120:123], v[160:163], v[40:43]
  v_mfma_f32_16x16x32_bf16 v[44:47], v[120:123], v[164:167], v[44:47]
  ds_read_b128 v[56:59], v12 offset:1088
  s_waitcnt lgkmcnt(15)
  v_mfma_f32_16x16x32_bf16 v[28:31], v[124:127], v[144:147], v[28:31]
  v_mfma_f32_16x16x32_bf16 v[32:35], v[124:127], v[148:151], v[32:35]
  ds_read_b128 v[60:63], v12 offset:1600
  v_mfma_f32_16x16x32_bf16 v[36:39], v[124:127], v[152:155], v[36:39]
  v_mfma_f32_16x16x32_bf16 v[40:43], v[124:127], v[156:159], v[40:43]
  ds_read_b128 v[64:67], v12 offset:2112
  v_mfma_f32_16x16x32_bf16 v[44:47], v[124:127], v[160:163], v[44:47]
  s_waitcnt lgkmcnt(15)
  v_mfma_f32_16x16x32_bf16 v[32:35], v[128:131], v[144:147], v[32:35]
  ds_read_b128 v[68:71], v12 offset:2624
  v_mfma_f32_16x16x32_bf16 v[36:39], v[128:131], v[148:151], v[36:39]
  v_mfma_f32_16x16x32_bf16 v[40:43], v[128:131], v[152:155], v[40:43]
  ds_read_b128 v[72:75], v12 offset:3136
  v_mfma_f32_16x16x32_bf16 v[44:47], v[128:131], v[156:159], v[44:47]
  s_waitcnt lgkmcnt(15)
  v_mfma_f32_16x16x32_bf16 v[36:39], v[132:135], v[144:147], v[36:39]
  ds_read_b128 v[76:79], v12 offset:3648
  v_mfma_f32_16x16x32_bf16 v[40:43], v[132:135], v[148:151], v[40:43]
  v_mfma_f32_16x16x32_bf16 v[44:47], v[132:135], v[152:155], v[44:47]
  s_waitcnt lgkmcnt(15)
  v_mfma_f32_16x16x32_bf16 v[40:43], v[136:139], v[144:147], v[40:43]
  v_mfma_f32_16x16x32_bf16 v[44:47], v[136:139], v[148:151], v[44:47]
  s_waitcnt lgkmcnt(15)
  v_mfma_f32_16x16x32_bf16 v[44:47], v[140:143], v[144:147], v[44:47]
  s_cmp_eq_u32 s19, 0
  s_cbranch_scc0 P1_ND_18
  v_mfma_f32_16x16x32_bf16 v[16:19], v[192:195], v[144:147], v[16:19]
  v_mfma_f32_16x16x32_bf16 v[20:23], v[192:195], v[148:151], v[20:23]
  v_mfma_f32_16x16x32_bf16 v[24:27], v[192:195], v[152:155], v[24:27]
  v_mfma_f32_16x16x32_bf16 v[28:31], v[192:195], v[156:159], v[28:31]
  v_mfma_f32_16x16x32_bf16 v[32:35], v[192:195], v[160:163], v[32:35]
  v_mfma_f32_16x16x32_bf16 v[36:39], v[192:195], v[164:167], v[36:39]
  v_mfma_f32_16x16x32_bf16 v[40:43], v[192:195], v[168:171], v[40:43]
  v_mfma_f32_16x16x32_bf16 v[44:47], v[192:195], v[172:175], v[44:47]
P1_ND_18:
  s_waitcnt lgkmcnt(0)
  v_mfma_f32_16x16x32_bf16 v[16:19], v[48:51], v[80:83], v[16:19]
  ds_read_b128 v[112:115], v12 offset:128
  v_mfma_f32_16x16x32_bf16 v[20:23], v[48:51], v[84:87], v[20:23]
  v_mfma_f32_16x16x32_bf16 v[24:27], v[48:51], v[88:91], v[24:27]
  ds_read_b128 v[144:147], v13 offset:64
  v_mfma_f32_16x16x32_bf16 v[28:31], v[48:51], v[92:95], v[28:31]
  v_mfma_f32_16x16x32_bf16 v[32:35], v[48:51], v[96:99], v[32:35]
  ds_read_b128 v[148:151], v13 offset:576
  v_mfma_f32_16x16x32_bf16 v[36:39], v[48:51], v[100:103], v[36:39]
  v_mfma_f32_16x16x32_bf16 v[40:43], v[48:51], v[104:107], v[40:43]
  ds_read_b128 v[152:155], v13 offset:1088
  v_mfma_f32_16x16x32_bf16 v[44:47], v[48:51], v[108:111], v[44:47]
  v_mfma_f32_16x16x32_bf16 v[20:23], v[52:55], v[80:83], v[20:23]
  ds_read_b128 v[156:159], v13 offset:1600
  v_mfma_f32_16x16x32_bf16 v[24:27], v[52:55], v[84:87], v[24:27]
  v_mfma_f32_16x16x32_bf16 v[28:31], v[52:55], v[88:91], v[28:31]
  ds_read_b128 v[160:163], v13 offset:2112
  v_mfma_f32_16x16x32_bf16 v[32:35], v[52:55], v[92:95], v[32:35]
  v_mfma_f32_16x16x32_bf16 v[36:39], v[52:55], v[96:99], v[36:39]
  ds_read_b128 v[164:167], v13 offset:2624
  v_mfma_f32_16x16x32_bf16 v[40:43], v[52:55], v[100:103], v[40:43]
  v_mfma_f32_16x16x32_bf16 v[44:47], v[52:55], v[104:107], v[44:47]
  ds_read_b128 v[168:171], v13 offset:3136
  v_mfma_f32_16x16x32_bf16 v[24:27], v[56:59], v[80:83], v[24:27]
  v_mfma_f32_16x16x32_bf16 v[28:31], v[56:59], v[84:87], v[28:31]
  ds_read_b128 v[172:175], v13 offset:3648
  v_mfma_f32_16x16x32_bf16 v[32:35], v[56:59], v[88:91], v[32:35]
  v_mfma_f32_16x16x32_bf16 v[36:39], v[56:59], v[92:95], v[36:39]
  ds_read_b128 v[116:119], v12 offset:640
  v_mfma_f32_16x16x32_bf16 v[40:43], v[56:59], v[96:99], v[40:43]
  v_mfma_f32_16x16x32_bf16 v[44:47], v[56:59], v[100:103], v[44:47]
  ds_read_b128 v[120:123], v12 offset:1152
  v_mfma_f32_16x16x32_bf16 v[28:31], v[60:63], v[80:83], v[28:31]
  v_mfma_f32_16x16x32_bf16 v[32:35], v[60:63], v[84:87], v[32:35]
  ds_read_b128 v[124:127], v12 offset:1664
  v_mfma_f32_16x16x32_bf16 v[36:39], v[60:63], v[88:91], v[36:39]
  v_mfma_f32_16x16x32_bf16 v[40:43], v[60:63], v[92:95], v[40:43]
  ds_read_b128 v[128:131], v12 offset:2176
  v_mfma_f32_16x16x32_bf16 v[44:47], v[60:63], v[96:99], v[44:47]
  v_mfma_f32_16x16x32_bf16 v[32:35], v[64:67], v[80:83], v[32:35]
  ds_read_b128 v[132:135], v12 offset:2688
  v_mfma_f32_16x16x32_bf16 v[36:39], v[64:67], v[84:87], v[36:39]
  v_mfma_f32_16x16x32_bf16 v[40:43], v[64:67], v[88:91], v[40:43]
  ds_read_b128 v[136:139], v12 offset:3200
  v_mfma_f32_16x16x32_bf16 v[44:47], v[64:67], v[92:95], v[44:47]
  v_mfma_f32_16x16x32_bf16 v[36:39], v[68:71], v[80:83], v[36:39]
  ds_read_b128 v[140:143], v12 offset:3712
  v_mfma_f32_16x16x32_bf16 v[40:43], v[68:71], v[84:87], v[40:43]
  v_mfma_f32_16x16x32_bf16 v[44:47], v[68:71], v[88:91], v[44:47]
  v_mfma_f32_16x16x32_bf16 v[40:43], v[72:75], v[80:83], v[40:43]
  v_mfma_f32_16x16x32_bf16 v[44:47], v[72:75], v[84:87], v[44:47]
  v_mfma_f32_16x16x32_bf16 v[44:47], v[76:79], v[80:83], v[44:47]
  s_waitcnt lgkmcnt(0)
  v_mfma_f32_16x16x32_bf16 v[16:19], v[112:115], v[144:147], v[16:19]
  ds_read_b128 v[48:51], v12 offset:192
  v_mfma_f32_16x16x32_bf16 v[20:23], v[112:115], v[148:151], v[20:23]
  v_mfma_f32_16x16x32_bf16 v[24:27], v[112:115], v[152:155], v[24:27]
  ds_read_b128 v[80:83], v13 offset:0
  v_mfma_f32_16x16x32_bf16 v[28:31], v[112:115], v[156:159], v[28:31]
  v_mfma_f32_16x16x32_bf16 v[32:35], v[112:115], v[160:163], v[32:35]
  ds_read_b128 v[84:87], v13 offset:512
  v_mfma_f32_16x16x32_bf16 v[36:39], v[112:115], v[164:167], v[36:39]
  v_mfma_f32_16x16x32_bf16 v[40:43], v[112:115], v[168:171], v[40:43]
  ds_read_b128 v[88:91], v13 offset:1024
  v_mfma_f32_16x16x32_bf16 v[44:47], v[112:115], v[172:175], v[44:47]
  v_mfma_f32_16x16x32_bf16 v[20:23], v[116:119], v[144:147], v[20:23]
  ds_read_b128 v[92:95], v13 offset:1536
  v_mfma_f32_16x16x32_bf16 v[24:27], v[116:119], v[148:151], v[24:27]
  v_mfma_f32_16x16x32_bf16 v[28:31], v[116:119], v[152:155], v[28:31]
  ds_read_b128 v[96:99], v13 offset:2048
  v_mfma_f32_16x16x32_bf16 v[32:35], v[116:119], v[156:159], v[32:35]
  v_mfma_f32_16x16x32_bf16 v[36:39], v[116:119], v[160:163], v[36:39]
  ds_read_b128 v[100:103], v13 offset:2560
  v_mfma_f32_16x16x32_bf16 v[40:43], v[116:119], v[164:167], v[40:43]
  v_mfma_f32_16x16x32_bf16 v[44:47], v[116:119], v[168:171], v[44:47]
  ds_read_b128 v[104:107], v13 offset:3072
  v_mfma_f32_16x16x32_bf16 v[24:27], v[120:123], v[144:147], v[24:27]
  v_mfma_f32_16x16x32_bf16 v[28:31], v[120:123], v[148:151], v[28:31]
  ds_read_b128 v[108:111], v13 offset:3584
  v_mfma_f32_16x16x32_bf16 v[32:35], v[120:123], v[152:155], v[32:35]
  v_mfma_f32_16x16x32_bf16 v[36:39], v[120:123], v[156:159], v[36:39]
  ds_read_b128 v[52:55], v12 offset:704
  v_mfma_f32_16x16x32_bf16 v[40:43], v[120:123], v[160:163], v[40:43]
  v_mfma_f32_16x16x32_bf16 v[44:47], v[120:123], v[164:167], v[44:47]
  ds_read_b128 v[56:59], v12 offset:1216
  v_mfma_f32_16x16x32_bf16 v[28:31], v[124:127], v[144:147], v[28:31]
  v_mfma_f32_16x16x32_bf16 v[32:35], v[124:127], v[148:151], v[32:35]
  ds_read_b128 v[60:63], v12 offset:1728
  v_mfma_f32_16x16x32_bf16 v[36:39], v[124:127], v[152:155], v[36:39]
  v_mfma_f32_16x16x32_bf16 v[40:43], v[124:127], v[156:159], v[40:43]
  ds_read_b128 v[64:67], v12 offset:2240
  v_mfma_f32_16x16x32_bf16 v[44:47], v[124:127], v[160:163], v[44:47]
  v_mfma_f32_16x16x32_bf16 v[32:35], v[128:131], v[144:147], v[32:35]
  ds_read_b128 v[68:71], v12 offset:2752
  v_mfma_f32_16x16x32_bf16 v[36:39], v[128:131], v[148:151], v[36:39]
  v_mfma_f32_16x16x32_bf16 v[40:43], v[128:131], v[152:155], v[40:43]
  ds_read_b128 v[72:75], v12 offset:3264
  v_mfma_f32_16x16x32_bf16 v[44:47], v[128:131], v[156:159], v[44:47]
  v_mfma_f32_16x16x32_bf16 v[36:39], v[132:135], v[144:147], v[36:39]
  ds_read_b128 v[76:79], v12 offset:3776
  v_mfma_f32_16x16x32_bf16 v[40:43], v[132:135], v[148:151], v[40:43]
  v_mfma_f32_16x16x32_bf16 v[44:47], v[132:135], v[152:155], v[44:47]
  v_mfma_f32_16x16x32_bf16 v[40:43], v[136:139], v[144:147], v[40:43]
  v_mfma_f32_16x16x32_bf16 v[44:47], v[136:139], v[148:151], v[44:47]
  v_mfma_f32_16x16x32_bf16 v[44:47], v[140:143], v[144:147], v[44:47]
  s_waitcnt lgkmcnt(0)
  v_mfma_f32_16x16x32_bf16 v[16:19], v[48:51], v[80:83], v[16:19]
  v_mfma_f32_16x16x32_bf16 v[20:23], v[48:51], v[84:87], v[20:23]
  v_mfma_f32_16x16x32_bf16 v[24:27], v[48:51], v[88:91], v[24:27]
  v_mfma_f32_16x16x32_bf16 v[28:31], v[48:51], v[92:95], v[28:31]
  v_mfma_f32_16x16x32_bf16 v[32:35], v[48:51], v[96:99], v[32:35]
  v_mfma_f32_16x16x32_bf16 v[36:39], v[48:51], v[100:103], v[36:39]
  v_mfma_f32_16x16x32_bf16 v[40:43], v[48:51], v[104:107], v[40:43]
  v_mfma_f32_16x16x32_bf16 v[44:47], v[48:51], v[108:111], v[44:47]
  v_mfma_f32_16x16x32_bf16 v[20:23], v[52:55], v[80:83], v[20:23]
  v_mfma_f32_16x16x32_bf16 v[24:27], v[52:55], v[84:87], v[24:27]
  v_mfma_f32_16x16x32_bf16 v[28:31], v[52:55], v[88:91], v[28:31]
  v_mfma_f32_16x16x32_bf16 v[32:35], v[52:55], v[92:95], v[32:35]
  v_mfma_f32_16x16x32_bf16 v[36:39], v[52:55], v[96:99], v[36:39]
  v_mfma_f32_16x16x32_bf16 v[40:43], v[52:55], v[100:103], v[40:43]
  v_mfma_f32_16x16x32_bf16 v[44:47], v[52:55], v[104:107], v[44:47]
  v_mfma_f32_16x16x32_bf16 v[24:27], v[56:59], v[80:83], v[24:27]
  v_mfma_f32_16x16x32_bf16 v[28:31], v[56:59], v[84:87], v[28:31]
  v_mfma_f32_16x16x32_bf16 v[32:35], v[56:59], v[88:91], v[32:35]
  v_mfma_f32_16x16x32_bf16 v[36:39], v[56:59], v[92:95], v[36:39]
  v_mfma_f32_16x16x32_bf16 v[40:43], v[56:59], v[96:99], v[40:43]
  v_mfma_f32_16x16x32_bf16 v[44:47], v[56:59], v[100:103], v[44:47]
  v_mfma_f32_16x16x32_bf16 v[28:31], v[60:63], v[80:83], v[28:31]
  v_mfma_f32_16x16x32_bf16 v[32:35], v[60:63], v[84:87], v[32:35]
  v_mfma_f32_16x16x32_bf16 v[36:39], v[60:63], v[88:91], v[36:39]
  v_mfma_f32_16x16x32_bf16 v[40:43], v[60:63], v[92:95], v[40:43]
  v_mfma_f32_16x16x32_bf16 v[44:47], v[60:63], v[96:99], v[44:47]
  v_mfma_f32_16x16x32_bf16 v[32:35], v[64:67], v[80:83], v[32:35]
  v_mfma_f32_16x16x32_bf16 v[36:39], v[64:67], v[84:87], v[36:39]
  v_mfma_f32_16x16x32_bf16 v[40:43], v[64:67], v[88:91], v[40:43]
  v_mfma_f32_16x16x32_bf16 v[44:47], v[64:67], v[92:95], v[44:47]
  v_mfma_f32_16x16x32_bf16 v[36:39], v[68:71], v[80:83], v[36:39]
  v_mfma_f32_16x16x32_bf16 v[40:43], v[68:71], v[84:87], v[40:43]
  v_mfma_f32_16x16x32_bf16 v[44:47], v[68:71], v[88:91], v[44:47]
  v_mfma_f32_16x16x32_bf16 v[40:43], v[72:75], v[80:83], v[40:43]
  v_mfma_f32_16x16x32_bf16 v[44:47], v[72:75], v[84:87], v[44:47]
  v_mfma_f32_16x16x32_bf16 v[44:47], v[76:79], v[80:83], v[44:47]
  s_mov_b32 s13, 2048
  s_cmp_eq_u32 s16, 0
  s_cbranch_scc0 FI_19
  v_lshlrev_b32 v104, 4, v0
  buffer_load_dwordx4 v[100:103], v104, s[56:59], s13 offen sc1
FI_19:
  v_lshlrev_b32 v4, 4, v2
  s_lshl_b32 s14, s16, 12
  s_add_u32 s14, s14, 78848
  v_add_u32 v5, s14, v4
  s_xor_b32 s15, s16, 1
  s_lshl_b32 s15, s15, 12
  s_add_u32 s15, s15, 78848
  v_add_u32 v6, s15, v4
  s_nop 7
  s_cmp_eq_u32 s19, 0
  s_cbranch_scc0 P1_H1_20
  ds_write_b128 v5, v[32:35] offset:0
  ds_write_b128 v5, v[36:39] offset:1024
  ds_write_b128 v5, v[40:43] offset:2048
  ds_write_b128 v5, v[44:47] offset:3072
  s_branch P1_J_21
P1_H1_20:
  ds_write_b128 v5, v[16:19] offset:0
  ds_write_b128 v5, v[20:23] offset:1024
  ds_write_b128 v5, v[24:27] offset:2048
  ds_write_b128 v5, v[28:31] offset:3072
  v_mov_b32 v16, v32
  v_mov_b32 v17, v33
  v_mov_b32 v18, v34
  v_mov_b32 v19, v35
  v_mov_b32 v20, v36
  v_mov_b32 v21, v37
  v_mov_b32 v22, v38
  v_mov_b32 v23, v39
  v_mov_b32 v24, v40
  v_mov_b32 v25, v41
  v_mov_b32 v26, v42
  v_mov_b32 v27, v43
  v_mov_b32 v28, v44
  v_mov_b32 v29, v45
  v_mov_b32 v30, v46
  v_mov_b32 v31, v47
P1_J_21:
  v_bfe_u32 v7, v2, 2, 2
  v_lshlrev_b32 v7, 16, v7
  v_and_b32 v8, 3, v2
  v_lshl_add_u32 v7, v8, 5, v7
  v_lshrrev_b32 v8, 4, v2
  v_lshl_add_u32 v7, v8, 3, v7
  s_lshl_b32 s14, s2, 8
  s_lshl_b32 s15, s18, 7
  s_add_u32 s14, s14, s15
  s_lshl_b32 s15, s19, 20
  s_add_u32 s14, s14, s15
  s_waitcnt lgkmcnt(0)
  s_barrier
  ds_read_b128 v[64:67], v6 offset:0
  ds_read_b128 v[68:71], v6 offset:1024
  ds_read_b128 v[72:75], v6 offset:2048
  ds_read_b128 v[76:79], v6 offset:3072
  s_waitcnt lgkmcnt(3)
  v_add_f32 v16, v16, v64
  v_add_f32 v17, v17, v65
  v_add_f32 v18, v18, v66
  v_add_f32 v19, v19, v67
  v_cvt_pk_bf16_f32 v80, v16, v17
  v_cvt_pk_bf16_f32 v81, v18, v19
  buffer_store_dwordx2 v[80:81], v7, s[32:35], s14 offen sc1
  s_add_u32 s14, s14, 0x40000
  s_waitcnt lgkmcnt(2)
  v_add_f32 v20, v20, v68
  v_add_f32 v21, v21, v69
  v_add_f32 v22, v22, v70
  v_add_f32 v23, v23, v71
  v_cvt_pk_bf16_f32 v82, v20, v21
  v_cvt_pk_bf16_f32 v83, v22, v23
  buffer_store_dwordx2 v[82:83], v7, s[32:35], s14 offen sc1
  s_add_u32 s14, s14, 0x40000
  s_waitcnt lgkmcnt(1)
  v_add_f32 v24, v24, v72
  v_add_f32 v25, v25, v73
  v_add_f32 v26, v26, v74
  v_add_f32 v27, v27, v75
  v_cvt_pk_bf16_f32 v84, v24, v25
  v_cvt_pk_bf16_f32 v85, v26, v27
  buffer_store_dwordx2 v[84:85], v7, s[32:35], s14 offen sc1
  s_add_u32 s14, s14, 0x40000
  s_waitcnt lgkmcnt(0)
  v_add_f32 v28, v28, v76
  v_add_f32 v29, v29, v77
  v_add_f32 v30, v30, v78
  v_add_f32 v31, v31, v79
  v_cvt_pk_bf16_f32 v86, v28, v29
  v_cvt_pk_bf16_f32 v87, v30, v31
  buffer_store_dwordx2 v[86:87], v7, s[32:35], s14 offen sc1
  s_lshl_b32 s12, s2, 2
  s_add_u32 s12, s12, 1024
  s_waitcnt vmcnt(0) lgkmcnt(0)
  s_cmp_eq_u32 s16, 0
  s_cbranch_scc0 FC_23
  v_xor_b32 v100, s54, v100
  v_xor_b32 v101, s54, v101
  v_xor_b32 v102, s54, v102
  v_xor_b32 v103, s54, v103
  v_or_b32 v100, v100, v101
  v_or3_b32 v100, v100, v102, v103
  v_cmp_ne_u32 vcc, 0, v100
  s_nop 1
  s_cmp_eq_u64 vcc, 0
  s_cbranch_scc1 FC_23
  s_cmp_eq_u32 s16, 0
  s_cbranch_scc0 WFS_26
  s_mov_b32 s55, 0x4000
  v_lshlrev_b32 v104, 4, v0
  buffer_load_dwordx4 v[100:103], v104, s[56:59], s13 offen sc1
WF_24:
  s_waitcnt vmcnt(0)
  v_xor_b32 v100, s54, v100
  v_xor_b32 v101, s54, v101
  v_xor_b32 v102, s54, v102
  v_xor_b32 v103, s54, v103
  v_or_b32 v100, v100, v101
  v_or3_b32 v100, v100, v102, v103
  v_cmp_ne_u32 vcc, 0, v100
  s_nop 1
  s_cmp_eq_u64 vcc, 0
  s_cbranch_scc1 WFD_25
  buffer_load_dwordx4 v[100:103], v104, s[56:59], s13 offen sc1
  s_sub_u32 s55, s55, 1
  s_cmp_eq_u32 s55, 0
  s_cbranch_scc0 WF_24
WFD_25:
WFS_26:
FC_23:
  s_barrier
  s_cmp_eq_u32 s16, 0
  s_cbranch_scc0 SIG_22
  v_mov_b32 v1, s54
  v_mov_b32 v2, 0
  buffer_store_dword v1, v2, s[56:59], s12 offen sc1
SIG_22:
  s_cmp_ge_u32 s2, 224
  s_cbranch_scc1 SKIP_G1_27
  s_load_dwordx2 s[8:9], s[0:1], 96
  s_load_dwordx2 s[6:7], s[0:1], 64
  s_load_dwordx2 s[4:5], s[0:1], 0
  v_lshrrev_b32 v1, 6, v0
  v_and_b32 v2, 63, v0
  s_and_b32 s17, s2, 7
  v_readfirstlane_b32 s16, v1
  s_lshr_b32 s18, s2, 3
  s_mul_i32 s19, s18, 9363
  s_lshr_b32 s19, s19, 16
  s_mul_i32 s12, s19, 7
  s_sub_u32 s18, s18, s12
  s_lshl_b32 s17, s17, 2
  s_add_u32 s17, s17, s19
  s_lshl_b32 s19, s18, 2
  s_add_u32 s19, s19, s16
  s_waitcnt lgkmcnt(0)
  s_mov_b32 s20, s4
  s_mov_b32 s21, s5
  s_mov_b32 s22, 0x200000
  s_mov_b32 s23, 0x20000
  s_add_u32 s24, s8, 0x200000
  s_addc_u32 s25, s9, 0
  s_mov_b32 s26, 0x200000
  s_mov_b32 s27, 0x20000
  s_add_u32 s28, s8, 0x400000
  s_addc_u32 s29, s9, 0
  s_mov_b32 s30, 0x1c0000
  s_mov_b32 s31, 0x20000
  s_mov_b32 s32, s6
  s_mov_b32 s33, s7
  s_mov_b32 s34, 0xe00
  s_mov_b32 s35, 0x20000
  s_add_u32 s36, s8, 0x1000000
  s_addc_u32 s37, s9, 0
  s_mov_b32 s38, 0x200000
  s_mov_b32 s39, 0x20000
  s_add_u32 s40, s8, 0x800000
  s_addc_u32 s41, s9, 0
  s_mov_b32 s42, 0x700000
  s_mov_b32 s43, 0x20000
  v_lshlrev_b32 v6, 4, v2
  v_lshrrev_b32 v8, 3, v2
  v_lshlrev_b32 v8, 7, v8
  v_and_b32 v9, 7, v2
  v_bfe_u32 v10, v2, 4, 1
  v_lshlrev_b32 v10, 1, v10
  v_xor_b32 v9, v9, v10
  v_lshl_add_u32 v3, v9, 4, v8
  v_xor_b32 v4, 64, v3
  v_and_b32 v8, 15, v2
  v_lshrrev_b32 v9, 4, v2
  s_lshl_b32 s14, s17, 2
  s_add_u32 s14, s14, s16
  s_lshl_b32 s14, s14, 14
  s_lshl_b32 s15, s19, 16
  s_lshl_b32 s13, s16, 14
  s_add_u32 s13, s13, 65536
  s_mov_b32 m0, s13
  s_mov_b32 s12, s14
  v_xor_b32 v10, 0, v6
  buffer_load_dwordx4 v10, s[20:23], s12 offen lds
  s_add_u32 m0, m0, 1024
  s_add_u32 s12, s12, 1024
  v_xor_b32 v11, 16, v6
  buffer_load_dwordx4 v11, s[20:23], s12 offen lds
  s_add_u32 m0, m0, 1024
  s_add_u32 s12, s12, 1024
  v_xor_b32 v12, 32, v6
  buffer_load_dwordx4 v12, s[20:23], s12 offen lds
  s_add_u32 m0, m0, 1024
  s_add_u32 s12, s12, 1024
  v_xor_b32 v13, 48, v6
  buffer_load_dwordx4 v13, s[20:23], s12 offen lds
  s_add_u32 m0, m0, 1024
  s_add_u32 s12, s12, 1024
  v_xor_b32 v10, 64, v6
  buffer_load_dwordx4 v10, s[20:23], s12 offen lds
  s_add_u32 m0, m0, 1024
  s_add_u32 s12, s12, 1024
  v_xor_b32 v11, 80, v6
  buffer_load_dwordx4 v11, s[20:23], s12 offen lds
  s_add_u32 m0, m0, 1024
  s_add_u32 s12, s12, 1024
  v_xor_b32 v12, 96, v6
  buffer_load_dwordx4 v12, s[20:23], s12 offen lds
  s_add_u32 m0, m0, 1024
  s_add_u32 s12, s12, 1024
  v_xor_b32 v13, 112, v6
  buffer_load_dwordx4 v13, s[20:23], s12 offen lds
  s_add_u32 m0, m0, 1024
  s_add_u32 s12, s12, 1024
  v_xor_b32 v10, 128, v6
  buffer_load_dwordx4 v10, s[20:23], s12 offen lds
  s_add_u32 m0, m0, 1024
  s_add_u32 s12, s12, 1024
  v_xor_b32 v11, 144, v6
  buffer_load_dwordx4 v11, s[20:23], s12 offen lds
  s_add_u32 m0, m0, 1024
  s_add_u32 s12, s12, 1024
  v_xor_b32 v12, 160, v6
  buffer_load_dwordx4 v12, s[20:23], s12 offen lds
  s_add_u32 m0, m0, 1024
  s_add_u32 s12, s12, 1024
  v_xor_b32 v13, 176, v6
  buffer_load_dwordx4 v13, s[20:23], s12 offen lds
  s_add_u32 m0, m0, 1024
  s_add_u32 s12, s12, 1024
  v_xor_b32 v10, 192, v6
  buffer_load_dwordx4 v10, s[20:23], s12 offen lds
  s_add_u32 m0, m0, 1024
  s_add_u32 s12, s12, 1024
  v_xor_b32 v11, 208, v6
  buffer_load_dwordx4 v11, s[20:23], s12 offen lds
  s_add_u32 m0, m0, 1024
  s_add_u32 s12, s12, 1024
  v_xor_b32 v12, 224, v6
  buffer_load_dwordx4 v12, s[20:23], s12 offen lds
  s_add_u32 m0, m0, 1024
  s_add_u32 s12, s12, 1024
  v_xor_b32 v13, 240, v6
  buffer_load_dwordx4 v13, s[20:23], s12 offen lds
G1_Q_28:
  s_lshl_b32 s12, s19, 7
  v_lshlrev_b32 v11, 5, v9
  v_add_u32 v11, s12, v11
  buffer_load_dwordx4 v[208:211], v11, s[32:35], 0 offen
  buffer_load_dwordx4 v[212:215], v11, s[32:35], 0 offen offset:16
  s_cmp_eq_u32 s16, 0
  s_cbranch_scc1 G1_PW_29
  buffer_load_dwordx4 a[0:3], v6, s[28:31], s15 offen offset:0 sc1
  buffer_load_dwordx4 a[4:7], v6, s[28:31], s15 offen offset:1024 sc1
  buffer_load_dwordx4 a[8:11], v6, s[28:31], s15 offen offset:2048 sc1
  buffer_load_dwordx4 a[12:15], v6, s[28:31], s15 offen offset:3072 sc1
  s_add_u32 s15, s15, 4096
  buffer_load_dwordx4 a[16:19], v6, s[28:31], s15 offen offset:0 sc1
  buffer_load_dwordx4 a[20:23], v6, s[28:31], s15 offen offset:1024 sc1
  buffer_load_dwordx4 a[24:27], v6, s[28:31], s15 offen offset:2048 sc1
  buffer_load_dwordx4 a[28:31], v6, s[28:31], s15 offen offset:3072 sc1
  s_add_u32 s15, s15, 4096
  buffer_load_dwordx4 a[32:35], v6, s[28:31], s15 offen offset:0 sc1
  buffer_load_dwordx4 a[36:39], v6, s[28:31], s15 offen offset:1024 sc1
  buffer_load_dwordx4 a[40:43], v6, s[28:31], s15 offen offset:2048 sc1
  buffer_load_dwordx4 a[44:47], v6, s[28:31], s15 offen offset:3072 sc1
  s_add_u32 s15, s15, 4096
  buffer_load_dwordx4 a[48:51], v6, s[28:31], s15 offen offset:0 sc1
  buffer_load_dwordx4 a[52:55], v6, s[28:31], s15 offen offset:1024 sc1
  buffer_load_dwordx4 a[56:59], v6, s[28:31], s15 offen offset:2048 sc1
  buffer_load_dwordx4 a[60:63], v6, s[28:31], s15 offen offset:3072 sc1
  s_add_u32 s15, s15, 4096
G1_PW_29:
  v_and_b32 v10, 7, v2
  v_lshlrev_b32 v10, 2, v10
  s_mov_b32 s13, 1024
  s_cmp_eq_u32 s16, 0
  s_cbranch_scc0 WFS_32
  s_mov_b32 s55, 0x4000
  v_lshlrev_b32 v148, 4, v0
  buffer_load_dwordx4 v[144:147], v148, s[56:59], s13 offen sc1
WF_30:
  s_waitcnt vmcnt(0)
  v_xor_b32 v144, s54, v144
  v_xor_b32 v145, s54, v145
  v_xor_b32 v146, s54, v146
  v_xor_b32 v147, s54, v147
  v_or_b32 v144, v144, v145
  v_or3_b32 v144, v144, v146, v147
  v_cmp_ne_u32 vcc, 0, v144
  s_nop 1
  s_cmp_eq_u64 vcc, 0
  s_cbranch_scc1 WFD_31
  buffer_load_dwordx4 v[144:147], v148, s[56:59], s13 offen sc1
  s_sub_u32 s55, s55, 1
  s_cmp_eq_u32 s55, 0
  s_cbranch_scc0 WF_30
WFD_31:
WFS_32:
  s_barrier
  s_lshl_b32 s13, s16, 14
  s_lshl_b32 s12, s17, 16
  s_add_u32 s12, s12, s13
  s_mov_b32 m0, s13
  s_nop 0
  buffer_load_dwordx4 v3, s[24:27], s12 offen sc1 lds
  s_add_u32 m0, m0, 1024
  s_add_u32 s12, s12, 1024
  buffer_load_dwordx4 v4, s[24:27], s12 offen sc1 lds
  s_add_u32 m0, m0, 1024
  s_add_u32 s12, s12, 1024
  buffer_load_dwordx4 v3, s[24:27], s12 offen sc1 lds
  s_add_u32 m0, m0, 1024
  s_add_u32 s12, s12, 1024
  buffer_load_dwordx4 v4, s[24:27], s12 offen sc1 lds
  s_add_u32 m0, m0, 1024
  s_add_u32 s12, s12, 1024
  buffer_load_dwordx4 v3, s[24:27], s12 offen sc1 lds
  s_add_u32 m0, m0, 1024
  s_add_u32 s12, s12, 1024
  buffer_load_dwordx4 v4, s[24:27], s12 offen sc1 lds
  s_add_u32 m0, m0, 1024
  s_add_u32 s12, s12, 1024
  buffer_load_dwordx4 v3, s[24:27], s12 offen sc1 lds
  s_add_u32 m0, m0, 1024
  s_add_u32 s12, s12, 1024
  buffer_load_dwordx4 v4, s[24:27], s12 offen sc1 lds
  s_add_u32 m0, m0, 1024
  s_add_u32 s12, s12, 1024
  buffer_load_dwordx4 v3, s[24:27], s12 offen sc1 lds
  s_add_u32 m0, m0, 1024
  s_add_u32 s12, s12, 1024
  buffer_load_dwordx4 v4, s[24:27], s12 offen sc1 lds
  s_add_u32 m0, m0, 1024
  s_add_u32 s12, s12, 1024
  buffer_load_dwordx4 v3, s[24:27], s12 offen sc1 lds
  s_add_u32 m0, m0, 1024
  s_add_u32 s12, s12, 1024
  buffer_load_dwordx4 v4, s[24:27], s12 offen sc1 lds
  s_add_u32 m0, m0, 1024
  s_add_u32 s12, s12, 1024
  buffer_load_dwordx4 v3, s[24:27], s12 offen sc1 lds
  s_add_u32 m0, m0, 1024
  s_add_u32 s12, s12, 1024
  buffer_load_dwordx4 v4, s[24:27], s12 offen sc1 lds
  s_add_u32 m0, m0, 1024
  s_add_u32 s12, s12, 1024
  buffer_load_dwordx4 v3, s[24:27], s12 offen sc1 lds
  s_add_u32 m0, m0, 1024
  s_add_u32 s12, s12, 1024
  buffer_load_dwordx4 v4, s[24:27], s12 offen sc1 lds
  s_cmp_eq_u32 s16, 0
  s_cbranch_scc0 G1_PW_33
  buffer_load_dwordx4 a[0:3], v6, s[28:31], s15 offen offset:0 sc1
  buffer_load_dwordx4 a[4:7], v6, s[28:31], s15 offen offset:1024 sc1
  buffer_load_dwordx4 a[8:11], v6, s[28:31], s15 offen offset:2048 sc1
  buffer_load_dwordx4 a[12:15], v6, s[28:31], s15 offen offset:3072 sc1
  s_add_u32 s15, s15, 4096
  buffer_load_dwordx4 a[16:19], v6, s[28:31], s15 offen offset:0 sc1
  buffer_load_dwordx4 a[20:23], v6, s[28:31], s15 offen offset:1024 sc1
  buffer_load_dwordx4 a[24:27], v6, s[28:31], s15 offen offset:2048 sc1
  buffer_load_dwordx4 a[28:31], v6, s[28:31], s15 offen offset:3072 sc1
  s_add_u32 s15, s15, 4096
  buffer_load_dwordx4 a[32:35], v6, s[28:31], s15 offen offset:0 sc1
  buffer_load_dwordx4 a[36:39], v6, s[28:31], s15 offen offset:1024 sc1
  buffer_load_dwordx4 a[40:43], v6, s[28:31], s15 offen offset:2048 sc1
  buffer_load_dwordx4 a[44:47], v6, s[28:31], s15 offen offset:3072 sc1
  s_add_u32 s15, s15, 4096
  buffer_load_dwordx4 a[48:51], v6, s[28:31], s15 offen offset:0 sc1
  buffer_load_dwordx4 a[52:55], v6, s[28:31], s15 offen offset:1024 sc1
  buffer_load_dwordx4 a[56:59], v6, s[28:31], s15 offen offset:2048 sc1
  buffer_load_dwordx4 a[60:63], v6, s[28:31], s15 offen offset:3072 sc1
  s_add_u32 s15, s15, 4096
G1_PW_33:
  v_lshlrev_b32 v10, 2, v9
  v_sub_u32 v10, v8, v10
  v_cmp_eq_u32 vcc, 0, v10
  v_mov_b32 v244, 0x3f803f80
  v_mov_b32 v248, 0
  v_cndmask_b32 v240, 0, 1.0, vcc
  v_cmp_eq_u32 vcc, 1, v10
  v_mov_b32 v245, 0x3f803f80
  v_mov_b32 v249, 0
  v_cndmask_b32 v241, 0, 1.0, vcc
  v_cmp_eq_u32 vcc, 2, v10
  v_mov_b32 v246, 0x3f803f80
  v_mov_b32 v250, 0
  v_cndmask_b32 v242, 0, 1.0, vcc
  v_cmp_eq_u32 vcc, 3, v10
  v_mov_b32 v247, 0x3f803f80
  v_mov_b32 v251, 0
  v_cndmask_b32 v243, 0, 1.0, vcc
  v_lshrrev_b32 v10, 2, v8
  v_and_b32 v11, 3, v2
  v_lshl_add_u32 v12, v9, 3, v10
  v_lshlrev_b32 v12, 7, v12
  v_lshrrev_b32 v13, 1, v11
  s_lshl_b32 s12, s16, 1
  v_add_u32 v13, s12, v13
  v_and_b32 v10, 2, v10
  v_xor_b32 v13, v13, v10
  v_and_b32 v10, 1, v9
  v_lshlrev_b32 v10, 2, v10
  v_xor_b32 v13, v13, v10
  v_lshl_add_u32 v12, v13, 4, v12
  v_and_b32 v11, 1, v11
  v_lshl_add_u32 v7, v11, 3, v12
  v_mov_b32 v14, 1.0
  v_mov_b32 v232, 0
  v_mov_b32 v236, 0
  v_mov_b32 v233, 0
  v_mov_b32 v237, 0
  v_mov_b32 v234, 0
  v_mov_b32 v238, 0
  v_mov_b32 v235, 0
  v_mov_b32 v239, 0
  s_lshl_b32 s12, s16, 14
  s_add_u32 s12, s12, 65536
  v_lshlrev_b32 v10, 10, v8
  v_add_u32 v10, s12, v10
  v_lshlrev_b32 v11, 4, v8
  v_lshlrev_b32 v12, 4, v9
  v_add_u32 v13, 0, v12
  v_xor_b32 v13, v13, v11
  v_add_u32 v216, v10, v13
  v_add_u32 v13, 64, v12
  v_xor_b32 v13, v13, v11
  v_add_u32 v217, v10, v13
  v_add_u32 v13, 128, v12
  v_xor_b32 v13, v13, v11
  v_add_u32 v218, v10, v13
  v_add_u32 v13, 192, v12
  v_xor_b32 v13, v13, v11
  v_add_u32 v219, v10, v13
  s_waitcnt vmcnt(32)
  ds_read_b128 v[16:19], v216 offset:0
  ds_read_b128 v[24:27], v217 offset:0
  ds_read_b128 v[32:35], v218 offset:0
  ds_read_b128 v[40:43], v219 offset:0
  ds_read_b128 v[48:51], v216 offset:256
  ds_read_b128 v[56:59], v217 offset:256
  ds_read_b128 v[64:67], v218 offset:256
  ds_read_b128 v[72:75], v219 offset:256
  ds_read_b128 v[80:83], v216 offset:512
  ds_read_b128 v[88:91], v217 offset:512
  ds_read_b128 v[96:99], v218 offset:512
  ds_read_b128 v[104:107], v219 offset:512
  ds_read_b128 v[112:115], v216 offset:768
  ds_read_b128 v[120:123], v217 offset:768
  ds_read_b128 v[128:131], v218 offset:768
  ds_read_b128 v[136:139], v219 offset:768
  s_waitcnt lgkmcnt(15)
  v_mfma_f32_16x16x32_bf16 v[232:235], v[244:247], v[16:19], v[232:235]
  v_mfma_f32_16x16x32_bf16 v[236:239], v[16:19], v[16:19], v[236:239]
  s_waitcnt lgkmcnt(14)
  v_mfma_f32_16x16x32_bf16 v[232:235], v[244:247], v[24:27], v[232:235]
  v_mfma_f32_16x16x32_bf16 v[236:239], v[24:27], v[24:27], v[236:239]
  s_waitcnt lgkmcnt(13)
  v_mfma_f32_16x16x32_bf16 v[232:235], v[244:247], v[32:35], v[232:235]
  v_mfma_f32_16x16x32_bf16 v[236:239], v[32:35], v[32:35], v[236:239]
  s_waitcnt lgkmcnt(12)
  v_mfma_f32_16x16x32_bf16 v[232:235], v[244:247], v[40:43], v[232:235]
  v_mfma_f32_16x16x32_bf16 v[236:239], v[40:43], v[40:43], v[236:239]
  s_waitcnt lgkmcnt(11)
  v_mfma_f32_16x16x32_bf16 v[232:235], v[244:247], v[48:51], v[232:235]
  v_mfma_f32_16x16x32_bf16 v[236:239], v[48:51], v[48:51], v[236:239]
  s_waitcnt lgkmcnt(10)
  v_mfma_f32_16x16x32_bf16 v[232:235], v[244:247], v[56:59], v[232:235]
  v_mfma_f32_16x16x32_bf16 v[236:239], v[56:59], v[56:59], v[236:239]
  s_waitcnt lgkmcnt(9)
  v_mfma_f32_16x16x32_bf16 v[232:235], v[244:247], v[64:67], v[232:235]
  v_mfma_f32_16x16x32_bf16 v[236:239], v[64:67], v[64:67], v[236:239]
  s_waitcnt lgkmcnt(8)
  v_mfma_f32_16x16x32_bf16 v[232:235], v[244:247], v[72:75], v[232:235]
  v_mfma_f32_16x16x32_bf16 v[236:239], v[72:75], v[72:75], v[236:239]
  s_waitcnt lgkmcnt(7)
  v_mfma_f32_16x16x32_bf16 v[232:235], v[244:247], v[80:83], v[232:235]
  v_mfma_f32_16x16x32_bf16 v[236:239], v[80:83], v[80:83], v[236:239]
  s_waitcnt lgkmcnt(6)
  v_mfma_f32_16x16x32_bf16 v[232:235], v[244:247], v[88:91], v[232:235]
  v_mfma_f32_16x16x32_bf16 v[236:239], v[88:91], v[88:91], v[236:239]
  s_waitcnt lgkmcnt(5)
  v_mfma_f32_16x16x32_bf16 v[232:235], v[244:247], v[96:99], v[232:235]
  v_mfma_f32_16x16x32_bf16 v[236:239], v[96:99], v[96:99], v[236:239]
  s_waitcnt lgkmcnt(4)
  v_mfma_f32_16x16x32_bf16 v[232:235], v[244:247], v[104:107], v[232:235]
  v_mfma_f32_16x16x32_bf16 v[236:239], v[104:107], v[104:107], v[236:239]
  s_waitcnt lgkmcnt(3)
  v_mfma_f32_16x16x32_bf16 v[232:235], v[244:247], v[112:115], v[232:235]
  v_mfma_f32_16x16x32_bf16 v[236:239], v[112:115], v[112:115], v[236:239]
  s_waitcnt lgkmcnt(2)
  v_mfma_f32_16x16x32_bf16 v[232:235], v[244:247], v[120:123], v[232:235]
  v_mfma_f32_16x16x32_bf16 v[236:239], v[120:123], v[120:123], v[236:239]
  s_waitcnt lgkmcnt(1)
  v_mfma_f32_16x16x32_bf16 v[232:235], v[244:247], v[128:131], v[232:235]
  v_mfma_f32_16x16x32_bf16 v[236:239], v[128:131], v[128:131], v[236:239]
  s_waitcnt lgkmcnt(0)
  v_mfma_f32_16x16x32_bf16 v[232:235], v[244:247], v[136:139], v[232:235]
  v_mfma_f32_16x16x32_bf16 v[236:239], v[136:139], v[136:139], v[236:239]
  s_cmp_eq_u32 s16, 0
  s_cbranch_scc1 G1_WA_34
  s_waitcnt vmcnt(0)
  s_branch G1_WB_35
G1_WA_34:
  s_waitcnt vmcnt(16)
G1_WB_35:
  s_barrier
  ds_read_b64_tr_b16 v[20:21], v7 offset:0
  ds_read_b64_tr_b16 v[22:23], v7 offset:512
  ds_read_b64_tr_b16 v[28:29], v7 offset:4096
  ds_read_b64_tr_b16 v[30:31], v7 offset:4608
  ds_read_b64_tr_b16 v[36:37], v7 offset:8192
  ds_read_b64_tr_b16 v[38:39], v7 offset:8704
  ds_read_b64_tr_b16 v[44:45], v7 offset:12288
  ds_read_b64_tr_b16 v[46:47], v7 offset:12800
  ds_read_b64_tr_b16 v[52:53], v7 offset:16384
  ds_read_b64_tr_b16 v[54:55], v7 offset:16896
  ds_read_b64_tr_b16 v[60:61], v7 offset:20480
  ds_read_b64_tr_b16 v[62:63], v7 offset:20992
  ds_read_b64_tr_b16 v[68:69], v7 offset:24576
  ds_read_b64_tr_b16 v[70:71], v7 offset:25088
  s_nop 7
  v_mul_f32 v10, v236, v240
  v_fma_f32 v10, v237, v241, v10
  v_fma_f32 v10, v238, v242, v10
  v_fma_f32 v10, v239, v243, v10
  v_mul_f32 v11, 0.001953125, v232
  s_nop 0
  v_mfma_f32_16x16x4_f32 v[248:251], v14, v10, 0
  v_mul_f32 v12, v11, v11
  s_nop 7
  s_nop 3
  v_mul_f32 v13, 0.001953125, v248
  v_sub_f32 v13, v13, v12
  v_max_f32 v13, 0, v13
  v_add_f32 v13, 0x3727c5ac, v13
  v_rsq_f32 v252, v13
  s_nop 0
  v_mul_f32 v254, v11, v252
  v_mov_b32 v253, v252
  v_mul_f32 v254, -1.0, v254
  v_mov_b32 v255, v254
  v_mov_b32 v232, 0
  v_mov_b32 v236, 0
  v_mov_b32 v233, 0
  v_mov_b32 v237, 0
  v_mov_b32 v234, 0
  v_mov_b32 v238, 0
  v_mov_b32 v235, 0
  v_mov_b32 v239, 0
  v_mov_b32 v8, 0xffff0000
  s_waitcnt lgkmcnt(12)
  v_lshlrev_b32 v216, 16, v16
  v_and_b32 v217, v8, v16
  v_lshlrev_b32 v218, 16, v17
  v_and_b32 v219, v8, v17
  v_lshlrev_b32 v220, 16, v18
  v_and_b32 v221, v8, v18
  v_lshlrev_b32 v222, 16, v19
  v_and_b32 v223, v8, v19
  v_lshlrev_b32 v224, 16, v20
  v_and_b32 v225, v8, v20
  v_lshlrev_b32 v226, 16, v21
  v_and_b32 v227, v8, v21
  v_lshlrev_b32 v228, 16, v22
  v_and_b32 v229, v8, v22
  v_lshlrev_b32 v230, 16, v23
  v_and_b32 v231, v8, v23
  v_pk_fma_f32 v[16:17], v[216:217], v[252:253], v[254:255]
  v_pk_fma_f32 v[18:19], v[218:219], v[252:253], v[254:255]
  v_pk_fma_f32 v[20:21], v[220:221], v[252:253], v[254:255]
  v_pk_fma_f32 v[22:23], v[222:223], v[252:253], v[254:255]
  ds_read_b64_tr_b16 v[76:77], v7 offset:28672
  ds_read_b64_tr_b16 v[78:79], v7 offset:29184
  buffer_load_dwordx4 a[64:67], v6, s[28:31], s15 offen offset:0 sc1
  buffer_load_dwordx4 a[68:71], v6, s[28:31], s15 offen offset:1024 sc1
  v_pk_fma_f32 v[16:17], v[16:17], v[224:225], v[216:217]
  v_pk_fma_f32 v[18:19], v[18:19], v[226:227], v[218:219]
  v_pk_fma_f32 v[20:21], v[20:21], v[228:229], v[220:221]
  v_pk_fma_f32 v[22:23], v[22:23], v[230:231], v[222:223]
  v_cvt_pk_bf16_f32 v144, v16, v17
  v_cvt_pk_bf16_f32 v145, v18, v19
  v_cvt_pk_bf16_f32 v146, v20, v21
  v_cvt_pk_bf16_f32 v147, v22, v23
  s_waitcnt lgkmcnt(12)
  v_lshlrev_b32 v216, 16, v24
  v_and_b32 v217, v8, v24
  v_mfma_f32_16x16x32_bf16 v[232:235], v[244:247], v[144:147], v[232:235]
  v_lshlrev_b32 v218, 16, v25
  v_and_b32 v219, v8, v25
  v_lshlrev_b32 v220, 16, v26
  v_mfma_f32_16x16x32_bf16 v[236:239], v[144:147], v[144:147], v[236:239]
  v_and_b32 v221, v8, v26
  v_lshlrev_b32 v222, 16, v27
  v_and_b32 v223, v8, v27
  v_lshlrev_b32 v224, 16, v28
  v_and_b32 v225, v8, v28
  v_lshlrev_b32 v226, 16, v29
  v_and_b32 v227, v8, v29
  v_lshlrev_b32 v228, 16, v30
  v_and_b32 v229, v8, v30
  v_lshlrev_b32 v230, 16, v31
  v_and_b32 v231, v8, v31
  v_pk_fma_f32 v[24:25], v[216:217], v[252:253], v[254:255]
  v_pk_fma_f32 v[26:27], v[218:219], v[252:253], v[254:255]
  v_pk_fma_f32 v[28:29], v[220:221], v[252:253], v[254:255]
  v_pk_fma_f32 v[30:31], v[222:223], v[252:253], v[254:255]
  ds_read_b64_tr_b16 v[84:85], v7 offset:32768
  ds_read_b64_tr_b16 v[86:87], v7 offset:33280
  buffer_load_dwordx4 a[72:75], v6, s[28:31], s15 offen offset:2048 sc1
  buffer_load_dwordx4 a[76:79], v6, s[28:31], s15 offen offset:3072 sc1
  s_add_u32 s15, s15, 4096
  v_pk_fma_f32 v[24:25], v[24:25], v[224:225], v[216:217]
  v_pk_fma_f32 v[26:27], v[26:27], v[226:227], v[218:219]
  v_pk_fma_f32 v[28:29], v[28:29], v[228:229], v[220:221]
  v_pk_fma_f32 v[30:31], v[30:31], v[230:231], v[222:223]
  v_cvt_pk_bf16_f32 v148, v24, v25
  v_cvt_pk_bf16_f32 v149, v26, v27
  v_cvt_pk_bf16_f32 v150, v28, v29
  v_cvt_pk_bf16_f32 v151, v30, v31
  s_waitcnt lgkmcnt(12)
  v_lshlrev_b32 v216, 16, v32
  v_and_b32 v217, v8, v32
  v_mfma_f32_16x16x32_bf16 v[232:235], v[244:247], v[148:151], v[232:235]
  v_lshlrev_b32 v218, 16, v33
  v_and_b32 v219, v8, v33
  v_lshlrev_b32 v220, 16, v34
  v_mfma_f32_16x16x32_bf16 v[236:239], v[148:151], v[148:151], v[236:239]
  v_and_b32 v221, v8, v34
  v_lshlrev_b32 v222, 16, v35
  v_and_b32 v223, v8, v35
  v_lshlrev_b32 v224, 16, v36
  v_and_b32 v225, v8, v36
  v_lshlrev_b32 v226, 16, v37
  v_and_b32 v227, v8, v37
  v_lshlrev_b32 v228, 16, v38
  v_and_b32 v229, v8, v38
  v_lshlrev_b32 v230, 16, v39
  v_and_b32 v231, v8, v39
  v_pk_fma_f32 v[32:33], v[216:217], v[252:253], v[254:255]
  v_pk_fma_f32 v[34:35], v[218:219], v[252:253], v[254:255]
  v_pk_fma_f32 v[36:37], v[220:221], v[252:253], v[254:255]
  v_pk_fma_f32 v[38:39], v[222:223], v[252:253], v[254:255]
  ds_read_b64_tr_b16 v[92:93], v7 offset:36864
  ds_read_b64_tr_b16 v[94:95], v7 offset:37376
  buffer_load_dwordx4 a[80:83], v6, s[28:31], s15 offen offset:0 sc1
  buffer_load_dwordx4 a[84:87], v6, s[28:31], s15 offen offset:1024 sc1
  v_pk_fma_f32 v[32:33], v[32:33], v[224:225], v[216:217]
  v_pk_fma_f32 v[34:35], v[34:35], v[226:227], v[218:219]
  v_pk_fma_f32 v[36:37], v[36:37], v[228:229], v[220:221]
  v_pk_fma_f32 v[38:39], v[38:39], v[230:231], v[222:223]
  v_cvt_pk_bf16_f32 v152, v32, v33
  v_cvt_pk_bf16_f32 v153, v34, v35
  v_cvt_pk_bf16_f32 v154, v36, v37
  v_cvt_pk_bf16_f32 v155, v38, v39
  s_waitcnt lgkmcnt(12)
  v_lshlrev_b32 v216, 16, v40
  v_and_b32 v217, v8, v40
  v_mfma_f32_16x16x32_bf16 v[232:235], v[244:247], v[152:155], v[232:235]
  v_lshlrev_b32 v218, 16, v41
  v_and_b32 v219, v8, v41
  v_lshlrev_b32 v220, 16, v42
  v_mfma_f32_16x16x32_bf16 v[236:239], v[152:155], v[152:155], v[236:239]
  v_and_b32 v221, v8, v42
  v_lshlrev_b32 v222, 16, v43
  v_and_b32 v223, v8, v43
  v_lshlrev_b32 v224, 16, v44
  v_and_b32 v225, v8, v44
  v_lshlrev_b32 v226, 16, v45
  v_and_b32 v227, v8, v45
  v_lshlrev_b32 v228, 16, v46
  v_and_b32 v229, v8, v46
  v_lshlrev_b32 v230, 16, v47
  v_and_b32 v231, v8, v47
  v_pk_fma_f32 v[40:41], v[216:217], v[252:253], v[254:255]
  v_pk_fma_f32 v[42:43], v[218:219], v[252:253], v[254:255]
  v_pk_fma_f32 v[44:45], v[220:221], v[252:253], v[254:255]
  v_pk_fma_f32 v[46:47], v[222:223], v[252:253], v[254:255]
  ds_read_b64_tr_b16 v[100:101], v7 offset:40960
  ds_read_b64_tr_b16 v[102:103], v7 offset:41472
  buffer_load_dwordx4 a[88:91], v6, s[28:31], s15 offen offset:2048 sc1
  buffer_load_dwordx4 a[92:95], v6, s[28:31], s15 offen offset:3072 sc1
  s_add_u32 s15, s15, 4096
  v_pk_fma_f32 v[40:41], v[40:41], v[224:225], v[216:217]
  v_pk_fma_f32 v[42:43], v[42:43], v[226:227], v[218:219]
  v_pk_fma_f32 v[44:45], v[44:45], v[228:229], v[220:221]
  v_pk_fma_f32 v[46:47], v[46:47], v[230:231], v[222:223]
  v_cvt_pk_bf16_f32 v156, v40, v41
  v_cvt_pk_bf16_f32 v157, v42, v43
  v_cvt_pk_bf16_f32 v158, v44, v45
  v_cvt_pk_bf16_f32 v159, v46, v47
  s_waitcnt lgkmcnt(12)
  v_lshlrev_b32 v216, 16, v48
  v_and_b32 v217, v8, v48
  v_mfma_f32_16x16x32_bf16 v[232:235], v[244:247], v[156:159], v[232:235]
  v_lshlrev_b32 v218, 16, v49
  v_and_b32 v219, v8, v49
  v_lshlrev_b32 v220, 16, v50
  v_mfma_f32_16x16x32_bf16 v[236:239], v[156:159], v[156:159], v[236:239]
  v_and_b32 v221, v8, v50
  v_lshlrev_b32 v222, 16, v51
  v_and_b32 v223, v8, v51
  v_lshlrev_b32 v224, 16, v52
  v_and_b32 v225, v8, v52
  v_lshlrev_b32 v226, 16, v53
  v_and_b32 v227, v8, v53
  v_lshlrev_b32 v228, 16, v54
  v_and_b32 v229, v8, v54
  v_lshlrev_b32 v230, 16, v55
  v_and_b32 v231, v8, v55
  v_pk_fma_f32 v[48:49], v[216:217], v[252:253], v[254:255]
  v_pk_fma_f32 v[50:51], v[218:219], v[252:253], v[254:255]
  v_pk_fma_f32 v[52:53], v[220:221], v[252:253], v[254:255]
  v_pk_fma_f32 v[54:55], v[222:223], v[252:253], v[254:255]
  ds_read_b64_tr_b16 v[108:109], v7 offset:45056
  ds_read_b64_tr_b16 v[110:111], v7 offset:45568
  buffer_load_dwordx4 a[96:99], v6, s[28:31], s15 offen offset:0 sc1
  buffer_load_dwordx4 a[100:103], v6, s[28:31], s15 offen offset:1024 sc1
  v_pk_fma_f32 v[48:49], v[48:49], v[224:225], v[216:217]
  v_pk_fma_f32 v[50:51], v[50:51], v[226:227], v[218:219]
  v_pk_fma_f32 v[52:53], v[52:53], v[228:229], v[220:221]
  v_pk_fma_f32 v[54:55], v[54:55], v[230:231], v[222:223]
  v_cvt_pk_bf16_f32 v160, v48, v49
  v_cvt_pk_bf16_f32 v161, v50, v51
  v_cvt_pk_bf16_f32 v162, v52, v53
  v_cvt_pk_bf16_f32 v163, v54, v55
  s_waitcnt lgkmcnt(12)
  v_lshlrev_b32 v216, 16, v56
  v_and_b32 v217, v8, v56
  v_mfma_f32_16x16x32_bf16 v[232:235], v[244:247], v[160:163], v[232:235]
  v_lshlrev_b32 v218, 16, v57
  v_and_b32 v219, v8, v57
  v_lshlrev_b32 v220, 16, v58
  v_mfma_f32_16x16x32_bf16 v[236:239], v[160:163], v[160:163], v[236:239]
  v_and_b32 v221, v8, v58
  v_lshlrev_b32 v222, 16, v59
  v_and_b32 v223, v8, v59
  v_lshlrev_b32 v224, 16, v60
  v_and_b32 v225, v8, v60
  v_lshlrev_b32 v226, 16, v61
  v_and_b32 v227, v8, v61
  v_lshlrev_b32 v228, 16, v62
  v_and_b32 v229, v8, v62
  v_lshlrev_b32 v230, 16, v63
  v_and_b32 v231, v8, v63
  v_pk_fma_f32 v[56:57], v[216:217], v[252:253], v[254:255]
  v_pk_fma_f32 v[58:59], v[218:219], v[252:253], v[254:255]
  v_pk_fma_f32 v[60:61], v[220:221], v[252:253], v[254:255]
  v_pk_fma_f32 v[62:63], v[222:223], v[252:253], v[254:255]
  ds_read_b64_tr_b16 v[116:117], v7 offset:49152
  ds_read_b64_tr_b16 v[118:119], v7 offset:49664
  buffer_load_dwordx4 a[104:107], v6, s[28:31], s15 offen offset:2048 sc1
  buffer_load_dwordx4 a[108:111], v6, s[28:31], s15 offen offset:3072 sc1
  s_add_u32 s15, s15, 4096
  v_pk_fma_f32 v[56:57], v[56:57], v[224:225], v[216:217]
  v_pk_fma_f32 v[58:59], v[58:59], v[226:227], v[218:219]
  v_pk_fma_f32 v[60:61], v[60:61], v[228:229], v[220:221]
  v_pk_fma_f32 v[62:63], v[62:63], v[230:231], v[222:223]
  v_cvt_pk_bf16_f32 v164, v56, v57
  v_cvt_pk_bf16_f32 v165, v58, v59
  v_cvt_pk_bf16_f32 v166, v60, v61
  v_cvt_pk_bf16_f32 v167, v62, v63
  s_waitcnt lgkmcnt(12)
  v_lshlrev_b32 v216, 16, v64
  v_and_b32 v217, v8, v64
  v_mfma_f32_16x16x32_bf16 v[232:235], v[244:247], v[164:167], v[232:235]
  v_lshlrev_b32 v218, 16, v65
  v_and_b32 v219, v8, v65
  v_lshlrev_b32 v220, 16, v66
  v_mfma_f32_16x16x32_bf16 v[236:239], v[164:167], v[164:167], v[236:239]
  v_and_b32 v221, v8, v66
  v_lshlrev_b32 v222, 16, v67
  v_and_b32 v223, v8, v67
  v_lshlrev_b32 v224, 16, v68
  v_and_b32 v225, v8, v68
  v_lshlrev_b32 v226, 16, v69
  v_and_b32 v227, v8, v69
  v_lshlrev_b32 v228, 16, v70
  v_and_b32 v229, v8, v70
  v_lshlrev_b32 v230, 16, v71
  v_and_b32 v231, v8, v71
  v_pk_fma_f32 v[64:65], v[216:217], v[252:253], v[254:255]
  v_pk_fma_f32 v[66:67], v[218:219], v[252:253], v[254:255]
  v_pk_fma_f32 v[68:69], v[220:221], v[252:253], v[254:255]
  v_pk_fma_f32 v[70:71], v[222:223], v[252:253], v[254:255]
  ds_read_b64_tr_b16 v[124:125], v7 offset:53248
  ds_read_b64_tr_b16 v[126:127], v7 offset:53760
  buffer_load_dwordx4 a[112:115], v6, s[28:31], s15 offen offset:0 sc1
  buffer_load_dwordx4 a[116:119], v6, s[28:31], s15 offen offset:1024 sc1
  v_pk_fma_f32 v[64:65], v[64:65], v[224:225], v[216:217]
  v_pk_fma_f32 v[66:67], v[66:67], v[226:227], v[218:219]
  v_pk_fma_f32 v[68:69], v[68:69], v[228:229], v[220:221]
  v_pk_fma_f32 v[70:71], v[70:71], v[230:231], v[222:223]
  v_cvt_pk_bf16_f32 v168, v64, v65
  v_cvt_pk_bf16_f32 v169, v66, v67
  v_cvt_pk_bf16_f32 v170, v68, v69
  v_cvt_pk_bf16_f32 v171, v70, v71
  s_waitcnt lgkmcnt(12)
  v_lshlrev_b32 v216, 16, v72
  v_and_b32 v217, v8, v72
  v_mfma_f32_16x16x32_bf16 v[232:235], v[244:247], v[168:171], v[232:235]
  v_lshlrev_b32 v218, 16, v73
  v_and_b32 v219, v8, v73
  v_lshlrev_b32 v220, 16, v74
  v_mfma_f32_16x16x32_bf16 v[236:239], v[168:171], v[168:171], v[236:239]
  v_and_b32 v221, v8, v74
  v_lshlrev_b32 v222, 16, v75
  v_and_b32 v223, v8, v75
  v_lshlrev_b32 v224, 16, v76
  v_and_b32 v225, v8, v76
  v_lshlrev_b32 v226, 16, v77
  v_and_b32 v227, v8, v77
  v_lshlrev_b32 v228, 16, v78
  v_and_b32 v229, v8, v78
  v_lshlrev_b32 v230, 16, v79
  v_and_b32 v231, v8, v79
  v_pk_fma_f32 v[72:73], v[216:217], v[252:253], v[254:255]
  v_pk_fma_f32 v[74:75], v[218:219], v[252:253], v[254:255]
  v_pk_fma_f32 v[76:77], v[220:221], v[252:253], v[254:255]
  v_pk_fma_f32 v[78:79], v[222:223], v[252:253], v[254:255]
  ds_read_b64_tr_b16 v[132:133], v7 offset:57344
  ds_read_b64_tr_b16 v[134:135], v7 offset:57856
  buffer_load_dwordx4 a[120:123], v6, s[28:31], s15 offen offset:2048 sc1
  buffer_load_dwordx4 a[124:127], v6, s[28:31], s15 offen offset:3072 sc1
  s_add_u32 s15, s15, 4096
  v_pk_fma_f32 v[72:73], v[72:73], v[224:225], v[216:217]
  v_pk_fma_f32 v[74:75], v[74:75], v[226:227], v[218:219]
  v_pk_fma_f32 v[76:77], v[76:77], v[228:229], v[220:221]
  v_pk_fma_f32 v[78:79], v[78:79], v[230:231], v[222:223]
  v_cvt_pk_bf16_f32 v172, v72, v73
  v_cvt_pk_bf16_f32 v173, v74, v75
  v_cvt_pk_bf16_f32 v174, v76, v77
  v_cvt_pk_bf16_f32 v175, v78, v79
  s_waitcnt lgkmcnt(12)
  v_lshlrev_b32 v216, 16, v80
  v_and_b32 v217, v8, v80
  v_mfma_f32_16x16x32_bf16 v[232:235], v[244:247], v[172:175], v[232:235]
  v_lshlrev_b32 v218, 16, v81
  v_and_b32 v219, v8, v81
  v_lshlrev_b32 v220, 16, v82
  v_mfma_f32_16x16x32_bf16 v[236:239], v[172:175], v[172:175], v[236:239]
  v_and_b32 v221, v8, v82
  v_lshlrev_b32 v222, 16, v83
  v_and_b32 v223, v8, v83
  v_lshlrev_b32 v224, 16, v84
  v_and_b32 v225, v8, v84
  v_lshlrev_b32 v226, 16, v85
  v_and_b32 v227, v8, v85
  v_lshlrev_b32 v228, 16, v86
  v_and_b32 v229, v8, v86
  v_lshlrev_b32 v230, 16, v87
  v_and_b32 v231, v8, v87
  v_pk_fma_f32 v[80:81], v[216:217], v[252:253], v[254:255]
  v_pk_fma_f32 v[82:83], v[218:219], v[252:253], v[254:255]
  v_pk_fma_f32 v[84:85], v[220:221], v[252:253], v[254:255]
  v_pk_fma_f32 v[86:87], v[222:223], v[252:253], v[254:255]
  ds_read_b64_tr_b16 v[140:141], v7 offset:61440
  ds_read_b64_tr_b16 v[142:143], v7 offset:61952
  buffer_load_dwordx4 a[128:131], v6, s[28:31], s15 offen offset:0 sc1
  buffer_load_dwordx4 a[132:135], v6, s[28:31], s15 offen offset:1024 sc1
  v_pk_fma_f32 v[80:81], v[80:81], v[224:225], v[216:217]
  v_pk_fma_f32 v[82:83], v[82:83], v[226:227], v[218:219]
  v_pk_fma_f32 v[84:85], v[84:85], v[228:229], v[220:221]
  v_pk_fma_f32 v[86:87], v[86:87], v[230:231], v[222:223]
  v_cvt_pk_bf16_f32 v176, v80, v81
  v_cvt_pk_bf16_f32 v177, v82, v83
  v_cvt_pk_bf16_f32 v178, v84, v85
  v_cvt_pk_bf16_f32 v179, v86, v87
  s_waitcnt lgkmcnt(12)
  v_lshlrev_b32 v216, 16, v88
  v_and_b32 v217, v8, v88
  v_mfma_f32_16x16x32_bf16 v[232:235], v[244:247], v[176:179], v[232:235]
  v_lshlrev_b32 v218, 16, v89
  v_and_b32 v219, v8, v89
  v_lshlrev_b32 v220, 16, v90
  v_mfma_f32_16x16x32_bf16 v[236:239], v[176:179], v[176:179], v[236:239]
  v_and_b32 v221, v8, v90
  v_lshlrev_b32 v222, 16, v91
  v_and_b32 v223, v8, v91
  v_lshlrev_b32 v224, 16, v92
  v_and_b32 v225, v8, v92
  v_lshlrev_b32 v226, 16, v93
  v_and_b32 v227, v8, v93
  v_lshlrev_b32 v228, 16, v94
  v_and_b32 v229, v8, v94
  v_lshlrev_b32 v230, 16, v95
  v_and_b32 v231, v8, v95
  v_pk_fma_f32 v[88:89], v[216:217], v[252:253], v[254:255]
  v_pk_fma_f32 v[90:91], v[218:219], v[252:253], v[254:255]
  v_pk_fma_f32 v[92:93], v[220:221], v[252:253], v[254:255]
  v_pk_fma_f32 v[94:95], v[222:223], v[252:253], v[254:255]
  buffer_load_dwordx4 a[136:139], v6, s[28:31], s15 offen offset:2048 sc1
  buffer_load_dwordx4 a[140:143], v6, s[28:31], s15 offen offset:3072 sc1
  s_add_u32 s15, s15, 4096
  v_pk_fma_f32 v[88:89], v[88:89], v[224:225], v[216:217]
  v_pk_fma_f32 v[90:91], v[90:91], v[226:227], v[218:219]
  v_pk_fma_f32 v[92:93], v[92:93], v[228:229], v[220:221]
  v_pk_fma_f32 v[94:95], v[94:95], v[230:231], v[222:223]
  v_cvt_pk_bf16_f32 v180, v88, v89
  v_cvt_pk_bf16_f32 v181, v90, v91
  v_cvt_pk_bf16_f32 v182, v92, v93
  v_cvt_pk_bf16_f32 v183, v94, v95
  s_waitcnt lgkmcnt(10)
  v_lshlrev_b32 v216, 16, v96
  v_and_b32 v217, v8, v96
  v_mfma_f32_16x16x32_bf16 v[232:235], v[244:247], v[180:183], v[232:235]
  v_lshlrev_b32 v218, 16, v97
  v_and_b32 v219, v8, v97
  v_lshlrev_b32 v220, 16, v98
  v_mfma_f32_16x16x32_bf16 v[236:239], v[180:183], v[180:183], v[236:239]
  v_and_b32 v221, v8, v98
  v_lshlrev_b32 v222, 16, v99
  v_and_b32 v223, v8, v99
  v_lshlrev_b32 v224, 16, v100
  v_and_b32 v225, v8, v100
  v_lshlrev_b32 v226, 16, v101
  v_and_b32 v227, v8, v101
  v_lshlrev_b32 v228, 16, v102
  v_and_b32 v229, v8, v102
  v_lshlrev_b32 v230, 16, v103
  v_and_b32 v231, v8, v103
  v_pk_fma_f32 v[96:97], v[216:217], v[252:253], v[254:255]
  v_pk_fma_f32 v[98:99], v[218:219], v[252:253], v[254:255]
  v_pk_fma_f32 v[100:101], v[220:221], v[252:253], v[254:255]
  v_pk_fma_f32 v[102:103], v[222:223], v[252:253], v[254:255]
  buffer_load_dwordx4 a[144:147], v6, s[28:31], s15 offen offset:0 sc1
  buffer_load_dwordx4 a[148:151], v6, s[28:31], s15 offen offset:1024 sc1
  v_pk_fma_f32 v[96:97], v[96:97], v[224:225], v[216:217]
  v_pk_fma_f32 v[98:99], v[98:99], v[226:227], v[218:219]
  v_pk_fma_f32 v[100:101], v[100:101], v[228:229], v[220:221]
  v_pk_fma_f32 v[102:103], v[102:103], v[230:231], v[222:223]
  v_cvt_pk_bf16_f32 v184, v96, v97
  v_cvt_pk_bf16_f32 v185, v98, v99
  v_cvt_pk_bf16_f32 v186, v100, v101
  v_cvt_pk_bf16_f32 v187, v102, v103
  s_waitcnt lgkmcnt(8)
  v_lshlrev_b32 v216, 16, v104
  v_and_b32 v217, v8, v104
  v_mfma_f32_16x16x32_bf16 v[232:235], v[244:247], v[184:187], v[232:235]
  v_lshlrev_b32 v218, 16, v105
  v_and_b32 v219, v8, v105
  v_lshlrev_b32 v220, 16, v106
  v_mfma_f32_16x16x32_bf16 v[236:239], v[184:187], v[184:187], v[236:239]
  v_and_b32 v221, v8, v106
  v_lshlrev_b32 v222, 16, v107
  v_and_b32 v223, v8, v107
  v_lshlrev_b32 v224, 16, v108
  v_and_b32 v225, v8, v108
  v_lshlrev_b32 v226, 16, v109
  v_and_b32 v227, v8, v109
  v_lshlrev_b32 v228, 16, v110
  v_and_b32 v229, v8, v110
  v_lshlrev_b32 v230, 16, v111
  v_and_b32 v231, v8, v111
  v_pk_fma_f32 v[104:105], v[216:217], v[252:253], v[254:255]
  v_pk_fma_f32 v[106:107], v[218:219], v[252:253], v[254:255]
  v_pk_fma_f32 v[108:109], v[220:221], v[252:253], v[254:255]
  v_pk_fma_f32 v[110:111], v[222:223], v[252:253], v[254:255]
  buffer_load_dwordx4 a[152:155], v6, s[28:31], s15 offen offset:2048 sc1
  buffer_load_dwordx4 a[156:159], v6, s[28:31], s15 offen offset:3072 sc1
  s_add_u32 s15, s15, 4096
  v_pk_fma_f32 v[104:105], v[104:105], v[224:225], v[216:217]
  v_pk_fma_f32 v[106:107], v[106:107], v[226:227], v[218:219]
  v_pk_fma_f32 v[108:109], v[108:109], v[228:229], v[220:221]
  v_pk_fma_f32 v[110:111], v[110:111], v[230:231], v[222:223]
  v_cvt_pk_bf16_f32 v188, v104, v105
  v_cvt_pk_bf16_f32 v189, v106, v107
  v_cvt_pk_bf16_f32 v190, v108, v109
  v_cvt_pk_bf16_f32 v191, v110, v111
  s_waitcnt lgkmcnt(6)
  v_lshlrev_b32 v216, 16, v112
  v_and_b32 v217, v8, v112
  v_mfma_f32_16x16x32_bf16 v[232:235], v[244:247], v[188:191], v[232:235]
  v_lshlrev_b32 v218, 16, v113
  v_and_b32 v219, v8, v113
  v_lshlrev_b32 v220, 16, v114
  v_mfma_f32_16x16x32_bf16 v[236:239], v[188:191], v[188:191], v[236:239]
  v_and_b32 v221, v8, v114
  v_lshlrev_b32 v222, 16, v115
  v_and_b32 v223, v8, v115
  v_lshlrev_b32 v224, 16, v116
  v_and_b32 v225, v8, v116
  v_lshlrev_b32 v226, 16, v117
  v_and_b32 v227, v8, v117
  v_lshlrev_b32 v228, 16, v118
  v_and_b32 v229, v8, v118
  v_lshlrev_b32 v230, 16, v119
  v_and_b32 v231, v8, v119
  v_pk_fma_f32 v[112:113], v[216:217], v[252:253], v[254:255]
  v_pk_fma_f32 v[114:115], v[218:219], v[252:253], v[254:255]
  v_pk_fma_f32 v[116:117], v[220:221], v[252:253], v[254:255]
  v_pk_fma_f32 v[118:119], v[222:223], v[252:253], v[254:255]
  buffer_load_dwordx4 a[160:163], v6, s[28:31], s15 offen offset:0 sc1
  buffer_load_dwordx4 a[164:167], v6, s[28:31], s15 offen offset:1024 sc1
  v_pk_fma_f32 v[112:113], v[112:113], v[224:225], v[216:217]
  v_pk_fma_f32 v[114:115], v[114:115], v[226:227], v[218:219]
  v_pk_fma_f32 v[116:117], v[116:117], v[228:229], v[220:221]
  v_pk_fma_f32 v[118:119], v[118:119], v[230:231], v[222:223]
  v_cvt_pk_bf16_f32 v192, v112, v113
  v_cvt_pk_bf16_f32 v193, v114, v115
  v_cvt_pk_bf16_f32 v194, v116, v117
  v_cvt_pk_bf16_f32 v195, v118, v119
  s_waitcnt lgkmcnt(4)
  v_lshlrev_b32 v216, 16, v120
  v_and_b32 v217, v8, v120
  v_mfma_f32_16x16x32_bf16 v[232:235], v[244:247], v[192:195], v[232:235]
  v_lshlrev_b32 v218, 16, v121
  v_and_b32 v219, v8, v121
  v_lshlrev_b32 v220, 16, v122
  v_mfma_f32_16x16x32_bf16 v[236:239], v[192:195], v[192:195], v[236:239]
  v_and_b32 v221, v8, v122
  v_lshlrev_b32 v222, 16, v123
  v_and_b32 v223, v8, v123
  v_lshlrev_b32 v224, 16, v124
  v_and_b32 v225, v8, v124
  v_lshlrev_b32 v226, 16, v125
  v_and_b32 v227, v8, v125
  v_lshlrev_b32 v228, 16, v126
  v_and_b32 v229, v8, v126
  v_lshlrev_b32 v230, 16, v127
  v_and_b32 v231, v8, v127
  v_pk_fma_f32 v[120:121], v[216:217], v[252:253], v[254:255]
  v_pk_fma_f32 v[122:123], v[218:219], v[252:253], v[254:255]
  v_pk_fma_f32 v[124:125], v[220:221], v[252:253], v[254:255]
  v_pk_fma_f32 v[126:127], v[222:223], v[252:253], v[254:255]
  buffer_load_dwordx4 a[168:171], v6, s[28:31], s15 offen offset:2048 sc1
  buffer_load_dwordx4 a[172:175], v6, s[28:31], s15 offen offset:3072 sc1
  s_add_u32 s15, s15, 4096
  v_pk_fma_f32 v[120:121], v[120:121], v[224:225], v[216:217]
  v_pk_fma_f32 v[122:123], v[122:123], v[226:227], v[218:219]
  v_pk_fma_f32 v[124:125], v[124:125], v[228:229], v[220:221]
  v_pk_fma_f32 v[126:127], v[126:127], v[230:231], v[222:223]
  v_cvt_pk_bf16_f32 v196, v120, v121
  v_cvt_pk_bf16_f32 v197, v122, v123
  v_cvt_pk_bf16_f32 v198, v124, v125
  v_cvt_pk_bf16_f32 v199, v126, v127
  s_waitcnt lgkmcnt(2)
  v_lshlrev_b32 v216, 16, v128
  v_and_b32 v217, v8, v128
  v_mfma_f32_16x16x32_bf16 v[232:235], v[244:247], v[196:199], v[232:235]
  v_lshlrev_b32 v218, 16, v129
  v_and_b32 v219, v8, v129
  v_lshlrev_b32 v220, 16, v130
  v_mfma_f32_16x16x32_bf16 v[236:239], v[196:199], v[196:199], v[236:239]
  v_and_b32 v221, v8, v130
  v_lshlrev_b32 v222, 16, v131
  v_and_b32 v223, v8, v131
  v_lshlrev_b32 v224, 16, v132
  v_and_b32 v225, v8, v132
  v_lshlrev_b32 v226, 16, v133
  v_and_b32 v227, v8, v133
  v_lshlrev_b32 v228, 16, v134
  v_and_b32 v229, v8, v134
  v_lshlrev_b32 v230, 16, v135
  v_and_b32 v231, v8, v135
  v_pk_fma_f32 v[128:129], v[216:217], v[252:253], v[254:255]
  v_pk_fma_f32 v[130:131], v[218:219], v[252:253], v[254:255]
  v_pk_fma_f32 v[132:133], v[220:221], v[252:253], v[254:255]
  v_pk_fma_f32 v[134:135], v[222:223], v[252:253], v[254:255]
  buffer_load_dwordx4 a[176:179], v6, s[28:31], s15 offen offset:0 sc1
  buffer_load_dwordx4 a[180:183], v6, s[28:31], s15 offen offset:1024 sc1
  v_pk_fma_f32 v[128:129], v[128:129], v[224:225], v[216:217]
  v_pk_fma_f32 v[130:131], v[130:131], v[226:227], v[218:219]
  v_pk_fma_f32 v[132:133], v[132:133], v[228:229], v[220:221]
  v_pk_fma_f32 v[134:135], v[134:135], v[230:231], v[222:223]
  v_cvt_pk_bf16_f32 v200, v128, v129
  v_cvt_pk_bf16_f32 v201, v130, v131
  v_cvt_pk_bf16_f32 v202, v132, v133
  v_cvt_pk_bf16_f32 v203, v134, v135
  s_waitcnt lgkmcnt(0)
  v_lshlrev_b32 v216, 16, v136
  v_and_b32 v217, v8, v136
  v_mfma_f32_16x16x32_bf16 v[232:235], v[244:247], v[200:203], v[232:235]
  v_lshlrev_b32 v218, 16, v137
  v_and_b32 v219, v8, v137
  v_lshlrev_b32 v220, 16, v138
  v_mfma_f32_16x16x32_bf16 v[236:239], v[200:203], v[200:203], v[236:239]
  v_and_b32 v221, v8, v138
  v_lshlrev_b32 v222, 16, v139
  v_and_b32 v223, v8, v139
  v_lshlrev_b32 v224, 16, v140
  v_and_b32 v225, v8, v140
  v_lshlrev_b32 v226, 16, v141
  v_and_b32 v227, v8, v141
  v_lshlrev_b32 v228, 16, v142
  v_and_b32 v229, v8, v142
  v_lshlrev_b32 v230, 16, v143
  v_and_b32 v231, v8, v143
  v_pk_fma_f32 v[136:137], v[216:217], v[252:253], v[254:255]
  v_pk_fma_f32 v[138:139], v[218:219], v[252:253], v[254:255]
  v_pk_fma_f32 v[140:141], v[220:221], v[252:253], v[254:255]
  v_pk_fma_f32 v[142:143], v[222:223], v[252:253], v[254:255]
  buffer_load_dwordx4 a[184:187], v6, s[28:31], s15 offen offset:2048 sc1
  buffer_load_dwordx4 a[188:191], v6, s[28:31], s15 offen offset:3072 sc1
  s_add_u32 s15, s15, 4096
  v_pk_fma_f32 v[136:137], v[136:137], v[224:225], v[216:217]
  v_pk_fma_f32 v[138:139], v[138:139], v[226:227], v[218:219]
  v_pk_fma_f32 v[140:141], v[140:141], v[228:229], v[220:221]
  v_pk_fma_f32 v[142:143], v[142:143], v[230:231], v[222:223]
  v_cvt_pk_bf16_f32 v204, v136, v137
  v_cvt_pk_bf16_f32 v205, v138, v139
  v_cvt_pk_bf16_f32 v206, v140, v141
  v_cvt_pk_bf16_f32 v207, v142, v143
  s_nop 1
  v_mfma_f32_16x16x32_bf16 v[232:235], v[244:247], v[204:207], v[232:235]
  v_mfma_f32_16x16x32_bf16 v[236:239], v[204:207], v[204:207], v[236:239]
  s_cmp_eq_u32 s18, 0
  s_cbranch_scc0 P2_XS_36
  s_add_u32 s13, s14, 0
  buffer_store_dwordx4 v[144:147], v6, s[36:39], s13 offen offset:0 sc1
  s_add_u32 s13, s14, 4096
  buffer_store_dwordx4 v[172:175], v6, s[36:39], s13 offen offset:3072 sc1
  s_add_u32 s13, s14, 12288
  buffer_store_dwordx4 v[200:203], v6, s[36:39], s13 offen offset:2048 sc1
P2_XS_36:
  s_cmp_eq_u32 s18, 1
  s_cbranch_scc0 P2_XS_37
  s_add_u32 s13, s14, 0
  buffer_store_dwordx4 v[148:151], v6, s[36:39], s13 offen offset:1024 sc1
  s_add_u32 s13, s14, 8192
  buffer_store_dwordx4 v[176:179], v6, s[36:39], s13 offen offset:0 sc1
  s_add_u32 s13, s14, 12288
  buffer_store_dwordx4 v[204:207], v6, s[36:39], s13 offen offset:3072 sc1
P2_XS_37:
  s_cmp_eq_u32 s18, 2
  s_cbranch_scc0 P2_XS_38
  s_add_u32 s13, s14, 0
  buffer_store_dwordx4 v[152:155], v6, s[36:39], s13 offen offset:2048 sc1
  s_add_u32 s13, s14, 8192
  buffer_store_dwordx4 v[180:183], v6, s[36:39], s13 offen offset:1024 sc1
P2_XS_38:
  s_cmp_eq_u32 s18, 3
  s_cbranch_scc0 P2_XS_39
  s_add_u32 s13, s14, 0
  buffer_store_dwordx4 v[156:159], v6, s[36:39], s13 offen offset:3072 sc1
  s_add_u32 s13, s14, 8192
  buffer_store_dwordx4 v[184:187], v6, s[36:39], s13 offen offset:2048 sc1
P2_XS_39:
  s_cmp_eq_u32 s18, 4
  s_cbranch_scc0 P2_XS_40
  s_add_u32 s13, s14, 4096
  buffer_store_dwordx4 v[160:163], v6, s[36:39], s13 offen offset:0 sc1
  s_add_u32 s13, s14, 8192
  buffer_store_dwordx4 v[188:191], v6, s[36:39], s13 offen offset:3072 sc1
P2_XS_40:
  s_cmp_eq_u32 s18, 5
  s_cbranch_scc0 P2_XS_41
  s_add_u32 s13, s14, 4096
  buffer_store_dwordx4 v[164:167], v6, s[36:39], s13 offen offset:1024 sc1
  s_add_u32 s13, s14, 12288
  buffer_store_dwordx4 v[192:195], v6, s[36:39], s13 offen offset:0 sc1
P2_XS_41:
  s_cmp_eq_u32 s18, 6
  s_cbranch_scc0 P2_XS_42
  s_add_u32 s13, s14, 4096
  buffer_store_dwordx4 v[168:171], v6, s[36:39], s13 offen offset:2048 sc1
  s_add_u32 s13, s14, 12288
  buffer_store_dwordx4 v[196:199], v6, s[36:39], s13 offen offset:1024 sc1
P2_XS_42:
  s_nop 7
  v_mul_f32 v10, v236, v240
  v_fma_f32 v10, v237, v241, v10
  v_fma_f32 v10, v238, v242, v10
  v_fma_f32 v10, v239, v243, v10
  v_mul_f32 v11, 0.001953125, v232
  s_nop 0
  v_mfma_f32_16x16x4_f32 v[248:251], v14, v10, 0
  v_mul_f32 v12, v11, v11
  s_nop 7
  s_nop 3
  v_mul_f32 v13, 0.001953125, v248
  v_sub_f32 v13, v13, v12
  v_max_f32 v13, 0, v13
  v_add_f32 v13, 0x3727c5ac, v13
  v_rsq_f32 v252, v13
  s_nop 0
  v_mul_f32 v252, 0x3fb8aa3b, v252
  v_mul_f32 v254, v11, v252
  v_mov_b32 v253, v252
  v_mul_f32 v254, -1.0, v254
  v_mov_b32 v255, v254
  s_lshl_b32 s12, s16, 14
  s_add_u32 s12, s12, 65536
  v_add_u32 v9, s12, v6
  v_add_u32 v10, 65536, v6
  v_pk_fma_f32 v[16:17], v[16:17], v[252:253], v[254:255]
  v_pk_fma_f32 v[18:19], v[18:19], v[252:253], v[254:255]
  v_pk_fma_f32 v[20:21], v[20:21], v[252:253], v[254:255]
  v_pk_fma_f32 v[22:23], v[22:23], v[252:253], v[254:255]
  v_cvt_pk_bf16_f32 v216, v16, v17
  v_cvt_pk_bf16_f32 v217, v18, v19
  v_cvt_pk_bf16_f32 v218, v20, v21
  v_cvt_pk_bf16_f32 v219, v22, v23
  ds_write_b128 v9, v[216:219] offset:0
  buffer_load_dwordx4 a[192:195], v6, s[28:31], s15 offen offset:0 sc1
  v_pk_fma_f32 v[24:25], v[24:25], v[252:253], v[254:255]
  v_pk_fma_f32 v[26:27], v[26:27], v[252:253], v[254:255]
  v_pk_fma_f32 v[28:29], v[28:29], v[252:253], v[254:255]
  v_pk_fma_f32 v[30:31], v[30:31], v[252:253], v[254:255]
  v_cvt_pk_bf16_f32 v220, v24, v25
  v_cvt_pk_bf16_f32 v221, v26, v27
  v_cvt_pk_bf16_f32 v222, v28, v29
  v_cvt_pk_bf16_f32 v223, v30, v31
  ds_write_b128 v9, v[220:223] offset:1024
  buffer_load_dwordx4 a[196:199], v6, s[28:31], s15 offen offset:1024 sc1
  v_pk_fma_f32 v[32:33], v[32:33], v[252:253], v[254:255]
  v_pk_fma_f32 v[34:35], v[34:35], v[252:253], v[254:255]
  v_pk_fma_f32 v[36:37], v[36:37], v[252:253], v[254:255]
  v_pk_fma_f32 v[38:39], v[38:39], v[252:253], v[254:255]
  v_cvt_pk_bf16_f32 v224, v32, v33
  v_cvt_pk_bf16_f32 v225, v34, v35
  v_cvt_pk_bf16_f32 v226, v36, v37
  v_cvt_pk_bf16_f32 v227, v38, v39
  ds_write_b128 v9, v[224:227] offset:2048
  buffer_load_dwordx4 a[200:203], v6, s[28:31], s15 offen offset:2048 sc1
  v_pk_fma_f32 v[40:41], v[40:41], v[252:253], v[254:255]
  v_pk_fma_f32 v[42:43], v[42:43], v[252:253], v[254:255]
  v_pk_fma_f32 v[44:45], v[44:45], v[252:253], v[254:255]
  v_pk_fma_f32 v[46:47], v[46:47], v[252:253], v[254:255]
  v_cvt_pk_bf16_f32 v228, v40, v41
  v_cvt_pk_bf16_f32 v229, v42, v43
  v_cvt_pk_bf16_f32 v230, v44, v45
  v_cvt_pk_bf16_f32 v231, v46, v47
  ds_write_b128 v9, v[228:231] offset:3072
  buffer_load_dwordx4 a[204:207], v6, s[28:31], s15 offen offset:3072 sc1
  s_add_u32 s15, s15, 4096
  v_pk_fma_f32 v[48:49], v[48:49], v[252:253], v[254:255]
  v_pk_fma_f32 v[50:51], v[50:51], v[252:253], v[254:255]
  v_pk_fma_f32 v[52:53], v[52:53], v[252:253], v[254:255]
  v_pk_fma_f32 v[54:55], v[54:55], v[252:253], v[254:255]
  v_cvt_pk_bf16_f32 v216, v48, v49
  v_cvt_pk_bf16_f32 v217, v50, v51
  v_cvt_pk_bf16_f32 v218, v52, v53
  v_cvt_pk_bf16_f32 v219, v54, v55
  ds_write_b128 v9, v[216:219] offset:4096
  buffer_load_dwordx4 a[208:211], v6, s[28:31], s15 offen offset:0 sc1
  v_pk_fma_f32 v[56:57], v[56:57], v[252:253], v[254:255]
  v_pk_fma_f32 v[58:59], v[58:59], v[252:253], v[254:255]
  v_pk_fma_f32 v[60:61], v[60:61], v[252:253], v[254:255]
  v_pk_fma_f32 v[62:63], v[62:63], v[252:253], v[254:255]
  v_cvt_pk_bf16_f32 v220, v56, v57
  v_cvt_pk_bf16_f32 v221, v58, v59
  v_cvt_pk_bf16_f32 v222, v60, v61
  v_cvt_pk_bf16_f32 v223, v62, v63
  ds_write_b128 v9, v[220:223] offset:5120
  buffer_load_dwordx4 a[212:215], v6, s[28:31], s15 offen offset:1024 sc1
  v_pk_fma_f32 v[64:65], v[64:65], v[252:253], v[254:255]
  v_pk_fma_f32 v[66:67], v[66:67], v[252:253], v[254:255]
  v_pk_fma_f32 v[68:69], v[68:69], v[252:253], v[254:255]
  v_pk_fma_f32 v[70:71], v[70:71], v[252:253], v[254:255]
  v_cvt_pk_bf16_f32 v224, v64, v65
  v_cvt_pk_bf16_f32 v225, v66, v67
  v_cvt_pk_bf16_f32 v226, v68, v69
  v_cvt_pk_bf16_f32 v227, v70, v71
  ds_write_b128 v9, v[224:227] offset:6144
  buffer_load_dwordx4 a[216:219], v6, s[28:31], s15 offen offset:2048 sc1
  v_pk_fma_f32 v[72:73], v[72:73], v[252:253], v[254:255]
  v_pk_fma_f32 v[74:75], v[74:75], v[252:253], v[254:255]
  v_pk_fma_f32 v[76:77], v[76:77], v[252:253], v[254:255]
  v_pk_fma_f32 v[78:79], v[78:79], v[252:253], v[254:255]
  v_cvt_pk_bf16_f32 v228, v72, v73
  v_cvt_pk_bf16_f32 v229, v74, v75
  v_cvt_pk_bf16_f32 v230, v76, v77
  v_cvt_pk_bf16_f32 v231, v78, v79
  ds_write_b128 v9, v[228:231] offset:7168
  buffer_load_dwordx4 a[220:223], v6, s[28:31], s15 offen offset:3072 sc1
  s_add_u32 s15, s15, 4096
  v_pk_fma_f32 v[80:81], v[80:81], v[252:253], v[254:255]
  v_pk_fma_f32 v[82:83], v[82:83], v[252:253], v[254:255]
  v_pk_fma_f32 v[84:85], v[84:85], v[252:253], v[254:255]
  v_pk_fma_f32 v[86:87], v[86:87], v[252:253], v[254:255]
  v_cvt_pk_bf16_f32 v216, v80, v81
  v_cvt_pk_bf16_f32 v217, v82, v83
  v_cvt_pk_bf16_f32 v218, v84, v85
  v_cvt_pk_bf16_f32 v219, v86, v87
  ds_write_b128 v9, v[216:219] offset:8192
  buffer_load_dwordx4 a[224:227], v6, s[28:31], s15 offen offset:0 sc1
  v_pk_fma_f32 v[88:89], v[88:89], v[252:253], v[254:255]
  v_pk_fma_f32 v[90:91], v[90:91], v[252:253], v[254:255]
  v_pk_fma_f32 v[92:93], v[92:93], v[252:253], v[254:255]
  v_pk_fma_f32 v[94:95], v[94:95], v[252:253], v[254:255]
  v_cvt_pk_bf16_f32 v220, v88, v89
  v_cvt_pk_bf16_f32 v221, v90, v91
  v_cvt_pk_bf16_f32 v222, v92, v93
  v_cvt_pk_bf16_f32 v223, v94, v95
  ds_write_b128 v9, v[220:223] offset:9216
  buffer_load_dwordx4 a[228:231], v6, s[28:31], s15 offen offset:1024 sc1
  v_pk_fma_f32 v[96:97], v[96:97], v[252:253], v[254:255]
  v_pk_fma_f32 v[98:99], v[98:99], v[252:253], v[254:255]
  v_pk_fma_f32 v[100:101], v[100:101], v[252:253], v[254:255]
  v_pk_fma_f32 v[102:103], v[102:103], v[252:253], v[254:255]
  v_cvt_pk_bf16_f32 v224, v96, v97
  v_cvt_pk_bf16_f32 v225, v98, v99
  v_cvt_pk_bf16_f32 v226, v100, v101
  v_cvt_pk_bf16_f32 v227, v102, v103
  ds_write_b128 v9, v[224:227] offset:10240
  buffer_load_dwordx4 a[232:235], v6, s[28:31], s15 offen offset:2048 sc1
  v_pk_fma_f32 v[104:105], v[104:105], v[252:253], v[254:255]
  v_pk_fma_f32 v[106:107], v[106:107], v[252:253], v[254:255]
  v_pk_fma_f32 v[108:109], v[108:109], v[252:253], v[254:255]
  v_pk_fma_f32 v[110:111], v[110:111], v[252:253], v[254:255]
  v_cvt_pk_bf16_f32 v228, v104, v105
  v_cvt_pk_bf16_f32 v229, v106, v107
  v_cvt_pk_bf16_f32 v230, v108, v109
  v_cvt_pk_bf16_f32 v231, v110, v111
  ds_write_b128 v9, v[228:231] offset:11264
  buffer_load_dwordx4 a[236:239], v6, s[28:31], s15 offen offset:3072 sc1
  s_add_u32 s15, s15, 4096
  v_pk_fma_f32 v[112:113], v[112:113], v[252:253], v[254:255]
  v_pk_fma_f32 v[114:115], v[114:115], v[252:253], v[254:255]
  v_pk_fma_f32 v[116:117], v[116:117], v[252:253], v[254:255]
  v_pk_fma_f32 v[118:119], v[118:119], v[252:253], v[254:255]
  v_cvt_pk_bf16_f32 v216, v112, v113
  v_cvt_pk_bf16_f32 v217, v114, v115
  v_cvt_pk_bf16_f32 v218, v116, v117
  v_cvt_pk_bf16_f32 v219, v118, v119
  ds_write_b128 v9, v[216:219] offset:12288
  buffer_load_dwordx4 a[240:243], v6, s[28:31], s15 offen offset:0 sc1
  v_pk_fma_f32 v[120:121], v[120:121], v[252:253], v[254:255]
  v_pk_fma_f32 v[122:123], v[122:123], v[252:253], v[254:255]
  v_pk_fma_f32 v[124:125], v[124:125], v[252:253], v[254:255]
  v_pk_fma_f32 v[126:127], v[126:127], v[252:253], v[254:255]
  v_cvt_pk_bf16_f32 v220, v120, v121
  v_cvt_pk_bf16_f32 v221, v122, v123
  v_cvt_pk_bf16_f32 v222, v124, v125
  v_cvt_pk_bf16_f32 v223, v126, v127
  ds_write_b128 v9, v[220:223] offset:13312
  buffer_load_dwordx4 a[244:247], v6, s[28:31], s15 offen offset:1024 sc1
  v_pk_fma_f32 v[128:129], v[128:129], v[252:253], v[254:255]
  v_pk_fma_f32 v[130:131], v[130:131], v[252:253], v[254:255]
  v_pk_fma_f32 v[132:133], v[132:133], v[252:253], v[254:255]
  v_pk_fma_f32 v[134:135], v[134:135], v[252:253], v[254:255]
  v_cvt_pk_bf16_f32 v224, v128, v129
  v_cvt_pk_bf16_f32 v225, v130, v131
  v_cvt_pk_bf16_f32 v226, v132, v133
  v_cvt_pk_bf16_f32 v227, v134, v135
  ds_write_b128 v9, v[224:227] offset:14336
  buffer_load_dwordx4 a[248:251], v6, s[28:31], s15 offen offset:2048 sc1
  v_pk_fma_f32 v[136:137], v[136:137], v[252:253], v[254:255]
  v_pk_fma_f32 v[138:139], v[138:139], v[252:253], v[254:255]
  v_pk_fma_f32 v[140:141], v[140:141], v[252:253], v[254:255]
  v_pk_fma_f32 v[142:143], v[142:143], v[252:253], v[254:255]
  v_cvt_pk_bf16_f32 v228, v136, v137
  v_cvt_pk_bf16_f32 v229, v138, v139
  v_cvt_pk_bf16_f32 v230, v140, v141
  v_cvt_pk_bf16_f32 v231, v142, v143
  ds_write_b128 v9, v[228:231] offset:15360
  buffer_load_dwordx4 a[252:255], v6, s[28:31], s15 offen offset:3072 sc1
  v_lshlrev_b32 v16, 16, v208
  v_and_b32 v20, v8, v208
  v_lshlrev_b32 v24, 16, v209
  v_and_b32 v28, v8, v209
  v_lshlrev_b32 v17, 16, v210
  v_and_b32 v21, v8, v210
  v_lshlrev_b32 v25, 16, v211
  v_and_b32 v29, v8, v211
  v_lshlrev_b32 v18, 16, v212
  v_and_b32 v22, v8, v212
  v_lshlrev_b32 v26, 16, v213
  v_and_b32 v30, v8, v213
  v_lshlrev_b32 v19, 16, v214
  v_and_b32 v23, v8, v214
  v_lshlrev_b32 v27, 16, v215
  v_and_b32 v31, v8, v215
  v_mul_f32 v16, 0x3fb8aa3b, v16
  v_mul_f32 v17, 0x3fb8aa3b, v17
  v_mul_f32 v18, 0x3fb8aa3b, v18
  v_mul_f32 v19, 0x3fb8aa3b, v19
  v_mul_f32 v20, 0x3fb8aa3b, v20
  v_mul_f32 v21, 0x3fb8aa3b, v21
  v_mul_f32 v22, 0x3fb8aa3b, v22
  v_mul_f32 v23, 0x3fb8aa3b, v23
  v_mul_f32 v24, 0x3fb8aa3b, v24
  v_mul_f32 v25, 0x3fb8aa3b, v25
  v_mul_f32 v26, 0x3fb8aa3b, v26
  v_mul_f32 v27, 0x3fb8aa3b, v27
  v_mul_f32 v28, 0x3fb8aa3b, v28
  v_mul_f32 v29, 0x3fb8aa3b, v29
  v_mul_f32 v30, 0x3fb8aa3b, v30
  v_mul_f32 v31, 0x3fb8aa3b, v31
  v_mov_b32 v128, 2.0
  v_mov_b32 v129, 2.0
  v_mov_b32 v130, 0xbfb17218
  v_mov_b32 v131, 0xbfb17218
  v_mov_b32 v132, 0x3f317218
  v_mov_b32 v133, 0x3f317218
  s_lshl_b32 s12, s17, 2
  s_mul_i32 s12, s12, 57344
  s_lshl_b32 s13, s19, 11
  s_add_u32 s12, s12, s13
  s_waitcnt lgkmcnt(0)
  s_barrier
  s_add_u32 s20, s8, 0x600000
  s_addc_u32 s21, s9, 0
  s_mov_b32 s22, 0x1c0000
  s_mov_b32 s23, 0x20000
  s_lshr_b32 s44, s2, 5
  s_mul_i32 s44, s44, 56
  s_mul_i32 s45, s16, 14
  s_add_u32 s44, s44, s45
  s_lshl_b32 s44, s44, 12
  ds_read_b128 v[64:67], v10 offset:0
  ds_read_b128 v[68:71], v10 offset:1024
  ds_read_b128 v[72:75], v10 offset:2048
  ds_read_b128 v[76:79], v10 offset:3072
  ds_read_b128 v[80:83], v10 offset:4096
  ds_read_b128 v[84:87], v10 offset:5120
  s_waitcnt lgkmcnt(5)
  s_waitcnt vmcnt(60)
  v_mfma_f32_16x16x32_bf16 v[32:35], a[0:3], v[64:67], v[16:19]
  ds_read_b128 v[88:91], v10 offset:6144
  v_mfma_f32_16x16x32_bf16 v[36:39], a[4:7], v[64:67], v[20:23]
  v_mfma_f32_16x16x32_bf16 v[40:43], a[8:11], v[64:67], v[24:27]
  v_mfma_f32_16x16x32_bf16 v[44:47], a[12:15], v[64:67], v[28:31]
  s_waitcnt lgkmcnt(5)
  s_waitcnt vmcnt(56)
  v_mfma_f32_16x16x32_bf16 v[32:35], a[16:19], v[68:71], v[32:35]
  ds_read_b128 v[92:95], v10 offset:7168
  v_mfma_f32_16x16x32_bf16 v[36:39], a[20:23], v[68:71], v[36:39]
  v_mfma_f32_16x16x32_bf16 v[40:43], a[24:27], v[68:71], v[40:43]
  v_mfma_f32_16x16x32_bf16 v[44:47], a[28:31], v[68:71], v[44:47]
  s_waitcnt lgkmcnt(5)
  s_waitcnt vmcnt(52)
  v_mfma_f32_16x16x32_bf16 v[32:35], a[32:35], v[72:75], v[32:35]
  ds_read_b128 v[64:67], v10 offset:8192
  v_mfma_f32_16x16x32_bf16 v[36:39], a[36:39], v[72:75], v[36:39]
  v_mfma_f32_16x16x32_bf16 v[40:43], a[40:43], v[72:75], v[40:43]
  v_mfma_f32_16x16x32_bf16 v[44:47], a[44:47], v[72:75], v[44:47]
  s_waitcnt lgkmcnt(5)
  s_waitcnt vmcnt(48)
  v_mfma_f32_16x16x32_bf16 v[32:35], a[48:51], v[76:79], v[32:35]
  ds_read_b128 v[68:71], v10 offset:9216
  v_mfma_f32_16x16x32_bf16 v[36:39], a[52:55], v[76:79], v[36:39]
  v_mfma_f32_16x16x32_bf16 v[40:43], a[56:59], v[76:79], v[40:43]
  v_mfma_f32_16x16x32_bf16 v[44:47], a[60:63], v[76:79], v[44:47]
  s_waitcnt lgkmcnt(5)
  s_waitcnt vmcnt(44)
  v_mfma_f32_16x16x32_bf16 v[32:35], a[64:67], v[80:83], v[32:35]
  ds_read_b128 v[72:75], v10 offset:10240
  v_mfma_f32_16x16x32_bf16 v[36:39], a[68:71], v[80:83], v[36:39]
  v_mfma_f32_16x16x32_bf16 v[40:43], a[72:75], v[80:83], v[40:43]
  v_mfma_f32_16x16x32_bf16 v[44:47], a[76:79], v[80:83], v[44:47]
  s_waitcnt lgkmcnt(5)
  s_waitcnt vmcnt(40)
  v_mfma_f32_16x16x32_bf16 v[32:35], a[80:83], v[84:87], v[32:35]
  ds_read_b128 v[76:79], v10 offset:11264
  v_mfma_f32_16x16x32_bf16 v[36:39], a[84:87], v[84:87], v[36:39]
  v_mfma_f32_16x16x32_bf16 v[40:43], a[88:91], v[84:87], v[40:43]
  v_mfma_f32_16x16x32_bf16 v[44:47], a[92:95], v[84:87], v[44:47]
  s_waitcnt lgkmcnt(5)
  s_waitcnt vmcnt(36)
  v_mfma_f32_16x16x32_bf16 v[32:35], a[96:99], v[88:91], v[32:35]
  ds_read_b128 v[80:83], v10 offset:12288
  v_mfma_f32_16x16x32_bf16 v[36:39], a[100:103], v[88:91], v[36:39]
  v_mfma_f32_16x16x32_bf16 v[40:43], a[104:107], v[88:91], v[40:43]
  v_mfma_f32_16x16x32_bf16 v[44:47], a[108:111], v[88:91], v[44:47]
  s_waitcnt lgkmcnt(5)
  s_waitcnt vmcnt(32)
  v_mfma_f32_16x16x32_bf16 v[32:35], a[112:115], v[92:95], v[32:35]
  ds_read_b128 v[84:87], v10 offset:13312
  v_mfma_f32_16x16x32_bf16 v[36:39], a[116:119], v[92:95], v[36:39]
  v_mfma_f32_16x16x32_bf16 v[40:43], a[120:123], v[92:95], v[40:43]
  v_mfma_f32_16x16x32_bf16 v[44:47], a[124:127], v[92:95], v[44:47]
  s_waitcnt lgkmcnt(5)
  s_waitcnt vmcnt(28)
  v_mfma_f32_16x16x32_bf16 v[32:35], a[128:131], v[64:67], v[32:35]
  ds_read_b128 v[88:91], v10 offset:14336
  v_mfma_f32_16x16x32_bf16 v[36:39], a[132:135], v[64:67], v[36:39]
  v_mfma_f32_16x16x32_bf16 v[40:43], a[136:139], v[64:67], v[40:43]
  v_mfma_f32_16x16x32_bf16 v[44:47], a[140:143], v[64:67], v[44:47]
  s_waitcnt lgkmcnt(5)
  s_waitcnt vmcnt(24)
  v_mfma_f32_16x16x32_bf16 v[32:35], a[144:147], v[68:71], v[32:35]
  ds_read_b128 v[92:95], v10 offset:15360
  v_mfma_f32_16x16x32_bf16 v[36:39], a[148:151], v[68:71], v[36:39]
  v_mfma_f32_16x16x32_bf16 v[40:43], a[152:155], v[68:71], v[40:43]
  v_mfma_f32_16x16x32_bf16 v[44:47], a[156:159], v[68:71], v[44:47]
  s_waitcnt lgkmcnt(5)
  s_waitcnt vmcnt(20)
  v_mfma_f32_16x16x32_bf16 v[32:35], a[160:163], v[72:75], v[32:35]
  ds_read_b128 v[64:67], v10 offset:16384
  v_mfma_f32_16x16x32_bf16 v[36:39], a[164:167], v[72:75], v[36:39]
  v_mfma_f32_16x16x32_bf16 v[40:43], a[168:171], v[72:75], v[40:43]
  v_mfma_f32_16x16x32_bf16 v[44:47], a[172:175], v[72:75], v[44:47]
  s_waitcnt lgkmcnt(5)
  s_waitcnt vmcnt(16)
  v_mfma_f32_16x16x32_bf16 v[32:35], a[176:179], v[76:79], v[32:35]
  ds_read_b128 v[68:71], v10 offset:17408
  v_mfma_f32_16x16x32_bf16 v[36:39], a[180:183], v[76:79], v[36:39]
  v_mfma_f32_16x16x32_bf16 v[40:43], a[184:187], v[76:79], v[40:43]
  v_mfma_f32_16x16x32_bf16 v[44:47], a[188:191], v[76:79], v[44:47]
  s_waitcnt lgkmcnt(5)
  s_waitcnt vmcnt(12)
  v_mfma_f32_16x16x32_bf16 v[32:35], a[192:195], v[80:83], v[32:35]
  ds_read_b128 v[72:75], v10 offset:18432
  v_mfma_f32_16x16x32_bf16 v[36:39], a[196:199], v[80:83], v[36:39]
  v_mfma_f32_16x16x32_bf16 v[40:43], a[200:203], v[80:83], v[40:43]
  v_mfma_f32_16x16x32_bf16 v[44:47], a[204:207], v[80:83], v[44:47]
  s_waitcnt lgkmcnt(5)
  s_waitcnt vmcnt(8)
  v_mfma_f32_16x16x32_bf16 v[32:35], a[208:211], v[84:87], v[32:35]
  ds_read_b128 v[76:79], v10 offset:19456
  v_mfma_f32_16x16x32_bf16 v[36:39], a[212:215], v[84:87], v[36:39]
  v_mfma_f32_16x16x32_bf16 v[40:43], a[216:219], v[84:87], v[40:43]
  v_mfma_f32_16x16x32_bf16 v[44:47], a[220:223], v[84:87], v[44:47]
  s_waitcnt lgkmcnt(5)
  s_waitcnt vmcnt(4)
  v_mfma_f32_16x16x32_bf16 v[32:35], a[224:227], v[88:91], v[32:35]
  ds_read_b128 v[80:83], v10 offset:20480
  v_mfma_f32_16x16x32_bf16 v[36:39], a[228:231], v[88:91], v[36:39]
  v_mfma_f32_16x16x32_bf16 v[40:43], a[232:235], v[88:91], v[40:43]
  v_mfma_f32_16x16x32_bf16 v[44:47], a[236:239], v[88:91], v[44:47]
  s_waitcnt lgkmcnt(5)
  s_waitcnt vmcnt(0)
  v_mfma_f32_16x16x32_bf16 v[32:35], a[240:243], v[92:95], v[32:35]
  ds_read_b128 v[84:87], v10 offset:21504
  v_mfma_f32_16x16x32_bf16 v[36:39], a[244:247], v[92:95], v[36:39]
  v_mfma_f32_16x16x32_bf16 v[40:43], a[248:251], v[92:95], v[40:43]
  v_mfma_f32_16x16x32_bf16 v[44:47], a[252:255], v[92:95], v[44:47]
  s_waitcnt lgkmcnt(5)
  v_mfma_f32_16x16x32_bf16 v[48:51], a[0:3], v[64:67], v[16:19]
  ds_read_b128 v[88:91], v10 offset:22528
  v_mfma_f32_16x16x32_bf16 v[52:55], a[4:7], v[64:67], v[20:23]
  v_mfma_f32_16x16x32_bf16 v[56:59], a[8:11], v[64:67], v[24:27]
  buffer_load_dwordx4 v[144:147], v6, s[20:23], s44 offen offset:0 sc1
  v_mfma_f32_16x16x32_bf16 v[60:63], a[12:15], v[64:67], v[28:31]
  s_waitcnt lgkmcnt(5)
  v_mfma_f32_16x16x32_bf16 v[48:51], a[16:19], v[68:71], v[48:51]
  ds_read_b128 v[92:95], v10 offset:23552
  v_mfma_f32_16x16x32_bf16 v[52:55], a[20:23], v[68:71], v[52:55]
  v_mfma_f32_16x16x32_bf16 v[56:59], a[24:27], v[68:71], v[56:59]
  buffer_load_dwordx4 v[148:151], v6, s[20:23], s44 offen offset:1024 sc1
  v_exp_f32 v96, v32
  v_mfma_f32_16x16x32_bf16 v[60:63], a[28:31], v[68:71], v[60:63]
  v_exp_f32 v97, v33
  s_waitcnt lgkmcnt(5)
  v_mfma_f32_16x16x32_bf16 v[48:51], a[32:35], v[72:75], v[48:51]
  ds_read_b128 v[64:67], v10 offset:24576
  v_exp_f32 v98, v34
  v_mfma_f32_16x16x32_bf16 v[52:55], a[36:39], v[72:75], v[52:55]
  v_exp_f32 v99, v35
  v_mfma_f32_16x16x32_bf16 v[56:59], a[40:43], v[72:75], v[56:59]
  buffer_load_dwordx4 v[152:155], v6, s[20:23], s44 offen offset:2048 sc1
  v_exp_f32 v100, v36
  v_mfma_f32_16x16x32_bf16 v[60:63], a[44:47], v[72:75], v[60:63]
  v_exp_f32 v101, v37
  s_waitcnt lgkmcnt(5)
  v_mfma_f32_16x16x32_bf16 v[48:51], a[48:51], v[76:79], v[48:51]
  ds_read_b128 v[68:71], v10 offset:25600
  v_exp_f32 v102, v38
  v_mfma_f32_16x16x32_bf16 v[52:55], a[52:55], v[76:79], v[52:55]
  v_exp_f32 v103, v39
  v_mfma_f32_16x16x32_bf16 v[56:59], a[56:59], v[76:79], v[56:59]
  buffer_load_dwordx4 v[156:159], v6, s[20:23], s44 offen offset:3072 sc1
  s_add_u32 s44, s44, 4096
  v_exp_f32 v104, v40
  v_mfma_f32_16x16x32_bf16 v[60:63], a[60:63], v[76:79], v[60:63]
  v_exp_f32 v105, v41
  s_waitcnt lgkmcnt(5)
  v_mfma_f32_16x16x32_bf16 v[48:51], a[64:67], v[80:83], v[48:51]
  ds_read_b128 v[72:75], v10 offset:26624
  v_exp_f32 v106, v42
  v_mfma_f32_16x16x32_bf16 v[52:55], a[68:71], v[80:83], v[52:55]
  v_exp_f32 v107, v43
  v_mfma_f32_16x16x32_bf16 v[56:59], a[72:75], v[80:83], v[56:59]
  buffer_load_dwordx4 v[160:163], v6, s[20:23], s44 offen offset:0 sc1
  v_exp_f32 v108, v44
  v_mfma_f32_16x16x32_bf16 v[60:63], a[76:79], v[80:83], v[60:63]
  v_exp_f32 v109, v45
  s_waitcnt lgkmcnt(5)
  v_mfma_f32_16x16x32_bf16 v[48:51], a[80:83], v[84:87], v[48:51]
  ds_read_b128 v[76:79], v10 offset:27648
  v_exp_f32 v110, v46
  v_mfma_f32_16x16x32_bf16 v[52:55], a[84:87], v[84:87], v[52:55]
  v_exp_f32 v111, v47
  v_add_f32 v112, 2.0, v96
  v_mfma_f32_16x16x32_bf16 v[56:59], a[88:91], v[84:87], v[56:59]
  buffer_load_dwordx4 v[164:167], v6, s[20:23], s44 offen offset:1024 sc1
  v_add_f32 v113, 2.0, v97
  v_add_f32 v114, 2.0, v98
  v_add_f32 v115, 2.0, v99
  v_mfma_f32_16x16x32_bf16 v[60:63], a[92:95], v[84:87], v[60:63]
  v_add_f32 v116, 2.0, v100
  v_add_f32 v117, 2.0, v101
  s_waitcnt lgkmcnt(5)
  v_mfma_f32_16x16x32_bf16 v[48:51], a[96:99], v[88:91], v[48:51]
  ds_read_b128 v[80:83], v10 offset:28672
  v_add_f32 v118, 2.0, v102
  v_add_f32 v119, 2.0, v103
  v_mfma_f32_16x16x32_bf16 v[52:55], a[100:103], v[88:91], v[52:55]
  v_add_f32 v120, 2.0, v104
  v_add_f32 v121, 2.0, v105
  v_mfma_f32_16x16x32_bf16 v[56:59], a[104:107], v[88:91], v[56:59]
  buffer_load_dwordx4 v[168:171], v6, s[20:23], s44 offen offset:2048 sc1
  v_add_f32 v122, 2.0, v106
  v_add_f32 v123, 2.0, v107
  v_add_f32 v124, 2.0, v108
  v_mfma_f32_16x16x32_bf16 v[60:63], a[108:111], v[88:91], v[60:63]
  v_add_f32 v125, 2.0, v109
  v_add_f32 v126, 2.0, v110
  s_waitcnt lgkmcnt(5)
  v_mfma_f32_16x16x32_bf16 v[48:51], a[112:115], v[92:95], v[48:51]
  ds_read_b128 v[84:87], v10 offset:29696
  v_add_f32 v127, 2.0, v111
  v_fma_f32 v96, v96, v112, 2.0
  v_mfma_f32_16x16x32_bf16 v[52:55], a[116:119], v[92:95], v[52:55]
  v_fma_f32 v97, v97, v113, 2.0
  v_fma_f32 v98, v98, v114, 2.0
  v_mfma_f32_16x16x32_bf16 v[56:59], a[120:123], v[92:95], v[56:59]
  buffer_load_dwordx4 v[172:175], v6, s[20:23], s44 offen offset:3072 sc1
  s_add_u32 s44, s44, 4096
  v_fma_f32 v99, v99, v115, 2.0
  v_fma_f32 v100, v100, v116, 2.0
  v_fma_f32 v101, v101, v117, 2.0
  v_mfma_f32_16x16x32_bf16 v[60:63], a[124:127], v[92:95], v[60:63]
  v_fma_f32 v102, v102, v118, 2.0
  v_fma_f32 v103, v103, v119, 2.0
  s_waitcnt lgkmcnt(5)
  v_mfma_f32_16x16x32_bf16 v[48:51], a[128:131], v[64:67], v[48:51]
  ds_read_b128 v[88:91], v10 offset:30720
  v_fma_f32 v104, v104, v120, 2.0
  v_fma_f32 v105, v105, v121, 2.0
  v_mfma_f32_16x16x32_bf16 v[52:55], a[132:135], v[64:67], v[52:55]
  v_fma_f32 v106, v106, v122, 2.0
  v_fma_f32 v107, v107, v123, 2.0
  v_mfma_f32_16x16x32_bf16 v[56:59], a[136:139], v[64:67], v[56:59]
  buffer_load_dwordx4 v[176:179], v6, s[20:23], s44 offen offset:0 sc1
  v_fma_f32 v108, v108, v124, 2.0
  v_fma_f32 v109, v109, v125, 2.0
  v_fma_f32 v110, v110, v126, 2.0
  v_mfma_f32_16x16x32_bf16 v[60:63], a[140:143], v[64:67], v[60:63]
  v_fma_f32 v111, v111, v127, 2.0
  s_waitcnt lgkmcnt(5)
  v_mfma_f32_16x16x32_bf16 v[48:51], a[144:147], v[68:71], v[48:51]
  ds_read_b128 v[92:95], v10 offset:31744
  v_rcp_f32 v96, v96
  v_mfma_f32_16x16x32_bf16 v[52:55], a[148:151], v[68:71], v[52:55]
  v_rcp_f32 v97, v97
  v_mfma_f32_16x16x32_bf16 v[56:59], a[152:155], v[68:71], v[56:59]
  buffer_load_dwordx4 v[180:183], v6, s[20:23], s44 offen offset:1024 sc1
  v_rcp_f32 v98, v98
  v_mfma_f32_16x16x32_bf16 v[60:63], a[156:159], v[68:71], v[60:63]
  v_rcp_f32 v99, v99
  s_waitcnt lgkmcnt(5)
  v_mfma_f32_16x16x32_bf16 v[48:51], a[160:163], v[72:75], v[48:51]
  ds_read_b128 v[64:67], v10 offset:32768
  v_rcp_f32 v100, v100
  v_mfma_f32_16x16x32_bf16 v[52:55], a[164:167], v[72:75], v[52:55]
  v_rcp_f32 v101, v101
  v_mfma_f32_16x16x32_bf16 v[56:59], a[168:171], v[72:75], v[56:59]
  buffer_load_dwordx4 v[184:187], v6, s[20:23], s44 offen offset:2048 sc1
  v_rcp_f32 v102, v102
  v_mfma_f32_16x16x32_bf16 v[60:63], a[172:175], v[72:75], v[60:63]
  v_rcp_f32 v103, v103
  s_waitcnt lgkmcnt(5)
  v_mfma_f32_16x16x32_bf16 v[48:51], a[176:179], v[76:79], v[48:51]
  ds_read_b128 v[68:71], v10 offset:33792
  v_rcp_f32 v104, v104
  v_mfma_f32_16x16x32_bf16 v[52:55], a[180:183], v[76:79], v[52:55]
  v_rcp_f32 v105, v105
  v_mfma_f32_16x16x32_bf16 v[56:59], a[184:187], v[76:79], v[56:59]
  buffer_load_dwordx4 v[188:191], v6, s[20:23], s44 offen offset:3072 sc1
  s_add_u32 s44, s44, 4096
  v_rcp_f32 v106, v106
  v_mfma_f32_16x16x32_bf16 v[60:63], a[188:191], v[76:79], v[60:63]
  v_rcp_f32 v107, v107
  s_waitcnt lgkmcnt(5)
  v_mfma_f32_16x16x32_bf16 v[48:51], a[192:195], v[80:83], v[48:51]
  ds_read_b128 v[72:75], v10 offset:34816
  v_rcp_f32 v108, v108
  v_mfma_f32_16x16x32_bf16 v[52:55], a[196:199], v[80:83], v[52:55]
  v_rcp_f32 v109, v109
  v_mfma_f32_16x16x32_bf16 v[56:59], a[200:203], v[80:83], v[56:59]
  buffer_load_dwordx4 v[192:195], v6, s[20:23], s44 offen offset:0 sc1
  v_rcp_f32 v110, v110
  v_mfma_f32_16x16x32_bf16 v[60:63], a[204:207], v[80:83], v[60:63]
  v_rcp_f32 v111, v111
  v_fma_f32 v96, v96, v130, v132
  s_waitcnt lgkmcnt(5)
  v_mfma_f32_16x16x32_bf16 v[48:51], a[208:211], v[84:87], v[48:51]
  ds_read_b128 v[76:79], v10 offset:35840
  v_fma_f32 v97, v97, v130, v132
  v_fma_f32 v98, v98, v130, v132
  v_mfma_f32_16x16x32_bf16 v[52:55], a[212:215], v[84:87], v[52:55]
  v_fma_f32 v99, v99, v130, v132
  v_fma_f32 v100, v100, v130, v132
  v_mfma_f32_16x16x32_bf16 v[56:59], a[216:219], v[84:87], v[56:59]
  buffer_load_dwordx4 v[196:199], v6, s[20:23], s44 offen offset:1024 sc1
  v_fma_f32 v101, v101, v130, v132
  v_fma_f32 v102, v102, v130, v132
  v_fma_f32 v103, v103, v130, v132
  v_mfma_f32_16x16x32_bf16 v[60:63], a[220:223], v[84:87], v[60:63]
  v_fma_f32 v104, v104, v130, v132
  v_fma_f32 v105, v105, v130, v132
  s_waitcnt lgkmcnt(5)
  v_mfma_f32_16x16x32_bf16 v[48:51], a[224:227], v[88:91], v[48:51]
  ds_read_b128 v[80:83], v10 offset:36864
  v_fma_f32 v106, v106, v130, v132
  v_fma_f32 v107, v107, v130, v132
  v_mfma_f32_16x16x32_bf16 v[52:55], a[228:231], v[88:91], v[52:55]
  v_fma_f32 v108, v108, v130, v132
  v_fma_f32 v109, v109, v130, v132
  v_mfma_f32_16x16x32_bf16 v[56:59], a[232:235], v[88:91], v[56:59]
  v_fma_f32 v110, v110, v130, v132
  v_fma_f32 v111, v111, v130, v132
  v_mul_f32 v96, v96, v32
  v_mfma_f32_16x16x32_bf16 v[60:63], a[236:239], v[88:91], v[60:63]
  v_mul_f32 v97, v97, v33
  v_mul_f32 v98, v98, v34
  s_waitcnt lgkmcnt(5)
  v_mfma_f32_16x16x32_bf16 v[48:51], a[240:243], v[92:95], v[48:51]
  ds_read_b128 v[84:87], v10 offset:37888
  v_mul_f32 v99, v99, v35
  v_mul_f32 v100, v100, v36
  v_mfma_f32_16x16x32_bf16 v[52:55], a[244:247], v[92:95], v[52:55]
  v_mul_f32 v101, v101, v37
  v_mul_f32 v102, v102, v38
  v_mfma_f32_16x16x32_bf16 v[56:59], a[248:251], v[92:95], v[56:59]
  v_mul_f32 v103, v103, v39
  v_mul_f32 v104, v104, v40
  v_mul_f32 v105, v105, v41
  v_mfma_f32_16x16x32_bf16 v[60:63], a[252:255], v[92:95], v[60:63]
  v_mul_f32 v106, v106, v42
  v_mul_f32 v107, v107, v43
  v_mul_f32 v108, v108, v44
  v_mul_f32 v109, v109, v45
  v_mul_f32 v110, v110, v46
  v_mul_f32 v111, v111, v47
  v_cvt_pk_bf16_f32 v136, v96, v100
  v_cvt_pk_bf16_f32 v137, v104, v108
  v_cvt_pk_bf16_f32 v138, v97, v101
  v_cvt_pk_bf16_f32 v139, v105, v109
  buffer_store_dwordx4 v[136:139], v6, s[40:43], s12 offen offset:0 sc1
  v_cvt_pk_bf16_f32 v140, v98, v102
  v_cvt_pk_bf16_f32 v141, v106, v110
  v_cvt_pk_bf16_f32 v142, v99, v103
  v_cvt_pk_bf16_f32 v143, v107, v111
  buffer_store_dwordx4 v[140:143], v6, s[40:43], s12 offen offset:1024 sc1
  s_add_u32 s12, s12, 57344
  s_waitcnt lgkmcnt(5)
  v_mfma_f32_16x16x32_bf16 v[32:35], a[0:3], v[64:67], v[16:19]
  ds_read_b128 v[88:91], v10 offset:38912
  v_mfma_f32_16x16x32_bf16 v[36:39], a[4:7], v[64:67], v[20:23]
  v_mfma_f32_16x16x32_bf16 v[40:43], a[8:11], v[64:67], v[24:27]
  buffer_load_dwordx4 v[200:203], v6, s[20:23], s44 offen offset:2048 sc1
  v_mfma_f32_16x16x32_bf16 v[44:47], a[12:15], v[64:67], v[28:31]
  s_waitcnt lgkmcnt(5)
  v_mfma_f32_16x16x32_bf16 v[32:35], a[16:19], v[68:71], v[32:35]
  ds_read_b128 v[92:95], v10 offset:39936
  v_mfma_f32_16x16x32_bf16 v[36:39], a[20:23], v[68:71], v[36:39]
  v_mfma_f32_16x16x32_bf16 v[40:43], a[24:27], v[68:71], v[40:43]
  buffer_load_dwordx4 v[204:207], v6, s[20:23], s44 offen offset:3072 sc1
  s_add_u32 s44, s44, 4096
  v_exp_f32 v96, v48
  v_mfma_f32_16x16x32_bf16 v[44:47], a[28:31], v[68:71], v[44:47]
  v_exp_f32 v97, v49
  s_waitcnt lgkmcnt(5)
  v_mfma_f32_16x16x32_bf16 v[32:35], a[32:35], v[72:75], v[32:35]
  ds_read_b128 v[64:67], v10 offset:40960
  v_exp_f32 v98, v50
  v_mfma_f32_16x16x32_bf16 v[36:39], a[36:39], v[72:75], v[36:39]
  v_exp_f32 v99, v51
  v_mfma_f32_16x16x32_bf16 v[40:43], a[40:43], v[72:75], v[40:43]
  buffer_load_dwordx4 v[208:211], v6, s[20:23], s44 offen offset:0 sc1
  v_exp_f32 v100, v52
  v_mfma_f32_16x16x32_bf16 v[44:47], a[44:47], v[72:75], v[44:47]
  v_exp_f32 v101, v53
  s_waitcnt lgkmcnt(5)
  v_mfma_f32_16x16x32_bf16 v[32:35], a[48:51], v[76:79], v[32:35]
  ds_read_b128 v[68:71], v10 offset:41984
  v_exp_f32 v102, v54
  v_mfma_f32_16x16x32_bf16 v[36:39], a[52:55], v[76:79], v[36:39]
  v_exp_f32 v103, v55
  v_mfma_f32_16x16x32_bf16 v[40:43], a[56:59], v[76:79], v[40:43]
  buffer_load_dwordx4 v[212:215], v6, s[20:23], s44 offen offset:1024 sc1
  v_exp_f32 v104, v56
  v_mfma_f32_16x16x32_bf16 v[44:47], a[60:63], v[76:79], v[44:47]
  v_exp_f32 v105, v57
  s_waitcnt lgkmcnt(5)
  v_mfma_f32_16x16x32_bf16 v[32:35], a[64:67], v[80:83], v[32:35]
  ds_read_b128 v[72:75], v10 offset:43008
  v_exp_f32 v106, v58
  v_mfma_f32_16x16x32_bf16 v[36:39], a[68:71], v[80:83], v[36:39]
  v_exp_f32 v107, v59
  v_mfma_f32_16x16x32_bf16 v[40:43], a[72:75], v[80:83], v[40:43]
  buffer_load_dwordx4 v[216:219], v6, s[20:23], s44 offen offset:2048 sc1
  v_exp_f32 v108, v60
  v_mfma_f32_16x16x32_bf16 v[44:47], a[76:79], v[80:83], v[44:47]
  v_exp_f32 v109, v61
  s_waitcnt lgkmcnt(5)
  v_mfma_f32_16x16x32_bf16 v[32:35], a[80:83], v[84:87], v[32:35]
  ds_read_b128 v[76:79], v10 offset:44032
  v_exp_f32 v110, v62
  v_mfma_f32_16x16x32_bf16 v[36:39], a[84:87], v[84:87], v[36:39]
  v_exp_f32 v111, v63
  v_add_f32 v112, 2.0, v96
  v_mfma_f32_16x16x32_bf16 v[40:43], a[88:91], v[84:87], v[40:43]
  buffer_load_dwordx4 v[220:223], v6, s[20:23], s44 offen offset:3072 sc1
  s_add_u32 s44, s44, 4096
  v_add_f32 v113, 2.0, v97
  v_add_f32 v114, 2.0, v98
  v_add_f32 v115, 2.0, v99
  v_mfma_f32_16x16x32_bf16 v[44:47], a[92:95], v[84:87], v[44:47]
  v_add_f32 v116, 2.0, v100
  v_add_f32 v117, 2.0, v101
  s_waitcnt lgkmcnt(5)
  v_mfma_f32_16x16x32_bf16 v[32:35], a[96:99], v[88:91], v[32:35]
  ds_read_b128 v[80:83], v10 offset:45056
  v_add_f32 v118, 2.0, v102
  v_add_f32 v119, 2.0, v103
  v_mfma_f32_16x16x32_bf16 v[36:39], a[100:103], v[88:91], v[36:39]
  v_add_f32 v120, 2.0, v104
  v_add_f32 v121, 2.0, v105
  v_mfma_f32_16x16x32_bf16 v[40:43], a[104:107], v[88:91], v[40:43]
  buffer_load_dwordx4 v[224:227], v6, s[20:23], s44 offen offset:0 sc1
  v_add_f32 v122, 2.0, v106
  v_add_f32 v123, 2.0, v107
  v_add_f32 v124, 2.0, v108
  v_mfma_f32_16x16x32_bf16 v[44:47], a[108:111], v[88:91], v[44:47]
  v_add_f32 v125, 2.0, v109
  v_add_f32 v126, 2.0, v110
  s_waitcnt lgkmcnt(5)
  v_mfma_f32_16x16x32_bf16 v[32:35], a[112:115], v[92:95], v[32:35]
  ds_read_b128 v[84:87], v10 offset:46080
  v_add_f32 v127, 2.0, v111
  v_fma_f32 v96, v96, v112, 2.0
  v_mfma_f32_16x16x32_bf16 v[36:39], a[116:119], v[92:95], v[36:39]
  v_fma_f32 v97, v97, v113, 2.0
  v_fma_f32 v98, v98, v114, 2.0
  v_mfma_f32_16x16x32_bf16 v[40:43], a[120:123], v[92:95], v[40:43]
  buffer_load_dwordx4 v[228:231], v6, s[20:23], s44 offen offset:1024 sc1
  v_fma_f32 v99, v99, v115, 2.0
  v_fma_f32 v100, v100, v116, 2.0
  v_fma_f32 v101, v101, v117, 2.0
  v_mfma_f32_16x16x32_bf16 v[44:47], a[124:127], v[92:95], v[44:47]
  v_fma_f32 v102, v102, v118, 2.0
  v_fma_f32 v103, v103, v119, 2.0
  s_waitcnt lgkmcnt(5)
  v_mfma_f32_16x16x32_bf16 v[32:35], a[128:131], v[64:67], v[32:35]
  ds_read_b128 v[88:91], v10 offset:47104
  v_fma_f32 v104, v104, v120, 2.0
  v_fma_f32 v105, v105, v121, 2.0
  v_mfma_f32_16x16x32_bf16 v[36:39], a[132:135], v[64:67], v[36:39]
  v_fma_f32 v106, v106, v122, 2.0
  v_fma_f32 v107, v107, v123, 2.0
  v_mfma_f32_16x16x32_bf16 v[40:43], a[136:139], v[64:67], v[40:43]
  buffer_load_dwordx4 v[232:235], v6, s[20:23], s44 offen offset:2048 sc1
  v_fma_f32 v108, v108, v124, 2.0
  v_fma_f32 v109, v109, v125, 2.0
  v_fma_f32 v110, v110, v126, 2.0
  v_mfma_f32_16x16x32_bf16 v[44:47], a[140:143], v[64:67], v[44:47]
  v_fma_f32 v111, v111, v127, 2.0
  s_waitcnt lgkmcnt(5)
  v_mfma_f32_16x16x32_bf16 v[32:35], a[144:147], v[68:71], v[32:35]
  ds_read_b128 v[92:95], v10 offset:48128
  v_rcp_f32 v96, v96
  v_mfma_f32_16x16x32_bf16 v[36:39], a[148:151], v[68:71], v[36:39]
  v_rcp_f32 v97, v97
  v_mfma_f32_16x16x32_bf16 v[40:43], a[152:155], v[68:71], v[40:43]
  buffer_load_dwordx4 v[236:239], v6, s[20:23], s44 offen offset:3072 sc1
  s_add_u32 s44, s44, 4096
  v_rcp_f32 v98, v98
  v_mfma_f32_16x16x32_bf16 v[44:47], a[156:159], v[68:71], v[44:47]
  v_rcp_f32 v99, v99
  s_waitcnt lgkmcnt(5)
  v_mfma_f32_16x16x32_bf16 v[32:35], a[160:163], v[72:75], v[32:35]
  ds_read_b128 v[64:67], v10 offset:49152
  v_rcp_f32 v100, v100
  v_mfma_f32_16x16x32_bf16 v[36:39], a[164:167], v[72:75], v[36:39]
  v_rcp_f32 v101, v101
  v_mfma_f32_16x16x32_bf16 v[40:43], a[168:171], v[72:75], v[40:43]
  buffer_load_dwordx4 v[240:243], v6, s[20:23], s44 offen offset:0 sc1
  v_rcp_f32 v102, v102
  v_mfma_f32_16x16x32_bf16 v[44:47], a[172:175], v[72:75], v[44:47]
  v_rcp_f32 v103, v103
  s_waitcnt lgkmcnt(5)
  v_mfma_f32_16x16x32_bf16 v[32:35], a[176:179], v[76:79], v[32:35]
  ds_read_b128 v[68:71], v10 offset:50176
  v_rcp_f32 v104, v104
  v_mfma_f32_16x16x32_bf16 v[36:39], a[180:183], v[76:79], v[36:39]
  v_rcp_f32 v105, v105
  v_mfma_f32_16x16x32_bf16 v[40:43], a[184:187], v[76:79], v[40:43]
  buffer_load_dwordx4 v[244:247], v6, s[20:23], s44 offen offset:1024 sc1
  v_rcp_f32 v106, v106
  v_mfma_f32_16x16x32_bf16 v[44:47], a[188:191], v[76:79], v[44:47]
  v_rcp_f32 v107, v107
  s_waitcnt lgkmcnt(5)
  v_mfma_f32_16x16x32_bf16 v[32:35], a[192:195], v[80:83], v[32:35]
  ds_read_b128 v[72:75], v10 offset:51200
  v_rcp_f32 v108, v108
  v_mfma_f32_16x16x32_bf16 v[36:39], a[196:199], v[80:83], v[36:39]
  v_rcp_f32 v109, v109
  v_mfma_f32_16x16x32_bf16 v[40:43], a[200:203], v[80:83], v[40:43]
  buffer_load_dwordx4 v[248:251], v6, s[20:23], s44 offen offset:2048 sc1
  v_rcp_f32 v110, v110
  v_mfma_f32_16x16x32_bf16 v[44:47], a[204:207], v[80:83], v[44:47]
  v_rcp_f32 v111, v111
  v_fma_f32 v96, v96, v130, v132
  s_waitcnt lgkmcnt(5)
  v_mfma_f32_16x16x32_bf16 v[32:35], a[208:211], v[84:87], v[32:35]
  ds_read_b128 v[76:79], v10 offset:52224
  v_fma_f32 v97, v97, v130, v132
  v_fma_f32 v98, v98, v130, v132
  v_mfma_f32_16x16x32_bf16 v[36:39], a[212:215], v[84:87], v[36:39]
  v_fma_f32 v99, v99, v130, v132
  v_fma_f32 v100, v100, v130, v132
  v_mfma_f32_16x16x32_bf16 v[40:43], a[216:219], v[84:87], v[40:43]
  buffer_load_dwordx4 v[252:255], v6, s[20:23], s44 offen offset:3072 sc1
  s_add_u32 s44, s44, 4096
  v_fma_f32 v101, v101, v130, v132
  v_fma_f32 v102, v102, v130, v132
  v_fma_f32 v103, v103, v130, v132
  v_mfma_f32_16x16x32_bf16 v[44:47], a[220:223], v[84:87], v[44:47]
  v_fma_f32 v104, v104, v130, v132
  v_fma_f32 v105, v105, v130, v132
  s_waitcnt lgkmcnt(5)
  v_mfma_f32_16x16x32_bf16 v[32:35], a[224:227], v[88:91], v[32:35]
  ds_read_b128 v[80:83], v10 offset:53248
  v_fma_f32 v106, v106, v130, v132
  v_fma_f32 v107, v107, v130, v132
  v_mfma_f32_16x16x32_bf16 v[36:39], a[228:231], v[88:91], v[36:39]
  v_fma_f32 v108, v108, v130, v132
  v_fma_f32 v109, v109, v130, v132
  v_mfma_f32_16x16x32_bf16 v[40:43], a[232:235], v[88:91], v[40:43]
  v_fma_f32 v110, v110, v130, v132
  v_fma_f32 v111, v111, v130, v132
  v_mul_f32 v96, v96, v48
  v_mfma_f32_16x16x32_bf16 v[44:47], a[236:239], v[88:91], v[44:47]
  v_mul_f32 v97, v97, v49
  v_mul_f32 v98, v98, v50
  s_waitcnt lgkmcnt(5)
  v_mfma_f32_16x16x32_bf16 v[32:35], a[240:243], v[92:95], v[32:35]
  ds_read_b128 v[84:87], v10 offset:54272
  v_mul_f32 v99, v99, v51
  v_mul_f32 v100, v100, v52
  v_mfma_f32_16x16x32_bf16 v[36:39], a[244:247], v[92:95], v[36:39]
  v_mul_f32 v101, v101, v53
  v_mul_f32 v102, v102, v54
  v_mfma_f32_16x16x32_bf16 v[40:43], a[248:251], v[92:95], v[40:43]
  v_mul_f32 v103, v103, v55
  v_mul_f32 v104, v104, v56
  v_mul_f32 v105, v105, v57
  v_mfma_f32_16x16x32_bf16 v[44:47], a[252:255], v[92:95], v[44:47]
  v_mul_f32 v106, v106, v58
  v_mul_f32 v107, v107, v59
  v_mul_f32 v108, v108, v60
  v_mul_f32 v109, v109, v61
  v_mul_f32 v110, v110, v62
  v_mul_f32 v111, v111, v63
  v_cvt_pk_bf16_f32 v136, v96, v100
  v_cvt_pk_bf16_f32 v137, v104, v108
  v_cvt_pk_bf16_f32 v138, v97, v101
  v_cvt_pk_bf16_f32 v139, v105, v109
  buffer_store_dwordx4 v[136:139], v6, s[40:43], s12 offen offset:0 sc1
  v_cvt_pk_bf16_f32 v140, v98, v102
  v_cvt_pk_bf16_f32 v141, v106, v110
  v_cvt_pk_bf16_f32 v142, v99, v103
  v_cvt_pk_bf16_f32 v143, v107, v111
  buffer_store_dwordx4 v[140:143], v6, s[40:43], s12 offen offset:1024 sc1
  s_add_u32 s12, s12, 57344
  s_waitcnt lgkmcnt(5)
  v_mfma_f32_16x16x32_bf16 v[48:51], a[0:3], v[64:67], v[16:19]
  ds_read_b128 v[88:91], v10 offset:55296
  v_mfma_f32_16x16x32_bf16 v[52:55], a[4:7], v[64:67], v[20:23]
  v_mfma_f32_16x16x32_bf16 v[56:59], a[8:11], v[64:67], v[24:27]
  v_mfma_f32_16x16x32_bf16 v[60:63], a[12:15], v[64:67], v[28:31]
  s_waitcnt lgkmcnt(5)
  v_mfma_f32_16x16x32_bf16 v[48:51], a[16:19], v[68:71], v[48:51]
  ds_read_b128 v[92:95], v10 offset:56320
  v_mfma_f32_16x16x32_bf16 v[52:55], a[20:23], v[68:71], v[52:55]
  buffer_load_dwordx4 a[0:3], v6, s[20:23], s44 offen offset:0 sc1
  v_mfma_f32_16x16x32_bf16 v[56:59], a[24:27], v[68:71], v[56:59]
  v_exp_f32 v96, v32
  v_mfma_f32_16x16x32_bf16 v[60:63], a[28:31], v[68:71], v[60:63]
  v_exp_f32 v97, v33
  s_waitcnt lgkmcnt(5)
  v_mfma_f32_16x16x32_bf16 v[48:51], a[32:35], v[72:75], v[48:51]
  ds_read_b128 v[64:67], v10 offset:57344
  v_exp_f32 v98, v34
  v_mfma_f32_16x16x32_bf16 v[52:55], a[36:39], v[72:75], v[52:55]
  buffer_load_dwordx4 a[4:7], v6, s[20:23], s44 offen offset:1024 sc1
  v_exp_f32 v99, v35
  v_mfma_f32_16x16x32_bf16 v[56:59], a[40:43], v[72:75], v[56:59]
  v_exp_f32 v100, v36
  v_mfma_f32_16x16x32_bf16 v[60:63], a[44:47], v[72:75], v[60:63]
  v_exp_f32 v101, v37
  s_waitcnt lgkmcnt(5)
  v_mfma_f32_16x16x32_bf16 v[48:51], a[48:51], v[76:79], v[48:51]
  ds_read_b128 v[68:71], v10 offset:58368
  v_exp_f32 v102, v38
  v_mfma_f32_16x16x32_bf16 v[52:55], a[52:55], v[76:79], v[52:55]
  buffer_load_dwordx4 a[8:11], v6, s[20:23], s44 offen offset:2048 sc1
  v_exp_f32 v103, v39
  v_mfma_f32_16x16x32_bf16 v[56:59], a[56:59], v[76:79], v[56:59]
  v_exp_f32 v104, v40
  v_mfma_f32_16x16x32_bf16 v[60:63], a[60:63], v[76:79], v[60:63]
  v_exp_f32 v105, v41
  s_waitcnt lgkmcnt(5)
  v_mfma_f32_16x16x32_bf16 v[48:51], a[64:67], v[80:83], v[48:51]
  ds_read_b128 v[72:75], v10 offset:59392
  v_exp_f32 v106, v42
  v_mfma_f32_16x16x32_bf16 v[52:55], a[68:71], v[80:83], v[52:55]
  buffer_load_dwordx4 a[12:15], v6, s[20:23], s44 offen offset:3072 sc1
  s_add_u32 s44, s44, 4096
  v_exp_f32 v107, v43
  v_mfma_f32_16x16x32_bf16 v[56:59], a[72:75], v[80:83], v[56:59]
  v_exp_f32 v108, v44
  v_mfma_f32_16x16x32_bf16 v[60:63], a[76:79], v[80:83], v[60:63]
  v_exp_f32 v109, v45
  s_waitcnt lgkmcnt(5)
  v_mfma_f32_16x16x32_bf16 v[48:51], a[80:83], v[84:87], v[48:51]
  ds_read_b128 v[76:79], v10 offset:60416
  v_exp_f32 v110, v46
  v_mfma_f32_16x16x32_bf16 v[52:55], a[84:87], v[84:87], v[52:55]
  buffer_load_dwordx4 a[16:19], v6, s[20:23], s44 offen offset:0 sc1
  v_exp_f32 v111, v47
  v_add_f32 v112, 2.0, v96
  v_mfma_f32_16x16x32_bf16 v[56:59], a[88:91], v[84:87], v[56:59]
  v_add_f32 v113, 2.0, v97
  v_add_f32 v114, 2.0, v98
  v_add_f32 v115, 2.0, v99
  v_mfma_f32_16x16x32_bf16 v[60:63], a[92:95], v[84:87], v[60:63]
  v_add_f32 v116, 2.0, v100
  v_add_f32 v117, 2.0, v101
  s_waitcnt lgkmcnt(5)
  v_mfma_f32_16x16x32_bf16 v[48:51], a[96:99], v[88:91], v[48:51]
  ds_read_b128 v[80:83], v10 offset:61440
  v_add_f32 v118, 2.0, v102
  v_add_f32 v119, 2.0, v103
  v_mfma_f32_16x16x32_bf16 v[52:55], a[100:103], v[88:91], v[52:55]
  buffer_load_dwordx4 a[20:23], v6, s[20:23], s44 offen offset:1024 sc1
  v_add_f32 v120, 2.0, v104
  v_add_f32 v121, 2.0, v105
  v_mfma_f32_16x16x32_bf16 v[56:59], a[104:107], v[88:91], v[56:59]
  v_add_f32 v122, 2.0, v106
  v_add_f32 v123, 2.0, v107
  v_add_f32 v124, 2.0, v108
  v_mfma_f32_16x16x32_bf16 v[60:63], a[108:111], v[88:91], v[60:63]
  v_add_f32 v125, 2.0, v109
  v_add_f32 v126, 2.0, v110
  s_waitcnt lgkmcnt(5)
  v_mfma_f32_16x16x32_bf16 v[48:51], a[112:115], v[92:95], v[48:51]
  ds_read_b128 v[84:87], v10 offset:62464
  v_add_f32 v127, 2.0, v111
  v_fma_f32 v96, v96, v112, 2.0
  v_mfma_f32_16x16x32_bf16 v[52:55], a[116:119], v[92:95], v[52:55]
  buffer_load_dwordx4 a[24:27], v6, s[20:23], s44 offen offset:2048 sc1
  v_fma_f32 v97, v97, v113, 2.0
  v_fma_f32 v98, v98, v114, 2.0
  v_mfma_f32_16x16x32_bf16 v[56:59], a[120:123], v[92:95], v[56:59]
  v_fma_f32 v99, v99, v115, 2.0
  v_fma_f32 v100, v100, v116, 2.0
  v_fma_f32 v101, v101, v117, 2.0
  v_mfma_f32_16x16x32_bf16 v[60:63], a[124:127], v[92:95], v[60:63]
  v_fma_f32 v102, v102, v118, 2.0
  v_fma_f32 v103, v103, v119, 2.0
  s_waitcnt lgkmcnt(5)
  v_mfma_f32_16x16x32_bf16 v[48:51], a[128:131], v[64:67], v[48:51]
  ds_read_b128 v[88:91], v10 offset:63488
  v_fma_f32 v104, v104, v120, 2.0
  v_fma_f32 v105, v105, v121, 2.0
  v_mfma_f32_16x16x32_bf16 v[52:55], a[132:135], v[64:67], v[52:55]
  buffer_load_dwordx4 a[28:31], v6, s[20:23], s44 offen offset:3072 sc1
  s_add_u32 s44, s44, 4096
  v_fma_f32 v106, v106, v122, 2.0
  v_fma_f32 v107, v107, v123, 2.0
  v_mfma_f32_16x16x32_bf16 v[56:59], a[136:139], v[64:67], v[56:59]
  v_fma_f32 v108, v108, v124, 2.0
  v_fma_f32 v109, v109, v125, 2.0
  v_fma_f32 v110, v110, v126, 2.0
  v_mfma_f32_16x16x32_bf16 v[60:63], a[140:143], v[64:67], v[60:63]
  v_fma_f32 v111, v111, v127, 2.0
  s_waitcnt lgkmcnt(5)
  v_mfma_f32_16x16x32_bf16 v[48:51], a[144:147], v[68:71], v[48:51]
  ds_read_b128 v[92:95], v10 offset:64512
  v_rcp_f32 v96, v96
  v_mfma_f32_16x16x32_bf16 v[52:55], a[148:151], v[68:71], v[52:55]
  buffer_load_dwordx4 a[32:35], v6, s[20:23], s44 offen offset:0 sc1
  v_rcp_f32 v97, v97
  v_mfma_f32_16x16x32_bf16 v[56:59], a[152:155], v[68:71], v[56:59]
  v_rcp_f32 v98, v98
  v_mfma_f32_16x16x32_bf16 v[60:63], a[156:159], v[68:71], v[60:63]
  v_rcp_f32 v99, v99
  s_waitcnt lgkmcnt(5)
  v_mfma_f32_16x16x32_bf16 v[48:51], a[160:163], v[72:75], v[48:51]
  v_rcp_f32 v100, v100
  v_mfma_f32_16x16x32_bf16 v[52:55], a[164:167], v[72:75], v[52:55]
  buffer_load_dwordx4 a[36:39], v6, s[20:23], s44 offen offset:1024 sc1
  v_rcp_f32 v101, v101
  v_mfma_f32_16x16x32_bf16 v[56:59], a[168:171], v[72:75], v[56:59]
  v_rcp_f32 v102, v102
  v_mfma_f32_16x16x32_bf16 v[60:63], a[172:175], v[72:75], v[60:63]
  v_rcp_f32 v103, v103
  s_waitcnt lgkmcnt(4)
  v_mfma_f32_16x16x32_bf16 v[48:51], a[176:179], v[76:79], v[48:51]
  v_rcp_f32 v104, v104
  v_mfma_f32_16x16x32_bf16 v[52:55], a[180:183], v[76:79], v[52:55]
  buffer_load_dwordx4 a[40:43], v6, s[20:23], s44 offen offset:2048 sc1
  v_rcp_f32 v105, v105
  v_mfma_f32_16x16x32_bf16 v[56:59], a[184:187], v[76:79], v[56:59]
  v_rcp_f32 v106, v106
  v_mfma_f32_16x16x32_bf16 v[60:63], a[188:191], v[76:79], v[60:63]
  v_rcp_f32 v107, v107
  s_waitcnt lgkmcnt(3)
  v_mfma_f32_16x16x32_bf16 v[48:51], a[192:195], v[80:83], v[48:51]
  v_rcp_f32 v108, v108
  v_mfma_f32_16x16x32_bf16 v[52:55], a[196:199], v[80:83], v[52:55]
  buffer_load_dwordx4 a[44:47], v6, s[20:23], s44 offen offset:3072 sc1
  s_add_u32 s44, s44, 4096
  v_rcp_f32 v109, v109
  v_mfma_f32_16x16x32_bf16 v[56:59], a[200:203], v[80:83], v[56:59]
  v_rcp_f32 v110, v110
  v_mfma_f32_16x16x32_bf16 v[60:63], a[204:207], v[80:83], v[60:63]
  v_rcp_f32 v111, v111
  v_fma_f32 v96, v96, v130, v132
  s_waitcnt lgkmcnt(2)
  v_mfma_f32_16x16x32_bf16 v[48:51], a[208:211], v[84:87], v[48:51]
  v_fma_f32 v97, v97, v130, v132
  v_fma_f32 v98, v98, v130, v132
  v_fma_f32 v99, v99, v130, v132
  v_mfma_f32_16x16x32_bf16 v[52:55], a[212:215], v[84:87], v[52:55]
  v_fma_f32 v100, v100, v130, v132
  v_fma_f32 v101, v101, v130, v132
  v_mfma_f32_16x16x32_bf16 v[56:59], a[216:219], v[84:87], v[56:59]
  v_fma_f32 v102, v102, v130, v132
  v_fma_f32 v103, v103, v130, v132
  v_fma_f32 v104, v104, v130, v132
  v_mfma_f32_16x16x32_bf16 v[60:63], a[220:223], v[84:87], v[60:63]
  v_fma_f32 v105, v105, v130, v132
  v_fma_f32 v106, v106, v130, v132
  s_waitcnt lgkmcnt(1)
  v_mfma_f32_16x16x32_bf16 v[48:51], a[224:227], v[88:91], v[48:51]
  v_fma_f32 v107, v107, v130, v132
  v_fma_f32 v108, v108, v130, v132
  v_fma_f32 v109, v109, v130, v132
  v_mfma_f32_16x16x32_bf16 v[52:55], a[228:231], v[88:91], v[52:55]
  v_fma_f32 v110, v110, v130, v132
  v_fma_f32 v111, v111, v130, v132
  v_mfma_f32_16x16x32_bf16 v[56:59], a[232:235], v[88:91], v[56:59]
  v_mul_f32 v96, v96, v32
  v_mul_f32 v97, v97, v33
  v_mul_f32 v98, v98, v34
  v_mfma_f32_16x16x32_bf16 v[60:63], a[236:239], v[88:91], v[60:63]
  v_mul_f32 v99, v99, v35
  v_mul_f32 v100, v100, v36
  s_waitcnt lgkmcnt(0)
  v_mfma_f32_16x16x32_bf16 v[48:51], a[240:243], v[92:95], v[48:51]
  v_mul_f32 v101, v101, v37
  v_mul_f32 v102, v102, v38
  v_mul_f32 v103, v103, v39
  v_mfma_f32_16x16x32_bf16 v[52:55], a[244:247], v[92:95], v[52:55]
  v_mul_f32 v104, v104, v40
  v_mul_f32 v105, v105, v41
  v_mfma_f32_16x16x32_bf16 v[56:59], a[248:251], v[92:95], v[56:59]
  v_mul_f32 v106, v106, v42
  v_mul_f32 v107, v107, v43
  v_mul_f32 v108, v108, v44
  v_mfma_f32_16x16x32_bf16 v[60:63], a[252:255], v[92:95], v[60:63]
  v_mul_f32 v109, v109, v45
  v_mul_f32 v110, v110, v46
  v_mul_f32 v111, v111, v47
  v_cvt_pk_bf16_f32 v136, v96, v100
  v_cvt_pk_bf16_f32 v137, v104, v108
  v_cvt_pk_bf16_f32 v138, v97, v101
  v_cvt_pk_bf16_f32 v139, v105, v109
  buffer_store_dwordx4 v[136:139], v6, s[40:43], s12 offen offset:0 sc1
  v_cvt_pk_bf16_f32 v140, v98, v102
  v_cvt_pk_bf16_f32 v141, v106, v110
  v_cvt_pk_bf16_f32 v142, v99, v103
  v_cvt_pk_bf16_f32 v143, v107, v111
  buffer_store_dwordx4 v[140:143], v6, s[40:43], s12 offen offset:1024 sc1
  s_add_u32 s12, s12, 57344
  s_waitcnt vmcnt(14)
  s_barrier
  s_lshl_b32 s13, s17, 7
  s_lshl_b32 s45, s18, 2
  s_add_u32 s13, s13, s45
  s_add_u32 s13, s13, 4128
  s_cmp_eq_u32 s16, 0
  s_cbranch_scc0 SIG_43
  v_mov_b32 v10, s54
  v_mov_b32 v11, 0
  buffer_store_dword v10, v11, s[56:59], s13 offen sc1
SIG_43:
  s_nop 7
  s_nop 1
  v_exp_f32 v96, v48
  v_exp_f32 v97, v49
  v_exp_f32 v98, v50
  v_exp_f32 v99, v51
  v_exp_f32 v100, v52
  v_exp_f32 v101, v53
  v_exp_f32 v102, v54
  v_exp_f32 v103, v55
  v_exp_f32 v104, v56
  v_exp_f32 v105, v57
  v_exp_f32 v106, v58
  v_exp_f32 v107, v59
  v_exp_f32 v108, v60
  v_exp_f32 v109, v61
  v_exp_f32 v110, v62
  v_exp_f32 v111, v63
  v_pk_add_f32 v[112:113], v[96:97], v[128:129]
  v_pk_add_f32 v[114:115], v[98:99], v[128:129]
  v_pk_add_f32 v[116:117], v[100:101], v[128:129]
  v_pk_add_f32 v[118:119], v[102:103], v[128:129]
  v_pk_add_f32 v[120:121], v[104:105], v[128:129]
  v_pk_add_f32 v[122:123], v[106:107], v[128:129]
  v_pk_add_f32 v[124:125], v[108:109], v[128:129]
  v_pk_add_f32 v[126:127], v[110:111], v[128:129]
  v_pk_fma_f32 v[96:97], v[96:97], v[112:113], v[128:129]
  v_pk_fma_f32 v[98:99], v[98:99], v[114:115], v[128:129]
  v_pk_fma_f32 v[100:101], v[100:101], v[116:117], v[128:129]
  v_pk_fma_f32 v[102:103], v[102:103], v[118:119], v[128:129]
  v_pk_fma_f32 v[104:105], v[104:105], v[120:121], v[128:129]
  v_pk_fma_f32 v[106:107], v[106:107], v[122:123], v[128:129]
  v_pk_fma_f32 v[108:109], v[108:109], v[124:125], v[128:129]
  v_pk_fma_f32 v[110:111], v[110:111], v[126:127], v[128:129]
  v_rcp_f32 v96, v96
  v_rcp_f32 v97, v97
  v_rcp_f32 v98, v98
  v_rcp_f32 v99, v99
  v_rcp_f32 v100, v100
  v_rcp_f32 v101, v101
  v_rcp_f32 v102, v102
  v_rcp_f32 v103, v103
  v_rcp_f32 v104, v104
  v_rcp_f32 v105, v105
  v_rcp_f32 v106, v106
  v_rcp_f32 v107, v107
  v_rcp_f32 v108, v108
  v_rcp_f32 v109, v109
  v_rcp_f32 v110, v110
  v_rcp_f32 v111, v111
  v_pk_fma_f32 v[96:97], v[96:97], v[130:131], v[132:133]
  v_pk_fma_f32 v[98:99], v[98:99], v[130:131], v[132:133]
  v_pk_fma_f32 v[100:101], v[100:101], v[130:131], v[132:133]
  v_pk_fma_f32 v[102:103], v[102:103], v[130:131], v[132:133]
  v_pk_fma_f32 v[104:105], v[104:105], v[130:131], v[132:133]
  v_pk_fma_f32 v[106:107], v[106:107], v[130:131], v[132:133]
  v_pk_fma_f32 v[108:109], v[108:109], v[130:131], v[132:133]
  v_pk_fma_f32 v[110:111], v[110:111], v[130:131], v[132:133]
  v_pk_mul_f32 v[96:97], v[96:97], v[48:49]
  v_pk_mul_f32 v[98:99], v[98:99], v[50:51]
  v_pk_mul_f32 v[100:101], v[100:101], v[52:53]
  v_pk_mul_f32 v[102:103], v[102:103], v[54:55]
  v_pk_mul_f32 v[104:105], v[104:105], v[56:57]
  v_pk_mul_f32 v[106:107], v[106:107], v[58:59]
  v_pk_mul_f32 v[108:109], v[108:109], v[60:61]
  v_pk_mul_f32 v[110:111], v[110:111], v[62:63]
  v_cvt_pk_bf16_f32 v136, v96, v100
  v_cvt_pk_bf16_f32 v137, v104, v108
  v_cvt_pk_bf16_f32 v138, v97, v101
  v_cvt_pk_bf16_f32 v139, v105, v109
  buffer_store_dwordx4 v[136:139], v6, s[40:43], s12 offen offset:0 sc1
  v_cvt_pk_bf16_f32 v140, v98, v102
  v_cvt_pk_bf16_f32 v141, v106, v110
  v_cvt_pk_bf16_f32 v142, v99, v103
  v_cvt_pk_bf16_f32 v143, v107, v111
  buffer_store_dwordx4 v[140:143], v6, s[40:43], s12 offen offset:1024 sc1
  s_add_u32 s12, s12, 57344
  s_lshl_b32 s13, s17, 7
  s_lshl_b32 s12, s18, 2
  s_add_u32 s13, s13, s12
  s_add_u32 s13, s13, 4096
  s_and_b32 s46, s2, 7
  s_lshl_b32 s46, s46, 2
  s_bfe_u32 s45, s2, 0x20003
  s_add_u32 s46, s46, s45
  s_lshl_b32 s46, s46, 7
  s_add_u32 s46, s46, 4128
  v_and_b32 v7, 7, v2
  v_min_u32 v7, 6, v7
  v_lshlrev_b32 v7, 2, v7
  s_cmp_eq_u32 s16, 0
  s_cbranch_scc0 WFS_46
  s_mov_b32 s55, 0x4000
  buffer_load_dword v8, v7, s[56:59], s46 offen sc1
WF_44:
  s_waitcnt vmcnt(0)
  v_cmp_ne_u32 vcc, s54, v8
  s_nop 1
  s_cmp_eq_u64 vcc, 0
  s_cbranch_scc1 WFD_45
  buffer_load_dword v8, v7, s[56:59], s46 offen sc1
  s_sub_u32 s55, s55, 1
  s_cmp_eq_u32 s55, 0
  s_cbranch_scc0 WF_44
WFD_45:
WFS_46:
  buffer_load_dwordx4 a[48:51], v6, s[20:23], s44 offen offset:0 sc1
  buffer_load_dwordx4 a[52:55], v6, s[20:23], s44 offen offset:1024 sc1
  buffer_load_dwordx4 a[56:59], v6, s[20:23], s44 offen offset:2048 sc1
  buffer_load_dwordx4 a[60:63], v6, s[20:23], s44 offen offset:3072 sc1
  s_add_u32 s44, s44, 4096
  buffer_load_dwordx4 a[64:67], v6, s[20:23], s44 offen offset:0 sc1
  buffer_load_dwordx4 a[68:71], v6, s[20:23], s44 offen offset:1024 sc1
  buffer_load_dwordx4 a[72:75], v6, s[20:23], s44 offen offset:2048 sc1
  buffer_load_dwordx4 a[76:79], v6, s[20:23], s44 offen offset:3072 sc1
  s_add_u32 s44, s44, 4096
  buffer_load_dwordx4 a[80:83], v6, s[20:23], s44 offen offset:0 sc1
  buffer_load_dwordx4 a[84:87], v6, s[20:23], s44 offen offset:1024 sc1
  buffer_load_dwordx4 a[88:91], v6, s[20:23], s44 offen offset:2048 sc1
  buffer_load_dwordx4 a[92:95], v6, s[20:23], s44 offen offset:3072 sc1
  s_add_u32 s44, s44, 4096
  buffer_load_dwordx4 a[96:99], v6, s[20:23], s44 offen offset:0 sc1
  buffer_load_dwordx4 a[100:103], v6, s[20:23], s44 offen offset:1024 sc1
  buffer_load_dwordx4 a[104:107], v6, s[20:23], s44 offen offset:2048 sc1
  buffer_load_dwordx4 a[108:111], v6, s[20:23], s44 offen offset:3072 sc1
  s_add_u32 s44, s44, 4096
  s_waitcnt vmcnt(16) lgkmcnt(0)
  s_barrier
  s_cmp_eq_u32 s16, 0
  s_cbranch_scc0 SIG_47
  v_mov_b32 v1, s54
  v_mov_b32 v2, 0
  buffer_store_dword v1, v2, s[56:59], s13 offen sc1
SIG_47:
SKIP_G1_27:
  s_load_dwordx2 s[4:5], s[0:1], 96
  s_load_dwordx2 s[6:7], s[0:1], 80
  v_lshrrev_b32 v1, 6, v0
  v_and_b32 v2, 63, v0
  s_and_b32 s17, s2, 7
  v_readfirstlane_b32 s16, v1
  s_lshl_b32 s17, s17, 2
  s_bfe_u32 s12, s2, 0x20003
  s_add_u32 s17, s17, s12
  s_lshr_b32 s18, s2, 5
  v_lshlrev_b32 v3, 4, v2
  s_waitcnt lgkmcnt(0)
  s_add_u32 s20, s4, 0x600000
  s_addc_u32 s21, s5, 0
  s_mov_b32 s22, 0x1c0000
  s_mov_b32 s23, 0x20000
  s_add_u32 s24, s4, 0x800000
  s_addc_u32 s25, s5, 0
  s_mov_b32 s26, 0x700000
  s_mov_b32 s27, 0x20000
  s_add_u32 s28, s4, 0x1000000
  s_addc_u32 s29, s5, 0
  s_mov_b32 s30, 0x200000
  s_mov_b32 s31, 0x20000
  s_add_u32 s32, s4, 0x1200000
  s_addc_u32 s33, s5, 0
  s_mov_b32 s34, 0x200000
  s_mov_b32 s35, 0x20000
  s_mul_i32 s12, s18, 56
  s_mul_i32 s13, s16, 14
  s_add_u32 s12, s12, s13
  s_lshl_b32 s12, s12, 12
  s_mul_i32 s14, s17, 229376
  s_lshl_b32 s13, s13, 10
  s_add_u32 s14, s14, s13
  s_add_u32 s15, s14, 57344
  s_add_u32 s40, s15, 57344
  s_add_u32 s41, s40, 57344
  v_and_b32 v4, 15, v2
  v_lshrrev_b32 v5, 4, v2
  v_lshlrev_b32 v6, 4, v4
  v_lshl_add_u32 v6, v5, 9, v6
  s_lshl_b32 s42, s17, 2
  s_add_u32 s42, s42, s16
  s_lshl_b32 s42, s42, 14
  s_lshl_b32 s43, s18, 11
  s_add_u32 s43, s43, s42
  s_cmp_ge_u32 s2, 224
  s_cbranch_scc0 G2_PRE_48
  buffer_load_dwordx4 v[144:147], v3, s[20:23], s12 offen offset:0 sc1
  buffer_load_dwordx4 v[148:151], v3, s[20:23], s12 offen offset:1024 sc1
  buffer_load_dwordx4 v[152:155], v3, s[20:23], s12 offen offset:2048 sc1
  buffer_load_dwordx4 v[156:159], v3, s[20:23], s12 offen offset:3072 sc1
  s_add_u32 s12, s12, 4096
  buffer_load_dwordx4 v[160:163], v3, s[20:23], s12 offen offset:0 sc1
  buffer_load_dwordx4 v[164:167], v3, s[20:23], s12 offen offset:1024 sc1
  buffer_load_dwordx4 v[168:171], v3, s[20:23], s12 offen offset:2048 sc1
  buffer_load_dwordx4 v[172:175], v3, s[20:23], s12 offen offset:3072 sc1
  s_add_u32 s12, s12, 4096
  buffer_load_dwordx4 v[176:179], v3, s[20:23], s12 offen offset:0 sc1
  buffer_load_dwordx4 v[180:183], v3, s[20:23], s12 offen offset:1024 sc1
  buffer_load_dwordx4 v[184:187], v3, s[20:23], s12 offen offset:2048 sc1
  buffer_load_dwordx4 v[188:191], v3, s[20:23], s12 offen offset:3072 sc1
  s_add_u32 s12, s12, 4096
  buffer_load_dwordx4 v[192:195], v3, s[20:23], s12 offen offset:0 sc1
  buffer_load_dwordx4 v[196:199], v3, s[20:23], s12 offen offset:1024 sc1
  buffer_load_dwordx4 v[200:203], v3, s[20:23], s12 offen offset:2048 sc1
  buffer_load_dwordx4 v[204:207], v3, s[20:23], s12 offen offset:3072 sc1
  s_add_u32 s12, s12, 4096
  buffer_load_dwordx4 v[208:211], v3, s[20:23], s12 offen offset:0 sc1
  buffer_load_dwordx4 v[212:215], v3, s[20:23], s12 offen offset:1024 sc1
  buffer_load_dwordx4 v[216:219], v3, s[20:23], s12 offen offset:2048 sc1
  buffer_load_dwordx4 v[220:223], v3, s[20:23], s12 offen offset:3072 sc1
  s_add_u32 s12, s12, 4096
  buffer_load_dwordx4 v[224:227], v3, s[20:23], s12 offen offset:0 sc1
  buffer_load_dwordx4 v[228:231], v3, s[20:23], s12 offen offset:1024 sc1
  buffer_load_dwordx4 v[232:235], v3, s[20:23], s12 offen offset:2048 sc1
  buffer_load_dwordx4 v[236:239], v3, s[20:23], s12 offen offset:3072 sc1
  s_add_u32 s12, s12, 4096
  buffer_load_dwordx4 v[240:243], v3, s[20:23], s12 offen offset:0 sc1
  buffer_load_dwordx4 v[244:247], v3, s[20:23], s12 offen offset:1024 sc1
  buffer_load_dwordx4 v[248:251], v3, s[20:23], s12 offen offset:2048 sc1
  buffer_load_dwordx4 v[252:255], v3, s[20:23], s12 offen offset:3072 sc1
  s_add_u32 s12, s12, 4096
  buffer_load_dwordx4 a[0:3], v3, s[20:23], s12 offen offset:0 sc1
  buffer_load_dwordx4 a[4:7], v3, s[20:23], s12 offen offset:1024 sc1
  buffer_load_dwordx4 a[8:11], v3, s[20:23], s12 offen offset:2048 sc1
  buffer_load_dwordx4 a[12:15], v3, s[20:23], s12 offen offset:3072 sc1
  s_add_u32 s12, s12, 4096
  buffer_load_dwordx4 a[16:19], v3, s[20:23], s12 offen offset:0 sc1
  buffer_load_dwordx4 a[20:23], v3, s[20:23], s12 offen offset:1024 sc1
  buffer_load_dwordx4 a[24:27], v3, s[20:23], s12 offen offset:2048 sc1
  buffer_load_dwordx4 a[28:31], v3, s[20:23], s12 offen offset:3072 sc1
  s_add_u32 s12, s12, 4096
  buffer_load_dwordx4 a[32:35], v3, s[20:23], s12 offen offset:0 sc1
  buffer_load_dwordx4 a[36:39], v3, s[20:23], s12 offen offset:1024 sc1
  buffer_load_dwordx4 a[40:43], v3, s[20:23], s12 offen offset:2048 sc1
  buffer_load_dwordx4 a[44:47], v3, s[20:23], s12 offen offset:3072 sc1
  s_add_u32 s12, s12, 4096
  buffer_load_dwordx4 a[48:51], v3, s[20:23], s12 offen offset:0 sc1
  buffer_load_dwordx4 a[52:55], v3, s[20:23], s12 offen offset:1024 sc1
  buffer_load_dwordx4 a[56:59], v3, s[20:23], s12 offen offset:2048 sc1
  buffer_load_dwordx4 a[60:63], v3, s[20:23], s12 offen offset:3072 sc1
  s_add_u32 s12, s12, 4096
  buffer_load_dwordx4 a[64:67], v3, s[20:23], s12 offen offset:0 sc1
  buffer_load_dwordx4 a[68:71], v3, s[20:23], s12 offen offset:1024 sc1
  buffer_load_dwordx4 a[72:75], v3, s[20:23], s12 offen offset:2048 sc1
  buffer_load_dwordx4 a[76:79], v3, s[20:23], s12 offen offset:3072 sc1
  s_add_u32 s12, s12, 4096
  buffer_load_dwordx4 a[80:83], v3, s[20:23], s12 offen offset:0 sc1
  buffer_load_dwordx4 a[84:87], v3, s[20:23], s12 offen offset:1024 sc1
  buffer_load_dwordx4 a[88:91], v3, s[20:23], s12 offen offset:2048 sc1
  buffer_load_dwordx4 a[92:95], v3, s[20:23], s12 offen offset:3072 sc1
  s_add_u32 s12, s12, 4096
  buffer_load_dwordx4 a[96:99], v3, s[20:23], s12 offen offset:0 sc1
  buffer_load_dwordx4 a[100:103], v3, s[20:23], s12 offen offset:1024 sc1
  buffer_load_dwordx4 a[104:107], v3, s[20:23], s12 offen offset:2048 sc1
  buffer_load_dwordx4 a[108:111], v3, s[20:23], s12 offen offset:3072 sc1
  s_add_u32 s12, s12, 4096
G2_PRE_48:
  v_mov_b32 v16, 0
  v_mov_b32 v17, 0
  v_mov_b32 v18, 0
  v_mov_b32 v19, 0
  v_mov_b32 v20, 0
  v_mov_b32 v21, 0
  v_mov_b32 v22, 0
  v_mov_b32 v23, 0
  v_mov_b32 v24, 0
  v_mov_b32 v25, 0
  v_mov_b32 v26, 0
  v_mov_b32 v27, 0
  v_mov_b32 v28, 0
  v_mov_b32 v29, 0
  v_mov_b32 v30, 0
  v_mov_b32 v31, 0
  v_mov_b32 v32, 0
  v_mov_b32 v33, 0
  v_mov_b32 v34, 0
  v_mov_b32 v35, 0
  v_mov_b32 v36, 0
  v_mov_b32 v37, 0
  v_mov_b32 v38, 0
  v_mov_b32 v39, 0
  v_mov_b32 v40, 0
  v_mov_b32 v41, 0
  v_mov_b32 v42, 0
  v_mov_b32 v43, 0
  v_mov_b32 v44, 0
  v_mov_b32 v45, 0
  v_mov_b32 v46, 0
  v_mov_b32 v47, 0
  v_mov_b32 v48, 0
  v_mov_b32 v49, 0
  v_mov_b32 v50, 0
  v_mov_b32 v51, 0
  v_mov_b32 v52, 0
  v_mov_b32 v53, 0
  v_mov_b32 v54, 0
  v_mov_b32 v55, 0
  v_mov_b32 v56, 0
  v_mov_b32 v57, 0
  v_mov_b32 v58, 0
  v_mov_b32 v59, 0
  v_mov_b32 v60, 0
  v_mov_b32 v61, 0
  v_mov_b32 v62, 0
  v_mov_b32 v63, 0
  v_mov_b32 v64, 0
  v_mov_b32 v65, 0
  v_mov_b32 v66, 0
  v_mov_b32 v67, 0
  v_mov_b32 v68, 0
  v_mov_b32 v69, 0
  v_mov_b32 v70, 0
  v_mov_b32 v71, 0
  v_mov_b32 v72, 0
  v_mov_b32 v73, 0
  v_mov_b32 v74, 0
  v_mov_b32 v75, 0
  v_mov_b32 v76, 0
  v_mov_b32 v77, 0
  v_mov_b32 v78, 0
  v_mov_b32 v79, 0
  v_and_b32 v7, 7, v2
  v_min_u32 v7, 6, v7
  v_lshlrev_b32 v7, 2, v7
  s_lshl_b32 s13, s17, 7
  s_add_u32 s13, s13, 4096
  s_cmp_ge_u32 s2, 224
  s_cbranch_scc0 G2_A_49
  s_add_u32 s44, s13, 32
  s_cmp_eq_u32 s16, 0
  s_cbranch_scc0 WFS_52
  s_mov_b32 s55, 0x4000
  buffer_load_dword v80, v7, s[56:59], s44 offen sc1
WF_50:
  s_waitcnt vmcnt(0)
  v_cmp_ne_u32 vcc, s54, v80
  s_nop 1
  s_cmp_eq_u64 vcc, 0
  s_cbranch_scc1 WFD_51
  buffer_load_dword v80, v7, s[56:59], s44 offen sc1
  s_sub_u32 s55, s55, 1
  s_cmp_eq_u32 s55, 0
  s_cbranch_scc0 WF_50
WFD_51:
WFS_52:
  s_barrier
G2_A_49:
  buffer_load_dwordx4 v[8:11], v6, s[28:31], s43 offen sc1
  buffer_load_dwordx4 v[12:15], v6, s[28:31], s43 offen offset:256 sc1
  buffer_load_dwordx4 a[112:115], v3, s[24:27], s14 offen sc1
  s_add_u32 s14, s14, 1024
  buffer_load_dwordx4 a[116:119], v3, s[24:27], s15 offen sc1
  s_add_u32 s15, s15, 1024
  buffer_load_dwordx4 a[120:123], v3, s[24:27], s14 offen sc1
  s_add_u32 s14, s14, 1024
  buffer_load_dwordx4 a[124:127], v3, s[24:27], s15 offen sc1
  s_add_u32 s15, s15, 1024
  buffer_load_dwordx4 a[128:131], v3, s[24:27], s14 offen sc1
  s_add_u32 s14, s14, 1024
  buffer_load_dwordx4 a[132:135], v3, s[24:27], s15 offen sc1
  s_add_u32 s15, s15, 1024
  buffer_load_dwordx4 a[136:139], v3, s[24:27], s14 offen sc1
  s_add_u32 s14, s14, 1024
  buffer_load_dwordx4 a[140:143], v3, s[24:27], s15 offen sc1
  s_add_u32 s15, s15, 1024
  buffer_load_dwordx4 a[144:147], v3, s[24:27], s14 offen sc1
  s_add_u32 s14, s14, 1024
  buffer_load_dwordx4 a[148:151], v3, s[24:27], s15 offen sc1
  s_add_u32 s15, s15, 1024
  buffer_load_dwordx4 a[152:155], v3, s[24:27], s14 offen sc1
  s_add_u32 s14, s14, 1024
  buffer_load_dwordx4 a[156:159], v3, s[24:27], s15 offen sc1
  s_add_u32 s15, s15, 1024
  buffer_load_dwordx4 a[160:163], v3, s[24:27], s14 offen sc1
  s_add_u32 s14, s14, 1024
  buffer_load_dwordx4 a[164:167], v3, s[24:27], s15 offen sc1
  s_add_u32 s15, s15, 1024
  buffer_load_dwordx4 a[168:171], v3, s[24:27], s14 offen sc1
  s_add_u32 s14, s14, 1024
  buffer_load_dwordx4 a[172:175], v3, s[24:27], s15 offen sc1
  s_add_u32 s15, s15, 1024
  s_waitcnt vmcnt(14)
  v_mfma_f32_16x16x32_bf16 v[16:19], v[144:147], a[112:115], v[16:19]
  v_mfma_f32_16x16x32_bf16 v[20:23], v[148:151], a[112:115], v[20:23]
  v_mfma_f32_16x16x32_bf16 v[24:27], v[152:155], a[112:115], v[24:27]
  v_mfma_f32_16x16x32_bf16 v[28:31], v[156:159], a[112:115], v[28:31]
  buffer_load_dwordx4 a[176:179], v3, s[24:27], s14 offen sc1
  s_add_u32 s14, s14, 1024
  v_mfma_f32_16x16x32_bf16 v[32:35], v[144:147], a[116:119], v[32:35]
  v_mfma_f32_16x16x32_bf16 v[36:39], v[148:151], a[116:119], v[36:39]
  v_mfma_f32_16x16x32_bf16 v[40:43], v[152:155], a[116:119], v[40:43]
  v_mfma_f32_16x16x32_bf16 v[44:47], v[156:159], a[116:119], v[44:47]
  buffer_load_dwordx4 a[180:183], v3, s[24:27], s15 offen sc1
  s_add_u32 s15, s15, 1024
  s_waitcnt vmcnt(14)
  v_mfma_f32_16x16x32_bf16 v[16:19], v[160:163], a[120:123], v[16:19]
  v_mfma_f32_16x16x32_bf16 v[20:23], v[164:167], a[120:123], v[20:23]
  v_mfma_f32_16x16x32_bf16 v[24:27], v[168:171], a[120:123], v[24:27]
  v_mfma_f32_16x16x32_bf16 v[28:31], v[172:175], a[120:123], v[28:31]
  buffer_load_dwordx4 a[184:187], v3, s[24:27], s14 offen sc1
  s_add_u32 s14, s14, 1024
  v_mfma_f32_16x16x32_bf16 v[32:35], v[160:163], a[124:127], v[32:35]
  v_mfma_f32_16x16x32_bf16 v[36:39], v[164:167], a[124:127], v[36:39]
  v_mfma_f32_16x16x32_bf16 v[40:43], v[168:171], a[124:127], v[40:43]
  v_mfma_f32_16x16x32_bf16 v[44:47], v[172:175], a[124:127], v[44:47]
  buffer_load_dwordx4 a[188:191], v3, s[24:27], s15 offen sc1
  s_add_u32 s15, s15, 1024
  s_waitcnt vmcnt(14)
  v_mfma_f32_16x16x32_bf16 v[16:19], v[176:179], a[128:131], v[16:19]
  v_mfma_f32_16x16x32_bf16 v[20:23], v[180:183], a[128:131], v[20:23]
  v_mfma_f32_16x16x32_bf16 v[24:27], v[184:187], a[128:131], v[24:27]
  v_mfma_f32_16x16x32_bf16 v[28:31], v[188:191], a[128:131], v[28:31]
  buffer_load_dwordx4 a[192:195], v3, s[24:27], s14 offen sc1
  s_add_u32 s14, s14, 1024
  v_mfma_f32_16x16x32_bf16 v[32:35], v[176:179], a[132:135], v[32:35]
  v_mfma_f32_16x16x32_bf16 v[36:39], v[180:183], a[132:135], v[36:39]
  v_mfma_f32_16x16x32_bf16 v[40:43], v[184:187], a[132:135], v[40:43]
  v_mfma_f32_16x16x32_bf16 v[44:47], v[188:191], a[132:135], v[44:47]
  buffer_load_dwordx4 a[196:199], v3, s[24:27], s15 offen sc1
  s_add_u32 s15, s15, 1024
  s_waitcnt vmcnt(14)
  v_mfma_f32_16x16x32_bf16 v[16:19], v[192:195], a[136:139], v[16:19]
  v_mfma_f32_16x16x32_bf16 v[20:23], v[196:199], a[136:139], v[20:23]
  v_mfma_f32_16x16x32_bf16 v[24:27], v[200:203], a[136:139], v[24:27]
  v_mfma_f32_16x16x32_bf16 v[28:31], v[204:207], a[136:139], v[28:31]
  buffer_load_dwordx4 a[200:203], v3, s[24:27], s14 offen sc1
  s_add_u32 s14, s14, 1024
  v_mfma_f32_16x16x32_bf16 v[32:35], v[192:195], a[140:143], v[32:35]
  v_mfma_f32_16x16x32_bf16 v[36:39], v[196:199], a[140:143], v[36:39]
  v_mfma_f32_16x16x32_bf16 v[40:43], v[200:203], a[140:143], v[40:43]
  v_mfma_f32_16x16x32_bf16 v[44:47], v[204:207], a[140:143], v[44:47]
  buffer_load_dwordx4 a[204:207], v3, s[24:27], s15 offen sc1
  s_add_u32 s15, s15, 1024
  s_waitcnt vmcnt(14)
  v_mfma_f32_16x16x32_bf16 v[16:19], v[208:211], a[144:147], v[16:19]
  v_mfma_f32_16x16x32_bf16 v[20:23], v[212:215], a[144:147], v[20:23]
  v_mfma_f32_16x16x32_bf16 v[24:27], v[216:219], a[144:147], v[24:27]
  v_mfma_f32_16x16x32_bf16 v[28:31], v[220:223], a[144:147], v[28:31]
  buffer_load_dwordx4 a[208:211], v3, s[24:27], s14 offen sc1
  s_add_u32 s14, s14, 1024
  v_mfma_f32_16x16x32_bf16 v[32:35], v[208:211], a[148:151], v[32:35]
  v_mfma_f32_16x16x32_bf16 v[36:39], v[212:215], a[148:151], v[36:39]
  v_mfma_f32_16x16x32_bf16 v[40:43], v[216:219], a[148:151], v[40:43]
  v_mfma_f32_16x16x32_bf16 v[44:47], v[220:223], a[148:151], v[44:47]
  buffer_load_dwordx4 a[212:215], v3, s[24:27], s15 offen sc1
  s_add_u32 s15, s15, 1024
  s_waitcnt vmcnt(14)
  v_mfma_f32_16x16x32_bf16 v[16:19], v[224:227], a[152:155], v[16:19]
  v_mfma_f32_16x16x32_bf16 v[20:23], v[228:231], a[152:155], v[20:23]
  v_mfma_f32_16x16x32_bf16 v[24:27], v[232:235], a[152:155], v[24:27]
  v_mfma_f32_16x16x32_bf16 v[28:31], v[236:239], a[152:155], v[28:31]
  buffer_load_dwordx4 a[216:219], v3, s[24:27], s14 offen sc1
  s_add_u32 s14, s14, 1024
  v_mfma_f32_16x16x32_bf16 v[32:35], v[224:227], a[156:159], v[32:35]
  v_mfma_f32_16x16x32_bf16 v[36:39], v[228:231], a[156:159], v[36:39]
  v_mfma_f32_16x16x32_bf16 v[40:43], v[232:235], a[156:159], v[40:43]
  v_mfma_f32_16x16x32_bf16 v[44:47], v[236:239], a[156:159], v[44:47]
  buffer_load_dwordx4 a[220:223], v3, s[24:27], s15 offen sc1
  s_add_u32 s15, s15, 1024
  s_waitcnt vmcnt(14)
  v_mfma_f32_16x16x32_bf16 v[16:19], v[240:243], a[160:163], v[16:19]
  v_mfma_f32_16x16x32_bf16 v[20:23], v[244:247], a[160:163], v[20:23]
  v_mfma_f32_16x16x32_bf16 v[24:27], v[248:251], a[160:163], v[24:27]
  v_mfma_f32_16x16x32_bf16 v[28:31], v[252:255], a[160:163], v[28:31]
  v_mfma_f32_16x16x32_bf16 v[32:35], v[240:243], a[164:167], v[32:35]
  v_mfma_f32_16x16x32_bf16 v[36:39], v[244:247], a[164:167], v[36:39]
  v_mfma_f32_16x16x32_bf16 v[40:43], v[248:251], a[164:167], v[40:43]
  v_mfma_f32_16x16x32_bf16 v[44:47], v[252:255], a[164:167], v[44:47]
  s_cmp_eq_u32 s16, 0
  s_cbranch_scc0 G2_BI_53
  buffer_load_dword v80, v7, s[56:59], s13 offen sc1
G2_BI_53:
  s_waitcnt vmcnt(12)
  v_mfma_f32_16x16x32_bf16 v[16:19], a[0:3], a[168:171], v[16:19]
  v_mfma_f32_16x16x32_bf16 v[20:23], a[4:7], a[168:171], v[20:23]
  v_mfma_f32_16x16x32_bf16 v[24:27], a[8:11], a[168:171], v[24:27]
  v_mfma_f32_16x16x32_bf16 v[28:31], a[12:15], a[168:171], v[28:31]
  v_mfma_f32_16x16x32_bf16 v[32:35], a[0:3], a[172:175], v[32:35]
  v_mfma_f32_16x16x32_bf16 v[36:39], a[4:7], a[172:175], v[36:39]
  v_mfma_f32_16x16x32_bf16 v[40:43], a[8:11], a[172:175], v[40:43]
  v_mfma_f32_16x16x32_bf16 v[44:47], a[12:15], a[172:175], v[44:47]
  s_waitcnt vmcnt(10)
  v_mfma_f32_16x16x32_bf16 v[16:19], a[16:19], a[176:179], v[16:19]
  v_mfma_f32_16x16x32_bf16 v[20:23], a[20:23], a[176:179], v[20:23]
  v_mfma_f32_16x16x32_bf16 v[24:27], a[24:27], a[176:179], v[24:27]
  v_mfma_f32_16x16x32_bf16 v[28:31], a[28:31], a[176:179], v[28:31]
  v_mfma_f32_16x16x32_bf16 v[32:35], a[16:19], a[180:183], v[32:35]
  v_mfma_f32_16x16x32_bf16 v[36:39], a[20:23], a[180:183], v[36:39]
  v_mfma_f32_16x16x32_bf16 v[40:43], a[24:27], a[180:183], v[40:43]
  v_mfma_f32_16x16x32_bf16 v[44:47], a[28:31], a[180:183], v[44:47]
  s_waitcnt vmcnt(8)
  v_mfma_f32_16x16x32_bf16 v[16:19], a[32:35], a[184:187], v[16:19]
  v_mfma_f32_16x16x32_bf16 v[20:23], a[36:39], a[184:187], v[20:23]
  v_mfma_f32_16x16x32_bf16 v[24:27], a[40:43], a[184:187], v[24:27]
  v_mfma_f32_16x16x32_bf16 v[28:31], a[44:47], a[184:187], v[28:31]
  v_mfma_f32_16x16x32_bf16 v[32:35], a[32:35], a[188:191], v[32:35]
  v_mfma_f32_16x16x32_bf16 v[36:39], a[36:39], a[188:191], v[36:39]
  v_mfma_f32_16x16x32_bf16 v[40:43], a[40:43], a[188:191], v[40:43]
  v_mfma_f32_16x16x32_bf16 v[44:47], a[44:47], a[188:191], v[44:47]
  s_waitcnt vmcnt(0)
  s_cmp_eq_u32 s16, 0
  s_cbranch_scc0 G2_B_54
  v_cmp_ne_u32 vcc, s54, v80
  s_nop 1
  s_cmp_eq_u64 vcc, 0
  s_cbranch_scc1 G2_B_54
  s_cmp_eq_u32 s16, 0
  s_cbranch_scc0 WFS_57
  s_mov_b32 s55, 0x4000
  buffer_load_dword v80, v7, s[56:59], s13 offen sc1
WF_55:
  s_waitcnt vmcnt(0)
  v_cmp_ne_u32 vcc, s54, v80
  s_nop 1
  s_cmp_eq_u64 vcc, 0
  s_cbranch_scc1 WFD_56
  buffer_load_dword v80, v7, s[56:59], s13 offen sc1
  s_sub_u32 s55, s55, 1
  s_cmp_eq_u32 s55, 0
  s_cbranch_scc0 WF_55
WFD_56:
WFS_57:
G2_B_54:
  s_barrier
  buffer_load_dwordx4 a[224:227], v3, s[24:27], s40 offen sc1
  s_add_u32 s40, s40, 1024
  buffer_load_dwordx4 a[228:231], v3, s[24:27], s41 offen sc1
  s_add_u32 s41, s41, 1024
  buffer_load_dwordx4 a[232:235], v3, s[24:27], s40 offen sc1
  s_add_u32 s40, s40, 1024
  buffer_load_dwordx4 a[236:239], v3, s[24:27], s41 offen sc1
  s_add_u32 s41, s41, 1024
  buffer_load_dwordx4 a[240:243], v3, s[24:27], s40 offen sc1
  s_add_u32 s40, s40, 1024
  buffer_load_dwordx4 a[244:247], v3, s[24:27], s41 offen sc1
  s_add_u32 s41, s41, 1024
  buffer_load_dwordx4 a[248:251], v3, s[24:27], s40 offen sc1
  s_add_u32 s40, s40, 1024
  buffer_load_dwordx4 a[252:255], v3, s[24:27], s41 offen sc1
  s_add_u32 s41, s41, 1024
  v_mfma_f32_16x16x32_bf16 v[16:19], a[48:51], a[192:195], v[16:19]
  v_mfma_f32_16x16x32_bf16 v[20:23], a[52:55], a[192:195], v[20:23]
  v_mfma_f32_16x16x32_bf16 v[24:27], a[56:59], a[192:195], v[24:27]
  v_mfma_f32_16x16x32_bf16 v[28:31], a[60:63], a[192:195], v[28:31]
  buffer_load_dwordx4 a[112:115], v3, s[24:27], s40 offen sc1
  s_add_u32 s40, s40, 1024
  v_mfma_f32_16x16x32_bf16 v[32:35], a[48:51], a[196:199], v[32:35]
  v_mfma_f32_16x16x32_bf16 v[36:39], a[52:55], a[196:199], v[36:39]
  v_mfma_f32_16x16x32_bf16 v[40:43], a[56:59], a[196:199], v[40:43]
  v_mfma_f32_16x16x32_bf16 v[44:47], a[60:63], a[196:199], v[44:47]
  buffer_load_dwordx4 a[116:119], v3, s[24:27], s41 offen sc1
  s_add_u32 s41, s41, 1024
  v_mfma_f32_16x16x32_bf16 v[16:19], a[64:67], a[200:203], v[16:19]
  v_mfma_f32_16x16x32_bf16 v[20:23], a[68:71], a[200:203], v[20:23]
  v_mfma_f32_16x16x32_bf16 v[24:27], a[72:75], a[200:203], v[24:27]
  v_mfma_f32_16x16x32_bf16 v[28:31], a[76:79], a[200:203], v[28:31]
  buffer_load_dwordx4 a[120:123], v3, s[24:27], s40 offen sc1
  s_add_u32 s40, s40, 1024
  v_mfma_f32_16x16x32_bf16 v[32:35], a[64:67], a[204:207], v[32:35]
  v_mfma_f32_16x16x32_bf16 v[36:39], a[68:71], a[204:207], v[36:39]
  v_mfma_f32_16x16x32_bf16 v[40:43], a[72:75], a[204:207], v[40:43]
  v_mfma_f32_16x16x32_bf16 v[44:47], a[76:79], a[204:207], v[44:47]
  buffer_load_dwordx4 a[124:127], v3, s[24:27], s41 offen sc1
  s_add_u32 s41, s41, 1024
  v_mfma_f32_16x16x32_bf16 v[16:19], a[80:83], a[208:211], v[16:19]
  v_mfma_f32_16x16x32_bf16 v[20:23], a[84:87], a[208:211], v[20:23]
  v_mfma_f32_16x16x32_bf16 v[24:27], a[88:91], a[208:211], v[24:27]
  v_mfma_f32_16x16x32_bf16 v[28:31], a[92:95], a[208:211], v[28:31]
  buffer_load_dwordx4 a[128:131], v3, s[24:27], s40 offen sc1
  s_add_u32 s40, s40, 1024
  v_mfma_f32_16x16x32_bf16 v[32:35], a[80:83], a[212:215], v[32:35]
  v_mfma_f32_16x16x32_bf16 v[36:39], a[84:87], a[212:215], v[36:39]
  v_mfma_f32_16x16x32_bf16 v[40:43], a[88:91], a[212:215], v[40:43]
  v_mfma_f32_16x16x32_bf16 v[44:47], a[92:95], a[212:215], v[44:47]
  buffer_load_dwordx4 a[132:135], v3, s[24:27], s41 offen sc1
  s_add_u32 s41, s41, 1024
  v_mfma_f32_16x16x32_bf16 v[16:19], a[96:99], a[216:219], v[16:19]
  v_mfma_f32_16x16x32_bf16 v[20:23], a[100:103], a[216:219], v[20:23]
  v_mfma_f32_16x16x32_bf16 v[24:27], a[104:107], a[216:219], v[24:27]
  v_mfma_f32_16x16x32_bf16 v[28:31], a[108:111], a[216:219], v[28:31]
  buffer_load_dwordx4 a[136:139], v3, s[24:27], s40 offen sc1
  s_add_u32 s40, s40, 1024
  v_mfma_f32_16x16x32_bf16 v[32:35], a[96:99], a[220:223], v[32:35]
  v_mfma_f32_16x16x32_bf16 v[36:39], a[100:103], a[220:223], v[36:39]
  v_mfma_f32_16x16x32_bf16 v[40:43], a[104:107], a[220:223], v[40:43]
  v_mfma_f32_16x16x32_bf16 v[44:47], a[108:111], a[220:223], v[44:47]
  buffer_load_dwordx4 a[140:143], v3, s[24:27], s41 offen sc1
  s_add_u32 s41, s41, 1024
  s_waitcnt vmcnt(14)
  v_mfma_f32_16x16x32_bf16 v[48:51], v[144:147], a[224:227], v[48:51]
  v_mfma_f32_16x16x32_bf16 v[52:55], v[148:151], a[224:227], v[52:55]
  v_mfma_f32_16x16x32_bf16 v[56:59], v[152:155], a[224:227], v[56:59]
  v_mfma_f32_16x16x32_bf16 v[60:63], v[156:159], a[224:227], v[60:63]
  buffer_load_dwordx4 a[144:147], v3, s[24:27], s40 offen sc1
  s_add_u32 s40, s40, 1024
  v_mfma_f32_16x16x32_bf16 v[64:67], v[144:147], a[228:231], v[64:67]
  v_mfma_f32_16x16x32_bf16 v[68:71], v[148:151], a[228:231], v[68:71]
  v_mfma_f32_16x16x32_bf16 v[72:75], v[152:155], a[228:231], v[72:75]
  v_mfma_f32_16x16x32_bf16 v[76:79], v[156:159], a[228:231], v[76:79]
  buffer_load_dwordx4 a[148:151], v3, s[24:27], s41 offen sc1
  s_add_u32 s41, s41, 1024
  s_waitcnt vmcnt(14)
  v_mfma_f32_16x16x32_bf16 v[48:51], v[160:163], a[232:235], v[48:51]
  v_mfma_f32_16x16x32_bf16 v[52:55], v[164:167], a[232:235], v[52:55]
  v_mfma_f32_16x16x32_bf16 v[56:59], v[168:171], a[232:235], v[56:59]
  v_mfma_f32_16x16x32_bf16 v[60:63], v[172:175], a[232:235], v[60:63]
  buffer_load_dwordx4 a[152:155], v3, s[24:27], s40 offen sc1
  s_add_u32 s40, s40, 1024
  v_mfma_f32_16x16x32_bf16 v[64:67], v[160:163], a[236:239], v[64:67]
  v_mfma_f32_16x16x32_bf16 v[68:71], v[164:167], a[236:239], v[68:71]
  v_mfma_f32_16x16x32_bf16 v[72:75], v[168:171], a[236:239], v[72:75]
  v_mfma_f32_16x16x32_bf16 v[76:79], v[172:175], a[236:239], v[76:79]
  buffer_load_dwordx4 a[156:159], v3, s[24:27], s41 offen sc1
  s_add_u32 s41, s41, 1024
  s_waitcnt vmcnt(14)
  v_mfma_f32_16x16x32_bf16 v[48:51], v[176:179], a[240:243], v[48:51]
  v_mfma_f32_16x16x32_bf16 v[52:55], v[180:183], a[240:243], v[52:55]
  v_mfma_f32_16x16x32_bf16 v[56:59], v[184:187], a[240:243], v[56:59]
  v_mfma_f32_16x16x32_bf16 v[60:63], v[188:191], a[240:243], v[60:63]
  buffer_load_dwordx4 a[160:163], v3, s[24:27], s40 offen sc1
  s_add_u32 s40, s40, 1024
  v_mfma_f32_16x16x32_bf16 v[64:67], v[176:179], a[244:247], v[64:67]
  v_mfma_f32_16x16x32_bf16 v[68:71], v[180:183], a[244:247], v[68:71]
  v_mfma_f32_16x16x32_bf16 v[72:75], v[184:187], a[244:247], v[72:75]
  v_mfma_f32_16x16x32_bf16 v[76:79], v[188:191], a[244:247], v[76:79]
  buffer_load_dwordx4 a[164:167], v3, s[24:27], s41 offen sc1
  s_add_u32 s41, s41, 1024
  s_waitcnt vmcnt(14)
  v_mfma_f32_16x16x32_bf16 v[48:51], v[192:195], a[248:251], v[48:51]
  v_mfma_f32_16x16x32_bf16 v[52:55], v[196:199], a[248:251], v[52:55]
  v_mfma_f32_16x16x32_bf16 v[56:59], v[200:203], a[248:251], v[56:59]
  v_mfma_f32_16x16x32_bf16 v[60:63], v[204:207], a[248:251], v[60:63]
  buffer_load_dwordx4 a[168:171], v3, s[24:27], s40 offen sc1
  s_add_u32 s40, s40, 1024
  v_mfma_f32_16x16x32_bf16 v[64:67], v[192:195], a[252:255], v[64:67]
  v_mfma_f32_16x16x32_bf16 v[68:71], v[196:199], a[252:255], v[68:71]
  v_mfma_f32_16x16x32_bf16 v[72:75], v[200:203], a[252:255], v[72:75]
  v_mfma_f32_16x16x32_bf16 v[76:79], v[204:207], a[252:255], v[76:79]
  buffer_load_dwordx4 a[172:175], v3, s[24:27], s41 offen sc1
  s_add_u32 s41, s41, 1024
  s_waitcnt vmcnt(14)
  v_mfma_f32_16x16x32_bf16 v[48:51], v[208:211], a[112:115], v[48:51]
  v_mfma_f32_16x16x32_bf16 v[52:55], v[212:215], a[112:115], v[52:55]
  v_mfma_f32_16x16x32_bf16 v[56:59], v[216:219], a[112:115], v[56:59]
  v_mfma_f32_16x16x32_bf16 v[60:63], v[220:223], a[112:115], v[60:63]
  buffer_load_dwordx4 a[176:179], v3, s[24:27], s40 offen sc1
  s_add_u32 s40, s40, 1024
  v_mfma_f32_16x16x32_bf16 v[64:67], v[208:211], a[116:119], v[64:67]
  v_mfma_f32_16x16x32_bf16 v[68:71], v[212:215], a[116:119], v[68:71]
  v_mfma_f32_16x16x32_bf16 v[72:75], v[216:219], a[116:119], v[72:75]
  v_mfma_f32_16x16x32_bf16 v[76:79], v[220:223], a[116:119], v[76:79]
  buffer_load_dwordx4 a[180:183], v3, s[24:27], s41 offen sc1
  s_add_u32 s41, s41, 1024
  s_waitcnt vmcnt(14)
  v_mfma_f32_16x16x32_bf16 v[48:51], v[224:227], a[120:123], v[48:51]
  v_mfma_f32_16x16x32_bf16 v[52:55], v[228:231], a[120:123], v[52:55]
  v_mfma_f32_16x16x32_bf16 v[56:59], v[232:235], a[120:123], v[56:59]
  v_mfma_f32_16x16x32_bf16 v[60:63], v[236:239], a[120:123], v[60:63]
  buffer_load_dwordx4 a[184:187], v3, s[24:27], s40 offen sc1
  s_add_u32 s40, s40, 1024
  v_mfma_f32_16x16x32_bf16 v[64:67], v[224:227], a[124:127], v[64:67]
  v_mfma_f32_16x16x32_bf16 v[68:71], v[228:231], a[124:127], v[68:71]
  v_mfma_f32_16x16x32_bf16 v[72:75], v[232:235], a[124:127], v[72:75]
  v_mfma_f32_16x16x32_bf16 v[76:79], v[236:239], a[124:127], v[76:79]
  buffer_load_dwordx4 a[188:191], v3, s[24:27], s41 offen sc1
  s_add_u32 s41, s41, 1024
  s_waitcnt vmcnt(14)
  v_mfma_f32_16x16x32_bf16 v[48:51], v[240:243], a[128:131], v[48:51]
  v_mfma_f32_16x16x32_bf16 v[52:55], v[244:247], a[128:131], v[52:55]
  v_mfma_f32_16x16x32_bf16 v[56:59], v[248:251], a[128:131], v[56:59]
  v_mfma_f32_16x16x32_bf16 v[60:63], v[252:255], a[128:131], v[60:63]
  v_mfma_f32_16x16x32_bf16 v[64:67], v[240:243], a[132:135], v[64:67]
  v_mfma_f32_16x16x32_bf16 v[68:71], v[244:247], a[132:135], v[68:71]
  v_mfma_f32_16x16x32_bf16 v[72:75], v[248:251], a[132:135], v[72:75]
  v_mfma_f32_16x16x32_bf16 v[76:79], v[252:255], a[132:135], v[76:79]
  s_waitcnt vmcnt(12)
  v_mfma_f32_16x16x32_bf16 v[48:51], a[0:3], a[136:139], v[48:51]
  v_mfma_f32_16x16x32_bf16 v[52:55], a[4:7], a[136:139], v[52:55]
  v_mfma_f32_16x16x32_bf16 v[56:59], a[8:11], a[136:139], v[56:59]
  v_mfma_f32_16x16x32_bf16 v[60:63], a[12:15], a[136:139], v[60:63]
  v_mfma_f32_16x16x32_bf16 v[64:67], a[0:3], a[140:143], v[64:67]
  v_mfma_f32_16x16x32_bf16 v[68:71], a[4:7], a[140:143], v[68:71]
  v_mfma_f32_16x16x32_bf16 v[72:75], a[8:11], a[140:143], v[72:75]
  v_mfma_f32_16x16x32_bf16 v[76:79], a[12:15], a[140:143], v[76:79]
  s_waitcnt vmcnt(10)
  v_mfma_f32_16x16x32_bf16 v[48:51], a[16:19], a[144:147], v[48:51]
  v_mfma_f32_16x16x32_bf16 v[52:55], a[20:23], a[144:147], v[52:55]
  v_mfma_f32_16x16x32_bf16 v[56:59], a[24:27], a[144:147], v[56:59]
  v_mfma_f32_16x16x32_bf16 v[60:63], a[28:31], a[144:147], v[60:63]
  v_mfma_f32_16x16x32_bf16 v[64:67], a[16:19], a[148:151], v[64:67]
  v_mfma_f32_16x16x32_bf16 v[68:71], a[20:23], a[148:151], v[68:71]
  v_mfma_f32_16x16x32_bf16 v[72:75], a[24:27], a[148:151], v[72:75]
  v_mfma_f32_16x16x32_bf16 v[76:79], a[28:31], a[148:151], v[76:79]
  s_waitcnt vmcnt(8)
  v_mfma_f32_16x16x32_bf16 v[48:51], a[32:35], a[152:155], v[48:51]
  v_mfma_f32_16x16x32_bf16 v[52:55], a[36:39], a[152:155], v[52:55]
  v_mfma_f32_16x16x32_bf16 v[56:59], a[40:43], a[152:155], v[56:59]
  v_mfma_f32_16x16x32_bf16 v[60:63], a[44:47], a[152:155], v[60:63]
  v_mfma_f32_16x16x32_bf16 v[64:67], a[32:35], a[156:159], v[64:67]
  v_mfma_f32_16x16x32_bf16 v[68:71], a[36:39], a[156:159], v[68:71]
  v_mfma_f32_16x16x32_bf16 v[72:75], a[40:43], a[156:159], v[72:75]
  v_mfma_f32_16x16x32_bf16 v[76:79], a[44:47], a[156:159], v[76:79]
  s_waitcnt vmcnt(6)
  v_mfma_f32_16x16x32_bf16 v[48:51], a[48:51], a[160:163], v[48:51]
  v_mfma_f32_16x16x32_bf16 v[52:55], a[52:55], a[160:163], v[52:55]
  v_mfma_f32_16x16x32_bf16 v[56:59], a[56:59], a[160:163], v[56:59]
  v_mfma_f32_16x16x32_bf16 v[60:63], a[60:63], a[160:163], v[60:63]
  v_mfma_f32_16x16x32_bf16 v[64:67], a[48:51], a[164:167], v[64:67]
  v_mfma_f32_16x16x32_bf16 v[68:71], a[52:55], a[164:167], v[68:71]
  v_mfma_f32_16x16x32_bf16 v[72:75], a[56:59], a[164:167], v[72:75]
  v_mfma_f32_16x16x32_bf16 v[76:79], a[60:63], a[164:167], v[76:79]
  s_waitcnt vmcnt(4)
  v_mfma_f32_16x16x32_bf16 v[48:51], a[64:67], a[168:171], v[48:51]
  v_mfma_f32_16x16x32_bf16 v[52:55], a[68:71], a[168:171], v[52:55]
  v_mfma_f32_16x16x32_bf16 v[56:59], a[72:75], a[168:171], v[56:59]
  v_mfma_f32_16x16x32_bf16 v[60:63], a[76:79], a[168:171], v[60:63]
  v_mfma_f32_16x16x32_bf16 v[64:67], a[64:67], a[172:175], v[64:67]
  v_mfma_f32_16x16x32_bf16 v[68:71], a[68:71], a[172:175], v[68:71]
  v_mfma_f32_16x16x32_bf16 v[72:75], a[72:75], a[172:175], v[72:75]
  v_mfma_f32_16x16x32_bf16 v[76:79], a[76:79], a[172:175], v[76:79]
  s_waitcnt vmcnt(2)
  v_mfma_f32_16x16x32_bf16 v[48:51], a[80:83], a[176:179], v[48:51]
  v_mfma_f32_16x16x32_bf16 v[52:55], a[84:87], a[176:179], v[52:55]
  v_mfma_f32_16x16x32_bf16 v[56:59], a[88:91], a[176:179], v[56:59]
  v_mfma_f32_16x16x32_bf16 v[60:63], a[92:95], a[176:179], v[60:63]
  v_mfma_f32_16x16x32_bf16 v[64:67], a[80:83], a[180:183], v[64:67]
  v_mfma_f32_16x16x32_bf16 v[68:71], a[84:87], a[180:183], v[68:71]
  v_mfma_f32_16x16x32_bf16 v[72:75], a[88:91], a[180:183], v[72:75]
  v_mfma_f32_16x16x32_bf16 v[76:79], a[92:95], a[180:183], v[76:79]
  s_waitcnt vmcnt(0)
  v_mfma_f32_16x16x32_bf16 v[48:51], a[96:99], a[184:187], v[48:51]
  v_mfma_f32_16x16x32_bf16 v[52:55], a[100:103], a[184:187], v[52:55]
  v_mfma_f32_16x16x32_bf16 v[56:59], a[104:107], a[184:187], v[56:59]
  v_mfma_f32_16x16x32_bf16 v[60:63], a[108:111], a[184:187], v[60:63]
  v_mfma_f32_16x16x32_bf16 v[64:67], a[96:99], a[188:191], v[64:67]
  v_mfma_f32_16x16x32_bf16 v[68:71], a[100:103], a[188:191], v[68:71]
  v_mfma_f32_16x16x32_bf16 v[72:75], a[104:107], a[188:191], v[72:75]
  v_mfma_f32_16x16x32_bf16 v[76:79], a[108:111], a[188:191], v[76:79]
  s_mul_i32 s12, s16, 12288
  s_add_u32 s12, s12, 65536
  v_add_u32 v1, s12, v3
  s_nop 7
  s_cmp_eq_u32 s16, 0
  s_cbranch_scc0 P3_W_58
  ds_write_b128 v1, v[32:35] offset:0
  ds_write_b128 v1, v[36:39] offset:1024
  ds_write_b128 v1, v[40:43] offset:2048
  ds_write_b128 v1, v[44:47] offset:3072
  ds_write_b128 v1, v[48:51] offset:4096
  ds_write_b128 v1, v[52:55] offset:5120
  ds_write_b128 v1, v[56:59] offset:6144
  ds_write_b128 v1, v[60:63] offset:7168
  ds_write_b128 v1, v[64:67] offset:8192
  ds_write_b128 v1, v[68:71] offset:9216
  ds_write_b128 v1, v[72:75] offset:10240
  ds_write_b128 v1, v[76:79] offset:11264
P3_W_58:
  s_cmp_eq_u32 s16, 1
  s_cbranch_scc0 P3_W_59
  ds_write_b128 v1, v[16:19] offset:0
  ds_write_b128 v1, v[20:23] offset:1024
  ds_write_b128 v1, v[24:27] offset:2048
  ds_write_b128 v1, v[28:31] offset:3072
  ds_write_b128 v1, v[48:51] offset:4096
  ds_write_b128 v1, v[52:55] offset:5120
  ds_write_b128 v1, v[56:59] offset:6144
  ds_write_b128 v1, v[60:63] offset:7168
  ds_write_b128 v1, v[64:67] offset:8192
  ds_write_b128 v1, v[68:71] offset:9216
  ds_write_b128 v1, v[72:75] offset:10240
  ds_write_b128 v1, v[76:79] offset:11264
  v_mov_b32 v16, v32
  v_mov_b32 v17, v33
  v_mov_b32 v18, v34
  v_mov_b32 v19, v35
  v_mov_b32 v20, v36
  v_mov_b32 v21, v37
  v_mov_b32 v22, v38
  v_mov_b32 v23, v39
  v_mov_b32 v24, v40
  v_mov_b32 v25, v41
  v_mov_b32 v26, v42
  v_mov_b32 v27, v43
  v_mov_b32 v28, v44
  v_mov_b32 v29, v45
  v_mov_b32 v30, v46
  v_mov_b32 v31, v47
P3_W_59:
  s_cmp_eq_u32 s16, 2
  s_cbranch_scc0 P3_W_60
  ds_write_b128 v1, v[16:19] offset:0
  ds_write_b128 v1, v[20:23] offset:1024
  ds_write_b128 v1, v[24:27] offset:2048
  ds_write_b128 v1, v[28:31] offset:3072
  ds_write_b128 v1, v[32:35] offset:4096
  ds_write_b128 v1, v[36:39] offset:5120
  ds_write_b128 v1, v[40:43] offset:6144
  ds_write_b128 v1, v[44:47] offset:7168
  ds_write_b128 v1, v[64:67] offset:8192
  ds_write_b128 v1, v[68:71] offset:9216
  ds_write_b128 v1, v[72:75] offset:10240
  ds_write_b128 v1, v[76:79] offset:11264
  v_mov_b32 v16, v48
  v_mov_b32 v17, v49
  v_mov_b32 v18, v50
  v_mov_b32 v19, v51
  v_mov_b32 v20, v52
  v_mov_b32 v21, v53
  v_mov_b32 v22, v54
  v_mov_b32 v23, v55
  v_mov_b32 v24, v56
  v_mov_b32 v25, v57
  v_mov_b32 v26, v58
  v_mov_b32 v27, v59
  v_mov_b32 v28, v60
  v_mov_b32 v29, v61
  v_mov_b32 v30, v62
  v_mov_b32 v31, v63
P3_W_60:
  s_cmp_eq_u32 s16, 3
  s_cbranch_scc0 P3_W_61
  ds_write_b128 v1, v[16:19] offset:0
  ds_write_b128 v1, v[20:23] offset:1024
  ds_write_b128 v1, v[24:27] offset:2048
  ds_write_b128 v1, v[28:31] offset:3072
  ds_write_b128 v1, v[32:35] offset:4096
  ds_write_b128 v1, v[36:39] offset:5120
  ds_write_b128 v1, v[40:43] offset:6144
  ds_write_b128 v1, v[44:47] offset:7168
  ds_write_b128 v1, v[48:51] offset:8192
  ds_write_b128 v1, v[52:55] offset:9216
  ds_write_b128 v1, v[56:59] offset:10240
  ds_write_b128 v1, v[60:63] offset:11264
  v_mov_b32 v16, v64
  v_mov_b32 v17, v65
  v_mov_b32 v18, v66
  v_mov_b32 v19, v67
  v_mov_b32 v20, v68
  v_mov_b32 v21, v69
  v_mov_b32 v22, v70
  v_mov_b32 v23, v71
  v_mov_b32 v24, v72
  v_mov_b32 v25, v73
  v_mov_b32 v26, v74
  v_mov_b32 v27, v75
  v_mov_b32 v28, v76
  v_mov_b32 v29, v77
  v_mov_b32 v30, v78
  v_mov_b32 v31, v79
P3_W_61:
  v_mov_b32 v7, 0xffff0000
  v_lshlrev_b32 v80, 16, v8
  v_and_b32 v84, v7, v8
  v_lshlrev_b32 v88, 16, v9
  v_and_b32 v92, v7, v9
  v_lshlrev_b32 v81, 16, v10
  v_and_b32 v85, v7, v10
  v_lshlrev_b32 v89, 16, v11
  v_and_b32 v93, v7, v11
  v_lshlrev_b32 v82, 16, v12
  v_and_b32 v86, v7, v12
  v_lshlrev_b32 v90, 16, v13
  v_and_b32 v94, v7, v13
  v_lshlrev_b32 v83, 16, v14
  v_and_b32 v87, v7, v14
  v_lshlrev_b32 v91, 16, v15
  v_and_b32 v95, v7, v15
  v_add_f32 v16, v16, v80
  v_add_f32 v17, v17, v81
  v_add_f32 v18, v18, v82
  v_add_f32 v19, v19, v83
  v_add_f32 v20, v20, v84
  v_add_f32 v21, v21, v85
  v_add_f32 v22, v22, v86
  v_add_f32 v23, v23, v87
  v_add_f32 v24, v24, v88
  v_add_f32 v25, v25, v89
  v_add_f32 v26, v26, v90
  v_add_f32 v27, v27, v91
  v_add_f32 v28, v28, v92
  v_add_f32 v29, v29, v93
  v_add_f32 v30, v30, v94
  v_add_f32 v31, v31, v95
  v_add_u32 v13, 65536, v3
  s_waitcnt lgkmcnt(0)
  s_barrier
  s_cmp_eq_u32 s16, 0
  s_cbranch_scc0 P3_R_62
  ds_read_b128 v[96:99], v13 offset:12288
  ds_read_b128 v[100:103], v13 offset:13312
  ds_read_b128 v[104:107], v13 offset:14336
  ds_read_b128 v[108:111], v13 offset:15360
  ds_read_b128 v[112:115], v13 offset:24576
  ds_read_b128 v[116:119], v13 offset:25600
  ds_read_b128 v[120:123], v13 offset:26624
  ds_read_b128 v[124:127], v13 offset:27648
  ds_read_b128 v[128:131], v13 offset:36864
  ds_read_b128 v[132:135], v13 offset:37888
  ds_read_b128 v[136:139], v13 offset:38912
  ds_read_b128 v[140:143], v13 offset:39936
P3_R_62:
  s_cmp_eq_u32 s16, 1
  s_cbranch_scc0 P3_R_63
  ds_read_b128 v[96:99], v13 offset:0
  ds_read_b128 v[100:103], v13 offset:1024
  ds_read_b128 v[104:107], v13 offset:2048
  ds_read_b128 v[108:111], v13 offset:3072
  ds_read_b128 v[112:115], v13 offset:28672
  ds_read_b128 v[116:119], v13 offset:29696
  ds_read_b128 v[120:123], v13 offset:30720
  ds_read_b128 v[124:127], v13 offset:31744
  ds_read_b128 v[128:131], v13 offset:40960
  ds_read_b128 v[132:135], v13 offset:41984
  ds_read_b128 v[136:139], v13 offset:43008
  ds_read_b128 v[140:143], v13 offset:44032
P3_R_63:
  s_cmp_eq_u32 s16, 2
  s_cbranch_scc0 P3_R_64
  ds_read_b128 v[96:99], v13 offset:4096
  ds_read_b128 v[100:103], v13 offset:5120
  ds_read_b128 v[104:107], v13 offset:6144
  ds_read_b128 v[108:111], v13 offset:7168
  ds_read_b128 v[112:115], v13 offset:16384
  ds_read_b128 v[116:119], v13 offset:17408
  ds_read_b128 v[120:123], v13 offset:18432
  ds_read_b128 v[124:127], v13 offset:19456
  ds_read_b128 v[128:131], v13 offset:45056
  ds_read_b128 v[132:135], v13 offset:46080
  ds_read_b128 v[136:139], v13 offset:47104
  ds_read_b128 v[140:143], v13 offset:48128
P3_R_64:
  s_cmp_eq_u32 s16, 3
  s_cbranch_scc0 P3_R_65
  ds_read_b128 v[96:99], v13 offset:8192
  ds_read_b128 v[100:103], v13 offset:9216
  ds_read_b128 v[104:107], v13 offset:10240
  ds_read_b128 v[108:111], v13 offset:11264
  ds_read_b128 v[112:115], v13 offset:20480
  ds_read_b128 v[116:119], v13 offset:21504
  ds_read_b128 v[120:123], v13 offset:22528
  ds_read_b128 v[124:127], v13 offset:23552
  ds_read_b128 v[128:131], v13 offset:32768
  ds_read_b128 v[132:135], v13 offset:33792
  ds_read_b128 v[136:139], v13 offset:34816
  ds_read_b128 v[140:143], v13 offset:35840
P3_R_65:
  s_waitcnt lgkmcnt(8)
  v_add_f32 v16, v16, v96
  v_add_f32 v17, v17, v97
  v_add_f32 v18, v18, v98
  v_add_f32 v19, v19, v99
  v_add_f32 v20, v20, v100
  v_add_f32 v21, v21, v101
  v_add_f32 v22, v22, v102
  v_add_f32 v23, v23, v103
  v_add_f32 v24, v24, v104
  v_add_f32 v25, v25, v105
  v_add_f32 v26, v26, v106
  v_add_f32 v27, v27, v107
  v_add_f32 v28, v28, v108
  v_add_f32 v29, v29, v109
  v_add_f32 v30, v30, v110
  v_add_f32 v31, v31, v111
  s_waitcnt lgkmcnt(4)
  v_add_f32 v16, v16, v112
  v_add_f32 v17, v17, v113
  v_add_f32 v18, v18, v114
  v_add_f32 v19, v19, v115
  v_add_f32 v20, v20, v116
  v_add_f32 v21, v21, v117
  v_add_f32 v22, v22, v118
  v_add_f32 v23, v23, v119
  v_add_f32 v24, v24, v120
  v_add_f32 v25, v25, v121
  v_add_f32 v26, v26, v122
  v_add_f32 v27, v27, v123
  v_add_f32 v28, v28, v124
  v_add_f32 v29, v29, v125
  v_add_f32 v30, v30, v126
  v_add_f32 v31, v31, v127
  s_waitcnt lgkmcnt(0)
  v_add_f32 v16, v16, v128
  v_add_f32 v17, v17, v129
  v_add_f32 v18, v18, v130
  v_add_f32 v19, v19, v131
  v_add_f32 v20, v20, v132
  v_add_f32 v21, v21, v133
  v_add_f32 v22, v22, v134
  v_add_f32 v23, v23, v135
  v_add_f32 v24, v24, v136
  v_add_f32 v25, v25, v137
  v_add_f32 v26, v26, v138
  v_add_f32 v27, v27, v139
  v_add_f32 v28, v28, v140
  v_add_f32 v29, v29, v141
  v_add_f32 v30, v30, v142
  v_add_f32 v31, v31, v143
  v_cvt_pk_bf16_f32 v144, v16, v20
  v_cvt_pk_bf16_f32 v145, v24, v28
  v_cvt_pk_bf16_f32 v146, v17, v21
  v_cvt_pk_bf16_f32 v147, v25, v29
  v_cvt_pk_bf16_f32 v148, v18, v22
  v_cvt_pk_bf16_f32 v149, v26, v30
  v_cvt_pk_bf16_f32 v150, v19, v23
  v_cvt_pk_bf16_f32 v151, v27, v31
  buffer_store_dwordx4 v[144:147], v6, s[32:35], s43 offen sc1
  buffer_store_dwordx4 v[148:151], v6, s[32:35], s43 offen offset:256 sc1
  s_lshl_b32 s13, s17, 7
  s_lshl_b32 s12, s18, 2
  s_add_u32 s13, s13, s12
  s_add_u32 s13, s13, 8192
  s_waitcnt vmcnt(0) lgkmcnt(0)
  s_barrier
  s_cmp_eq_u32 s16, 0
  s_cbranch_scc0 SIG_66
  v_mov_b32 v1, s54
  v_mov_b32 v2, 0
  buffer_store_dword v1, v2, s[56:59], s13 offen sc1
SIG_66:
  s_cmp_ge_u32 s2, 224
  s_cbranch_scc1 SKIP_G1_67
  s_load_dwordx2 s[8:9], s[0:1], 96
  s_load_dwordx2 s[6:7], s[0:1], 64
  s_load_dwordx2 s[4:5], s[0:1], 0
  v_lshrrev_b32 v1, 6, v0
  v_and_b32 v2, 63, v0
  s_and_b32 s17, s2, 7
  v_readfirstlane_b32 s16, v1
  s_lshr_b32 s18, s2, 3
  s_mul_i32 s19, s18, 9363
  s_lshr_b32 s19, s19, 16
  s_mul_i32 s12, s19, 7
  s_sub_u32 s18, s18, s12
  s_lshl_b32 s17, s17, 2
  s_add_u32 s17, s17, s19
  s_lshl_b32 s19, s18, 2
  s_add_u32 s19, s19, s16
  s_waitcnt lgkmcnt(0)
  s_add_u32 s20, s8, 0x1200000
  s_addc_u32 s21, s9, 0
  s_mov_b32 s22, 0x200000
  s_mov_b32 s23, 0x20000
  s_add_u32 s24, s8, 0x200000
  s_addc_u32 s25, s9, 0
  s_mov_b32 s26, 0x200000
  s_mov_b32 s27, 0x20000
  s_add_u32 s28, s8, 0x400000
  s_addc_u32 s29, s9, 0
  s_mov_b32 s30, 0x1c0000
  s_mov_b32 s31, 0x20000
  s_mov_b32 s32, s6
  s_mov_b32 s33, s7
  s_mov_b32 s34, 0xe00
  s_mov_b32 s35, 0x20000
  s_add_u32 s36, s8, 0x1400000
  s_addc_u32 s37, s9, 0
  s_mov_b32 s38, 0x200000
  s_mov_b32 s39, 0x20000
  s_add_u32 s40, s8, 0x1800000
  s_addc_u32 s41, s9, 0
  s_mov_b32 s42, 0x700000
  s_mov_b32 s43, 0x20000
  v_lshlrev_b32 v6, 4, v2
  v_lshrrev_b32 v8, 3, v2
  v_lshlrev_b32 v8, 7, v8
  v_and_b32 v9, 7, v2
  v_bfe_u32 v10, v2, 4, 1
  v_lshlrev_b32 v10, 1, v10
  v_xor_b32 v9, v9, v10
  v_lshl_add_u32 v3, v9, 4, v8
  v_xor_b32 v4, 64, v3
  v_and_b32 v8, 15, v2
  v_lshrrev_b32 v9, 4, v2
  s_lshl_b32 s14, s17, 2
  s_add_u32 s14, s14, s16
  s_lshl_b32 s14, s14, 14
  s_lshl_b32 s15, s19, 16
  s_lshl_b32 s12, s19, 7
  v_lshlrev_b32 v11, 5, v9
  v_add_u32 v11, s12, v11
  buffer_load_dwordx4 v[208:211], v11, s[32:35], 0 offen
  buffer_load_dwordx4 v[212:215], v11, s[32:35], 0 offen offset:16
  s_cmp_eq_u32 s16, 0
  s_cbranch_scc1 G1_PW_68
  buffer_load_dwordx4 a[0:3], v6, s[28:31], s15 offen offset:0 sc1
  buffer_load_dwordx4 a[4:7], v6, s[28:31], s15 offen offset:1024 sc1
  buffer_load_dwordx4 a[8:11], v6, s[28:31], s15 offen offset:2048 sc1
  buffer_load_dwordx4 a[12:15], v6, s[28:31], s15 offen offset:3072 sc1
  s_add_u32 s15, s15, 4096
  buffer_load_dwordx4 a[16:19], v6, s[28:31], s15 offen offset:0 sc1
  buffer_load_dwordx4 a[20:23], v6, s[28:31], s15 offen offset:1024 sc1
  buffer_load_dwordx4 a[24:27], v6, s[28:31], s15 offen offset:2048 sc1
  buffer_load_dwordx4 a[28:31], v6, s[28:31], s15 offen offset:3072 sc1
  s_add_u32 s15, s15, 4096
  buffer_load_dwordx4 a[32:35], v6, s[28:31], s15 offen offset:0 sc1
  buffer_load_dwordx4 a[36:39], v6, s[28:31], s15 offen offset:1024 sc1
  buffer_load_dwordx4 a[40:43], v6, s[28:31], s15 offen offset:2048 sc1
  buffer_load_dwordx4 a[44:47], v6, s[28:31], s15 offen offset:3072 sc1
  s_add_u32 s15, s15, 4096
  buffer_load_dwordx4 a[48:51], v6, s[28:31], s15 offen offset:0 sc1
  buffer_load_dwordx4 a[52:55], v6, s[28:31], s15 offen offset:1024 sc1
  buffer_load_dwordx4 a[56:59], v6, s[28:31], s15 offen offset:2048 sc1
  buffer_load_dwordx4 a[60:63], v6, s[28:31], s15 offen offset:3072 sc1
  s_add_u32 s15, s15, 4096
G1_PW_68:
  v_and_b32 v10, 7, v2
  v_lshlrev_b32 v10, 2, v10
  s_lshl_b32 s13, s17, 7
  s_add_u32 s13, s13, 8192
  s_cmp_eq_u32 s16, 0
  s_cbranch_scc0 WFS_71
  s_mov_b32 s55, 0x4000
  buffer_load_dword v144, v10, s[56:59], s13 offen sc1
WF_69:
  s_waitcnt vmcnt(0)
  v_cmp_ne_u32 vcc, s54, v144
  s_nop 1
  s_cmp_eq_u64 vcc, 0
  s_cbranch_scc1 WFD_70
  buffer_load_dword v144, v10, s[56:59], s13 offen sc1
  s_sub_u32 s55, s55, 1
  s_cmp_eq_u32 s55, 0
  s_cbranch_scc0 WF_69
WFD_70:
WFS_71:
  s_barrier
  s_mov_b32 s12, s14
  buffer_load_dwordx4 v[16:19], v6, s[20:23], s12 offen offset:0 sc1
  buffer_load_dwordx4 v[24:27], v6, s[20:23], s12 offen offset:1024 sc1
  buffer_load_dwordx4 v[32:35], v6, s[20:23], s12 offen offset:2048 sc1
  buffer_load_dwordx4 v[40:43], v6, s[20:23], s12 offen offset:3072 sc1
  s_add_u32 s12, s12, 4096
  buffer_load_dwordx4 v[48:51], v6, s[20:23], s12 offen offset:0 sc1
  buffer_load_dwordx4 v[56:59], v6, s[20:23], s12 offen offset:1024 sc1
  buffer_load_dwordx4 v[64:67], v6, s[20:23], s12 offen offset:2048 sc1
  buffer_load_dwordx4 v[72:75], v6, s[20:23], s12 offen offset:3072 sc1
  s_add_u32 s12, s12, 4096
  buffer_load_dwordx4 v[80:83], v6, s[20:23], s12 offen offset:0 sc1
  buffer_load_dwordx4 v[88:91], v6, s[20:23], s12 offen offset:1024 sc1
  buffer_load_dwordx4 v[96:99], v6, s[20:23], s12 offen offset:2048 sc1
  buffer_load_dwordx4 v[104:107], v6, s[20:23], s12 offen offset:3072 sc1
  s_add_u32 s12, s12, 4096
  buffer_load_dwordx4 v[112:115], v6, s[20:23], s12 offen offset:0 sc1
  buffer_load_dwordx4 v[120:123], v6, s[20:23], s12 offen offset:1024 sc1
  buffer_load_dwordx4 v[128:131], v6, s[20:23], s12 offen offset:2048 sc1
  buffer_load_dwordx4 v[136:139], v6, s[20:23], s12 offen offset:3072 sc1
  s_cmp_eq_u32 s16, 0
  s_cbranch_scc0 G1_PW_72
  buffer_load_dwordx4 a[0:3], v6, s[28:31], s15 offen offset:0 sc1
  buffer_load_dwordx4 a[4:7], v6, s[28:31], s15 offen offset:1024 sc1
  buffer_load_dwordx4 a[8:11], v6, s[28:31], s15 offen offset:2048 sc1
  buffer_load_dwordx4 a[12:15], v6, s[28:31], s15 offen offset:3072 sc1
  s_add_u32 s15, s15, 4096
  buffer_load_dwordx4 a[16:19], v6, s[28:31], s15 offen offset:0 sc1
  buffer_load_dwordx4 a[20:23], v6, s[28:31], s15 offen offset:1024 sc1
  buffer_load_dwordx4 a[24:27], v6, s[28:31], s15 offen offset:2048 sc1
  buffer_load_dwordx4 a[28:31], v6, s[28:31], s15 offen offset:3072 sc1
  s_add_u32 s15, s15, 4096
  buffer_load_dwordx4 a[32:35], v6, s[28:31], s15 offen offset:0 sc1
  buffer_load_dwordx4 a[36:39], v6, s[28:31], s15 offen offset:1024 sc1
  buffer_load_dwordx4 a[40:43], v6, s[28:31], s15 offen offset:2048 sc1
  buffer_load_dwordx4 a[44:47], v6, s[28:31], s15 offen offset:3072 sc1
  s_add_u32 s15, s15, 4096
  buffer_load_dwordx4 a[48:51], v6, s[28:31], s15 offen offset:0 sc1
  buffer_load_dwordx4 a[52:55], v6, s[28:31], s15 offen offset:1024 sc1
  buffer_load_dwordx4 a[56:59], v6, s[28:31], s15 offen offset:2048 sc1
  buffer_load_dwordx4 a[60:63], v6, s[28:31], s15 offen offset:3072 sc1
  s_add_u32 s15, s15, 4096
G1_PW_72:
  v_lshlrev_b32 v10, 2, v9
  v_sub_u32 v10, v8, v10
  v_cmp_eq_u32 vcc, 0, v10
  v_mov_b32 v244, 0x3f803f80
  v_mov_b32 v248, 0
  v_cndmask_b32 v240, 0, 1.0, vcc
  v_cmp_eq_u32 vcc, 1, v10
  v_mov_b32 v245, 0x3f803f80
  v_mov_b32 v249, 0
  v_cndmask_b32 v241, 0, 1.0, vcc
  v_cmp_eq_u32 vcc, 2, v10
  v_mov_b32 v246, 0x3f803f80
  v_mov_b32 v250, 0
  v_cndmask_b32 v242, 0, 1.0, vcc
  v_cmp_eq_u32 vcc, 3, v10
  v_mov_b32 v247, 0x3f803f80
  v_mov_b32 v251, 0
  v_cndmask_b32 v243, 0, 1.0, vcc
  v_lshrrev_b32 v10, 2, v8
  v_and_b32 v11, 3, v2
  v_lshl_add_u32 v12, v9, 3, v10
  v_lshlrev_b32 v12, 7, v12
  v_lshrrev_b32 v13, 1, v11
  s_lshl_b32 s12, s16, 1
  v_add_u32 v13, s12, v13
  v_and_b32 v10, 2, v10
  v_xor_b32 v13, v13, v10
  v_and_b32 v10, 1, v9
  v_lshlrev_b32 v10, 2, v10
  v_xor_b32 v13, v13, v10
  v_lshl_add_u32 v12, v13, 4, v12
  v_and_b32 v11, 1, v11
  v_lshl_add_u32 v7, v11, 3, v12
  v_mov_b32 v14, 1.0
  v_mov_b32 v232, 0
  v_mov_b32 v236, 0
  v_mov_b32 v233, 0
  v_mov_b32 v237, 0
  v_mov_b32 v234, 0
  v_mov_b32 v238, 0
  v_mov_b32 v235, 0
  v_mov_b32 v239, 0
  s_cmp_eq_u32 s16, 0
  s_cbranch_scc1 G1_SA_73
  s_waitcnt vmcnt(15)
  v_mfma_f32_16x16x32_bf16 v[232:235], v[244:247], v[16:19], v[232:235]
  v_mfma_f32_16x16x32_bf16 v[236:239], v[16:19], v[16:19], v[236:239]
  s_waitcnt vmcnt(14)
  v_mfma_f32_16x16x32_bf16 v[232:235], v[244:247], v[24:27], v[232:235]
  v_mfma_f32_16x16x32_bf16 v[236:239], v[24:27], v[24:27], v[236:239]
  s_waitcnt vmcnt(13)
  v_mfma_f32_16x16x32_bf16 v[232:235], v[244:247], v[32:35], v[232:235]
  v_mfma_f32_16x16x32_bf16 v[236:239], v[32:35], v[32:35], v[236:239]
  s_waitcnt vmcnt(12)
  v_mfma_f32_16x16x32_bf16 v[232:235], v[244:247], v[40:43], v[232:235]
  v_mfma_f32_16x16x32_bf16 v[236:239], v[40:43], v[40:43], v[236:239]
  s_waitcnt vmcnt(11)
  v_mfma_f32_16x16x32_bf16 v[232:235], v[244:247], v[48:51], v[232:235]
  v_mfma_f32_16x16x32_bf16 v[236:239], v[48:51], v[48:51], v[236:239]
  s_waitcnt vmcnt(10)
  v_mfma_f32_16x16x32_bf16 v[232:235], v[244:247], v[56:59], v[232:235]
  v_mfma_f32_16x16x32_bf16 v[236:239], v[56:59], v[56:59], v[236:239]
  s_waitcnt vmcnt(9)
  v_mfma_f32_16x16x32_bf16 v[232:235], v[244:247], v[64:67], v[232:235]
  v_mfma_f32_16x16x32_bf16 v[236:239], v[64:67], v[64:67], v[236:239]
  s_waitcnt vmcnt(8)
  v_mfma_f32_16x16x32_bf16 v[232:235], v[244:247], v[72:75], v[232:235]
  v_mfma_f32_16x16x32_bf16 v[236:239], v[72:75], v[72:75], v[236:239]
  s_waitcnt vmcnt(7)
  v_mfma_f32_16x16x32_bf16 v[232:235], v[244:247], v[80:83], v[232:235]
  v_mfma_f32_16x16x32_bf16 v[236:239], v[80:83], v[80:83], v[236:239]
  s_waitcnt vmcnt(6)
  v_mfma_f32_16x16x32_bf16 v[232:235], v[244:247], v[88:91], v[232:235]
  v_mfma_f32_16x16x32_bf16 v[236:239], v[88:91], v[88:91], v[236:239]
  s_waitcnt vmcnt(5)
  v_mfma_f32_16x16x32_bf16 v[232:235], v[244:247], v[96:99], v[232:235]
  v_mfma_f32_16x16x32_bf16 v[236:239], v[96:99], v[96:99], v[236:239]
  s_waitcnt vmcnt(4)
  v_mfma_f32_16x16x32_bf16 v[232:235], v[244:247], v[104:107], v[232:235]
  v_mfma_f32_16x16x32_bf16 v[236:239], v[104:107], v[104:107], v[236:239]
  s_waitcnt vmcnt(3)
  v_mfma_f32_16x16x32_bf16 v[232:235], v[244:247], v[112:115], v[232:235]
  v_mfma_f32_16x16x32_bf16 v[236:239], v[112:115], v[112:115], v[236:239]
  s_waitcnt vmcnt(2)
  v_mfma_f32_16x16x32_bf16 v[232:235], v[244:247], v[120:123], v[232:235]
  v_mfma_f32_16x16x32_bf16 v[236:239], v[120:123], v[120:123], v[236:239]
  s_waitcnt vmcnt(1)
  v_mfma_f32_16x16x32_bf16 v[232:235], v[244:247], v[128:131], v[232:235]
  v_mfma_f32_16x16x32_bf16 v[236:239], v[128:131], v[128:131], v[236:239]
  s_waitcnt vmcnt(0)
  v_mfma_f32_16x16x32_bf16 v[232:235], v[244:247], v[136:139], v[232:235]
  v_mfma_f32_16x16x32_bf16 v[236:239], v[136:139], v[136:139], v[236:239]
  s_branch G1_SB_74
G1_SA_73:
  s_waitcnt vmcnt(31)
  v_mfma_f32_16x16x32_bf16 v[232:235], v[244:247], v[16:19], v[232:235]
  v_mfma_f32_16x16x32_bf16 v[236:239], v[16:19], v[16:19], v[236:239]
  s_waitcnt vmcnt(30)
  v_mfma_f32_16x16x32_bf16 v[232:235], v[244:247], v[24:27], v[232:235]
  v_mfma_f32_16x16x32_bf16 v[236:239], v[24:27], v[24:27], v[236:239]
  s_waitcnt vmcnt(29)
  v_mfma_f32_16x16x32_bf16 v[232:235], v[244:247], v[32:35], v[232:235]
  v_mfma_f32_16x16x32_bf16 v[236:239], v[32:35], v[32:35], v[236:239]
  s_waitcnt vmcnt(28)
  v_mfma_f32_16x16x32_bf16 v[232:235], v[244:247], v[40:43], v[232:235]
  v_mfma_f32_16x16x32_bf16 v[236:239], v[40:43], v[40:43], v[236:239]
  s_waitcnt vmcnt(27)
  v_mfma_f32_16x16x32_bf16 v[232:235], v[244:247], v[48:51], v[232:235]
  v_mfma_f32_16x16x32_bf16 v[236:239], v[48:51], v[48:51], v[236:239]
  s_waitcnt vmcnt(26)
  v_mfma_f32_16x16x32_bf16 v[232:235], v[244:247], v[56:59], v[232:235]
  v_mfma_f32_16x16x32_bf16 v[236:239], v[56:59], v[56:59], v[236:239]
  s_waitcnt vmcnt(25)
  v_mfma_f32_16x16x32_bf16 v[232:235], v[244:247], v[64:67], v[232:235]
  v_mfma_f32_16x16x32_bf16 v[236:239], v[64:67], v[64:67], v[236:239]
  s_waitcnt vmcnt(24)
  v_mfma_f32_16x16x32_bf16 v[232:235], v[244:247], v[72:75], v[232:235]
  v_mfma_f32_16x16x32_bf16 v[236:239], v[72:75], v[72:75], v[236:239]
  s_waitcnt vmcnt(23)
  v_mfma_f32_16x16x32_bf16 v[232:235], v[244:247], v[80:83], v[232:235]
  v_mfma_f32_16x16x32_bf16 v[236:239], v[80:83], v[80:83], v[236:239]
  s_waitcnt vmcnt(22)
  v_mfma_f32_16x16x32_bf16 v[232:235], v[244:247], v[88:91], v[232:235]
  v_mfma_f32_16x16x32_bf16 v[236:239], v[88:91], v[88:91], v[236:239]
  s_waitcnt vmcnt(21)
  v_mfma_f32_16x16x32_bf16 v[232:235], v[244:247], v[96:99], v[232:235]
  v_mfma_f32_16x16x32_bf16 v[236:239], v[96:99], v[96:99], v[236:239]
  s_waitcnt vmcnt(20)
  v_mfma_f32_16x16x32_bf16 v[232:235], v[244:247], v[104:107], v[232:235]
  v_mfma_f32_16x16x32_bf16 v[236:239], v[104:107], v[104:107], v[236:239]
  s_waitcnt vmcnt(19)
  v_mfma_f32_16x16x32_bf16 v[232:235], v[244:247], v[112:115], v[232:235]
  v_mfma_f32_16x16x32_bf16 v[236:239], v[112:115], v[112:115], v[236:239]
  s_waitcnt vmcnt(18)
  v_mfma_f32_16x16x32_bf16 v[232:235], v[244:247], v[120:123], v[232:235]
  v_mfma_f32_16x16x32_bf16 v[236:239], v[120:123], v[120:123], v[236:239]
  s_waitcnt vmcnt(17)
  v_mfma_f32_16x16x32_bf16 v[232:235], v[244:247], v[128:131], v[232:235]
  v_mfma_f32_16x16x32_bf16 v[236:239], v[128:131], v[128:131], v[236:239]
  s_waitcnt vmcnt(16)
  v_mfma_f32_16x16x32_bf16 v[232:235], v[244:247], v[136:139], v[232:235]
  v_mfma_f32_16x16x32_bf16 v[236:239], v[136:139], v[136:139], v[236:239]
G1_SB_74:
  s_barrier
  ds_read_b64_tr_b16 v[20:21], v7 offset:0
  ds_read_b64_tr_b16 v[22:23], v7 offset:512
  ds_read_b64_tr_b16 v[28:29], v7 offset:4096
  ds_read_b64_tr_b16 v[30:31], v7 offset:4608
  ds_read_b64_tr_b16 v[36:37], v7 offset:8192
  ds_read_b64_tr_b16 v[38:39], v7 offset:8704
  ds_read_b64_tr_b16 v[44:45], v7 offset:12288
  ds_read_b64_tr_b16 v[46:47], v7 offset:12800
  ds_read_b64_tr_b16 v[52:53], v7 offset:16384
  ds_read_b64_tr_b16 v[54:55], v7 offset:16896
  ds_read_b64_tr_b16 v[60:61], v7 offset:20480
  ds_read_b64_tr_b16 v[62:63], v7 offset:20992
  ds_read_b64_tr_b16 v[68:69], v7 offset:24576
  ds_read_b64_tr_b16 v[70:71], v7 offset:25088
  s_nop 7
  v_mul_f32 v10, v236, v240
  v_fma_f32 v10, v237, v241, v10
  v_fma_f32 v10, v238, v242, v10
  v_fma_f32 v10, v239, v243, v10
  v_mul_f32 v11, 0.001953125, v232
  s_nop 0
  v_mfma_f32_16x16x4_f32 v[248:251], v14, v10, 0
  v_mul_f32 v12, v11, v11
  s_nop 7
  s_nop 3
  v_mul_f32 v13, 0.001953125, v248
  v_sub_f32 v13, v13, v12
  v_max_f32 v13, 0, v13
  v_add_f32 v13, 0x3727c5ac, v13
  v_rsq_f32 v252, v13
  s_nop 0
  v_mul_f32 v254, v11, v252
  v_mov_b32 v253, v252
  v_mul_f32 v254, -1.0, v254
  v_mov_b32 v255, v254
  v_mov_b32 v232, 0
  v_mov_b32 v236, 0
  v_mov_b32 v233, 0
  v_mov_b32 v237, 0
  v_mov_b32 v234, 0
  v_mov_b32 v238, 0
  v_mov_b32 v235, 0
  v_mov_b32 v239, 0
  v_mov_b32 v8, 0xffff0000
  s_waitcnt lgkmcnt(12)
  v_lshlrev_b32 v216, 16, v16
  v_and_b32 v217, v8, v16
  v_lshlrev_b32 v218, 16, v17
  v_and_b32 v219, v8, v17
  v_lshlrev_b32 v220, 16, v18
  v_and_b32 v221, v8, v18
  v_lshlrev_b32 v222, 16, v19
  v_and_b32 v223, v8, v19
  v_lshlrev_b32 v224, 16, v20
  v_and_b32 v225, v8, v20
  v_lshlrev_b32 v226, 16, v21
  v_and_b32 v227, v8, v21
  v_lshlrev_b32 v228, 16, v22
  v_and_b32 v229, v8, v22
  v_lshlrev_b32 v230, 16, v23
  v_and_b32 v231, v8, v23
  v_pk_fma_f32 v[16:17], v[216:217], v[252:253], v[254:255]
  v_pk_fma_f32 v[18:19], v[218:219], v[252:253], v[254:255]
  v_pk_fma_f32 v[20:21], v[220:221], v[252:253], v[254:255]
  v_pk_fma_f32 v[22:23], v[222:223], v[252:253], v[254:255]
  ds_read_b64_tr_b16 v[76:77], v7 offset:28672
  ds_read_b64_tr_b16 v[78:79], v7 offset:29184
  buffer_load_dwordx4 a[64:67], v6, s[28:31], s15 offen offset:0 sc1
  buffer_load_dwordx4 a[68:71], v6, s[28:31], s15 offen offset:1024 sc1
  v_pk_fma_f32 v[16:17], v[16:17], v[224:225], v[216:217]
  v_pk_fma_f32 v[18:19], v[18:19], v[226:227], v[218:219]
  v_pk_fma_f32 v[20:21], v[20:21], v[228:229], v[220:221]
  v_pk_fma_f32 v[22:23], v[22:23], v[230:231], v[222:223]
  v_cvt_pk_bf16_f32 v144, v16, v17
  v_cvt_pk_bf16_f32 v145, v18, v19
  v_cvt_pk_bf16_f32 v146, v20, v21
  v_cvt_pk_bf16_f32 v147, v22, v23
  s_waitcnt lgkmcnt(12)
  v_lshlrev_b32 v216, 16, v24
  v_and_b32 v217, v8, v24
  v_mfma_f32_16x16x32_bf16 v[232:235], v[244:247], v[144:147], v[232:235]
  v_lshlrev_b32 v218, 16, v25
  v_and_b32 v219, v8, v25
  v_lshlrev_b32 v220, 16, v26
  v_mfma_f32_16x16x32_bf16 v[236:239], v[144:147], v[144:147], v[236:239]
  v_and_b32 v221, v8, v26
  v_lshlrev_b32 v222, 16, v27
  v_and_b32 v223, v8, v27
  v_lshlrev_b32 v224, 16, v28
  v_and_b32 v225, v8, v28
  v_lshlrev_b32 v226, 16, v29
  v_and_b32 v227, v8, v29
  v_lshlrev_b32 v228, 16, v30
  v_and_b32 v229, v8, v30
  v_lshlrev_b32 v230, 16, v31
  v_and_b32 v231, v8, v31
  v_pk_fma_f32 v[24:25], v[216:217], v[252:253], v[254:255]
  v_pk_fma_f32 v[26:27], v[218:219], v[252:253], v[254:255]
  v_pk_fma_f32 v[28:29], v[220:221], v[252:253], v[254:255]
  v_pk_fma_f32 v[30:31], v[222:223], v[252:253], v[254:255]
  ds_read_b64_tr_b16 v[84:85], v7 offset:32768
  ds_read_b64_tr_b16 v[86:87], v7 offset:33280
  buffer_load_dwordx4 a[72:75], v6, s[28:31], s15 offen offset:2048 sc1
  buffer_load_dwordx4 a[76:79], v6, s[28:31], s15 offen offset:3072 sc1
  s_add_u32 s15, s15, 4096
  v_pk_fma_f32 v[24:25], v[24:25], v[224:225], v[216:217]
  v_pk_fma_f32 v[26:27], v[26:27], v[226:227], v[218:219]
  v_pk_fma_f32 v[28:29], v[28:29], v[228:229], v[220:221]
  v_pk_fma_f32 v[30:31], v[30:31], v[230:231], v[222:223]
  v_cvt_pk_bf16_f32 v148, v24, v25
  v_cvt_pk_bf16_f32 v149, v26, v27
  v_cvt_pk_bf16_f32 v150, v28, v29
  v_cvt_pk_bf16_f32 v151, v30, v31
  s_waitcnt lgkmcnt(12)
  v_lshlrev_b32 v216, 16, v32
  v_and_b32 v217, v8, v32
  v_mfma_f32_16x16x32_bf16 v[232:235], v[244:247], v[148:151], v[232:235]
  v_lshlrev_b32 v218, 16, v33
  v_and_b32 v219, v8, v33
  v_lshlrev_b32 v220, 16, v34
  v_mfma_f32_16x16x32_bf16 v[236:239], v[148:151], v[148:151], v[236:239]
  v_and_b32 v221, v8, v34
  v_lshlrev_b32 v222, 16, v35
  v_and_b32 v223, v8, v35
  v_lshlrev_b32 v224, 16, v36
  v_and_b32 v225, v8, v36
  v_lshlrev_b32 v226, 16, v37
  v_and_b32 v227, v8, v37
  v_lshlrev_b32 v228, 16, v38
  v_and_b32 v229, v8, v38
  v_lshlrev_b32 v230, 16, v39
  v_and_b32 v231, v8, v39
  v_pk_fma_f32 v[32:33], v[216:217], v[252:253], v[254:255]
  v_pk_fma_f32 v[34:35], v[218:219], v[252:253], v[254:255]
  v_pk_fma_f32 v[36:37], v[220:221], v[252:253], v[254:255]
  v_pk_fma_f32 v[38:39], v[222:223], v[252:253], v[254:255]
  ds_read_b64_tr_b16 v[92:93], v7 offset:36864
  ds_read_b64_tr_b16 v[94:95], v7 offset:37376
  buffer_load_dwordx4 a[80:83], v6, s[28:31], s15 offen offset:0 sc1
  buffer_load_dwordx4 a[84:87], v6, s[28:31], s15 offen offset:1024 sc1
  v_pk_fma_f32 v[32:33], v[32:33], v[224:225], v[216:217]
  v_pk_fma_f32 v[34:35], v[34:35], v[226:227], v[218:219]
  v_pk_fma_f32 v[36:37], v[36:37], v[228:229], v[220:221]
  v_pk_fma_f32 v[38:39], v[38:39], v[230:231], v[222:223]
  v_cvt_pk_bf16_f32 v152, v32, v33
  v_cvt_pk_bf16_f32 v153, v34, v35
  v_cvt_pk_bf16_f32 v154, v36, v37
  v_cvt_pk_bf16_f32 v155, v38, v39
  s_waitcnt lgkmcnt(12)
  v_lshlrev_b32 v216, 16, v40
  v_and_b32 v217, v8, v40
  v_mfma_f32_16x16x32_bf16 v[232:235], v[244:247], v[152:155], v[232:235]
  v_lshlrev_b32 v218, 16, v41
  v_and_b32 v219, v8, v41
  v_lshlrev_b32 v220, 16, v42
  v_mfma_f32_16x16x32_bf16 v[236:239], v[152:155], v[152:155], v[236:239]
  v_and_b32 v221, v8, v42
  v_lshlrev_b32 v222, 16, v43
  v_and_b32 v223, v8, v43
  v_lshlrev_b32 v224, 16, v44
  v_and_b32 v225, v8, v44
  v_lshlrev_b32 v226, 16, v45
  v_and_b32 v227, v8, v45
  v_lshlrev_b32 v228, 16, v46
  v_and_b32 v229, v8, v46
  v_lshlrev_b32 v230, 16, v47
  v_and_b32 v231, v8, v47
  v_pk_fma_f32 v[40:41], v[216:217], v[252:253], v[254:255]
  v_pk_fma_f32 v[42:43], v[218:219], v[252:253], v[254:255]
  v_pk_fma_f32 v[44:45], v[220:221], v[252:253], v[254:255]
  v_pk_fma_f32 v[46:47], v[222:223], v[252:253], v[254:255]
  ds_read_b64_tr_b16 v[100:101], v7 offset:40960
  ds_read_b64_tr_b16 v[102:103], v7 offset:41472
  buffer_load_dwordx4 a[88:91], v6, s[28:31], s15 offen offset:2048 sc1
  buffer_load_dwordx4 a[92:95], v6, s[28:31], s15 offen offset:3072 sc1
  s_add_u32 s15, s15, 4096
  v_pk_fma_f32 v[40:41], v[40:41], v[224:225], v[216:217]
  v_pk_fma_f32 v[42:43], v[42:43], v[226:227], v[218:219]
  v_pk_fma_f32 v[44:45], v[44:45], v[228:229], v[220:221]
  v_pk_fma_f32 v[46:47], v[46:47], v[230:231], v[222:223]
  v_cvt_pk_bf16_f32 v156, v40, v41
  v_cvt_pk_bf16_f32 v157, v42, v43
  v_cvt_pk_bf16_f32 v158, v44, v45
  v_cvt_pk_bf16_f32 v159, v46, v47
  s_waitcnt lgkmcnt(12)
  v_lshlrev_b32 v216, 16, v48
  v_and_b32 v217, v8, v48
  v_mfma_f32_16x16x32_bf16 v[232:235], v[244:247], v[156:159], v[232:235]
  v_lshlrev_b32 v218, 16, v49
  v_and_b32 v219, v8, v49
  v_lshlrev_b32 v220, 16, v50
  v_mfma_f32_16x16x32_bf16 v[236:239], v[156:159], v[156:159], v[236:239]
  v_and_b32 v221, v8, v50
  v_lshlrev_b32 v222, 16, v51
  v_and_b32 v223, v8, v51
  v_lshlrev_b32 v224, 16, v52
  v_and_b32 v225, v8, v52
  v_lshlrev_b32 v226, 16, v53
  v_and_b32 v227, v8, v53
  v_lshlrev_b32 v228, 16, v54
  v_and_b32 v229, v8, v54
  v_lshlrev_b32 v230, 16, v55
  v_and_b32 v231, v8, v55
  v_pk_fma_f32 v[48:49], v[216:217], v[252:253], v[254:255]
  v_pk_fma_f32 v[50:51], v[218:219], v[252:253], v[254:255]
  v_pk_fma_f32 v[52:53], v[220:221], v[252:253], v[254:255]
  v_pk_fma_f32 v[54:55], v[222:223], v[252:253], v[254:255]
  ds_read_b64_tr_b16 v[108:109], v7 offset:45056
  ds_read_b64_tr_b16 v[110:111], v7 offset:45568
  buffer_load_dwordx4 a[96:99], v6, s[28:31], s15 offen offset:0 sc1
  buffer_load_dwordx4 a[100:103], v6, s[28:31], s15 offen offset:1024 sc1
  v_pk_fma_f32 v[48:49], v[48:49], v[224:225], v[216:217]
  v_pk_fma_f32 v[50:51], v[50:51], v[226:227], v[218:219]
  v_pk_fma_f32 v[52:53], v[52:53], v[228:229], v[220:221]
  v_pk_fma_f32 v[54:55], v[54:55], v[230:231], v[222:223]
  v_cvt_pk_bf16_f32 v160, v48, v49
  v_cvt_pk_bf16_f32 v161, v50, v51
  v_cvt_pk_bf16_f32 v162, v52, v53
  v_cvt_pk_bf16_f32 v163, v54, v55
  s_waitcnt lgkmcnt(12)
  v_lshlrev_b32 v216, 16, v56
  v_and_b32 v217, v8, v56
  v_mfma_f32_16x16x32_bf16 v[232:235], v[244:247], v[160:163], v[232:235]
  v_lshlrev_b32 v218, 16, v57
  v_and_b32 v219, v8, v57
  v_lshlrev_b32 v220, 16, v58
  v_mfma_f32_16x16x32_bf16 v[236:239], v[160:163], v[160:163], v[236:239]
  v_and_b32 v221, v8, v58
  v_lshlrev_b32 v222, 16, v59
  v_and_b32 v223, v8, v59
  v_lshlrev_b32 v224, 16, v60
  v_and_b32 v225, v8, v60
  v_lshlrev_b32 v226, 16, v61
  v_and_b32 v227, v8, v61
  v_lshlrev_b32 v228, 16, v62
  v_and_b32 v229, v8, v62
  v_lshlrev_b32 v230, 16, v63
  v_and_b32 v231, v8, v63
  v_pk_fma_f32 v[56:57], v[216:217], v[252:253], v[254:255]
  v_pk_fma_f32 v[58:59], v[218:219], v[252:253], v[254:255]
  v_pk_fma_f32 v[60:61], v[220:221], v[252:253], v[254:255]
  v_pk_fma_f32 v[62:63], v[222:223], v[252:253], v[254:255]
  ds_read_b64_tr_b16 v[116:117], v7 offset:49152
  ds_read_b64_tr_b16 v[118:119], v7 offset:49664
  buffer_load_dwordx4 a[104:107], v6, s[28:31], s15 offen offset:2048 sc1
  buffer_load_dwordx4 a[108:111], v6, s[28:31], s15 offen offset:3072 sc1
  s_add_u32 s15, s15, 4096
  v_pk_fma_f32 v[56:57], v[56:57], v[224:225], v[216:217]
  v_pk_fma_f32 v[58:59], v[58:59], v[226:227], v[218:219]
  v_pk_fma_f32 v[60:61], v[60:61], v[228:229], v[220:221]
  v_pk_fma_f32 v[62:63], v[62:63], v[230:231], v[222:223]
  v_cvt_pk_bf16_f32 v164, v56, v57
  v_cvt_pk_bf16_f32 v165, v58, v59
  v_cvt_pk_bf16_f32 v166, v60, v61
  v_cvt_pk_bf16_f32 v167, v62, v63
  s_waitcnt lgkmcnt(12)
  v_lshlrev_b32 v216, 16, v64
  v_and_b32 v217, v8, v64
  v_mfma_f32_16x16x32_bf16 v[232:235], v[244:247], v[164:167], v[232:235]
  v_lshlrev_b32 v218, 16, v65
  v_and_b32 v219, v8, v65
  v_lshlrev_b32 v220, 16, v66
  v_mfma_f32_16x16x32_bf16 v[236:239], v[164:167], v[164:167], v[236:239]
  v_and_b32 v221, v8, v66
  v_lshlrev_b32 v222, 16, v67
  v_and_b32 v223, v8, v67
  v_lshlrev_b32 v224, 16, v68
  v_and_b32 v225, v8, v68
  v_lshlrev_b32 v226, 16, v69
  v_and_b32 v227, v8, v69
  v_lshlrev_b32 v228, 16, v70
  v_and_b32 v229, v8, v70
  v_lshlrev_b32 v230, 16, v71
  v_and_b32 v231, v8, v71
  v_pk_fma_f32 v[64:65], v[216:217], v[252:253], v[254:255]
  v_pk_fma_f32 v[66:67], v[218:219], v[252:253], v[254:255]
  v_pk_fma_f32 v[68:69], v[220:221], v[252:253], v[254:255]
  v_pk_fma_f32 v[70:71], v[222:223], v[252:253], v[254:255]
  ds_read_b64_tr_b16 v[124:125], v7 offset:53248
  ds_read_b64_tr_b16 v[126:127], v7 offset:53760
  buffer_load_dwordx4 a[112:115], v6, s[28:31], s15 offen offset:0 sc1
  buffer_load_dwordx4 a[116:119], v6, s[28:31], s15 offen offset:1024 sc1
  v_pk_fma_f32 v[64:65], v[64:65], v[224:225], v[216:217]
  v_pk_fma_f32 v[66:67], v[66:67], v[226:227], v[218:219]
  v_pk_fma_f32 v[68:69], v[68:69], v[228:229], v[220:221]
  v_pk_fma_f32 v[70:71], v[70:71], v[230:231], v[222:223]
  v_cvt_pk_bf16_f32 v168, v64, v65
  v_cvt_pk_bf16_f32 v169, v66, v67
  v_cvt_pk_bf16_f32 v170, v68, v69
  v_cvt_pk_bf16_f32 v171, v70, v71
  s_waitcnt lgkmcnt(12)
  v_lshlrev_b32 v216, 16, v72
  v_and_b32 v217, v8, v72
  v_mfma_f32_16x16x32_bf16 v[232:235], v[244:247], v[168:171], v[232:235]
  v_lshlrev_b32 v218, 16, v73
  v_and_b32 v219, v8, v73
  v_lshlrev_b32 v220, 16, v74
  v_mfma_f32_16x16x32_bf16 v[236:239], v[168:171], v[168:171], v[236:239]
  v_and_b32 v221, v8, v74
  v_lshlrev_b32 v222, 16, v75
  v_and_b32 v223, v8, v75
  v_lshlrev_b32 v224, 16, v76
  v_and_b32 v225, v8, v76
  v_lshlrev_b32 v226, 16, v77
  v_and_b32 v227, v8, v77
  v_lshlrev_b32 v228, 16, v78
  v_and_b32 v229, v8, v78
  v_lshlrev_b32 v230, 16, v79
  v_and_b32 v231, v8, v79
  v_pk_fma_f32 v[72:73], v[216:217], v[252:253], v[254:255]
  v_pk_fma_f32 v[74:75], v[218:219], v[252:253], v[254:255]
  v_pk_fma_f32 v[76:77], v[220:221], v[252:253], v[254:255]
  v_pk_fma_f32 v[78:79], v[222:223], v[252:253], v[254:255]
  ds_read_b64_tr_b16 v[132:133], v7 offset:57344
  ds_read_b64_tr_b16 v[134:135], v7 offset:57856
  buffer_load_dwordx4 a[120:123], v6, s[28:31], s15 offen offset:2048 sc1
  buffer_load_dwordx4 a[124:127], v6, s[28:31], s15 offen offset:3072 sc1
  s_add_u32 s15, s15, 4096
  v_pk_fma_f32 v[72:73], v[72:73], v[224:225], v[216:217]
  v_pk_fma_f32 v[74:75], v[74:75], v[226:227], v[218:219]
  v_pk_fma_f32 v[76:77], v[76:77], v[228:229], v[220:221]
  v_pk_fma_f32 v[78:79], v[78:79], v[230:231], v[222:223]
  v_cvt_pk_bf16_f32 v172, v72, v73
  v_cvt_pk_bf16_f32 v173, v74, v75
  v_cvt_pk_bf16_f32 v174, v76, v77
  v_cvt_pk_bf16_f32 v175, v78, v79
  s_waitcnt lgkmcnt(12)
  v_lshlrev_b32 v216, 16, v80
  v_and_b32 v217, v8, v80
  v_mfma_f32_16x16x32_bf16 v[232:235], v[244:247], v[172:175], v[232:235]
  v_lshlrev_b32 v218, 16, v81
  v_and_b32 v219, v8, v81
  v_lshlrev_b32 v220, 16, v82
  v_mfma_f32_16x16x32_bf16 v[236:239], v[172:175], v[172:175], v[236:239]
  v_and_b32 v221, v8, v82
  v_lshlrev_b32 v222, 16, v83
  v_and_b32 v223, v8, v83
  v_lshlrev_b32 v224, 16, v84
  v_and_b32 v225, v8, v84
  v_lshlrev_b32 v226, 16, v85
  v_and_b32 v227, v8, v85
  v_lshlrev_b32 v228, 16, v86
  v_and_b32 v229, v8, v86
  v_lshlrev_b32 v230, 16, v87
  v_and_b32 v231, v8, v87
  v_pk_fma_f32 v[80:81], v[216:217], v[252:253], v[254:255]
  v_pk_fma_f32 v[82:83], v[218:219], v[252:253], v[254:255]
  v_pk_fma_f32 v[84:85], v[220:221], v[252:253], v[254:255]
  v_pk_fma_f32 v[86:87], v[222:223], v[252:253], v[254:255]
  ds_read_b64_tr_b16 v[140:141], v7 offset:61440
  ds_read_b64_tr_b16 v[142:143], v7 offset:61952
  buffer_load_dwordx4 a[128:131], v6, s[28:31], s15 offen offset:0 sc1
  buffer_load_dwordx4 a[132:135], v6, s[28:31], s15 offen offset:1024 sc1
  v_pk_fma_f32 v[80:81], v[80:81], v[224:225], v[216:217]
  v_pk_fma_f32 v[82:83], v[82:83], v[226:227], v[218:219]
  v_pk_fma_f32 v[84:85], v[84:85], v[228:229], v[220:221]
  v_pk_fma_f32 v[86:87], v[86:87], v[230:231], v[222:223]
  v_cvt_pk_bf16_f32 v176, v80, v81
  v_cvt_pk_bf16_f32 v177, v82, v83
  v_cvt_pk_bf16_f32 v178, v84, v85
  v_cvt_pk_bf16_f32 v179, v86, v87
  s_waitcnt lgkmcnt(12)
  v_lshlrev_b32 v216, 16, v88
  v_and_b32 v217, v8, v88
  v_mfma_f32_16x16x32_bf16 v[232:235], v[244:247], v[176:179], v[232:235]
  v_lshlrev_b32 v218, 16, v89
  v_and_b32 v219, v8, v89
  v_lshlrev_b32 v220, 16, v90
  v_mfma_f32_16x16x32_bf16 v[236:239], v[176:179], v[176:179], v[236:239]
  v_and_b32 v221, v8, v90
  v_lshlrev_b32 v222, 16, v91
  v_and_b32 v223, v8, v91
  v_lshlrev_b32 v224, 16, v92
  v_and_b32 v225, v8, v92
  v_lshlrev_b32 v226, 16, v93
  v_and_b32 v227, v8, v93
  v_lshlrev_b32 v228, 16, v94
  v_and_b32 v229, v8, v94
  v_lshlrev_b32 v230, 16, v95
  v_and_b32 v231, v8, v95
  v_pk_fma_f32 v[88:89], v[216:217], v[252:253], v[254:255]
  v_pk_fma_f32 v[90:91], v[218:219], v[252:253], v[254:255]
  v_pk_fma_f32 v[92:93], v[220:221], v[252:253], v[254:255]
  v_pk_fma_f32 v[94:95], v[222:223], v[252:253], v[254:255]
  buffer_load_dwordx4 a[136:139], v6, s[28:31], s15 offen offset:2048 sc1
  buffer_load_dwordx4 a[140:143], v6, s[28:31], s15 offen offset:3072 sc1
  s_add_u32 s15, s15, 4096
  v_pk_fma_f32 v[88:89], v[88:89], v[224:225], v[216:217]
  v_pk_fma_f32 v[90:91], v[90:91], v[226:227], v[218:219]
  v_pk_fma_f32 v[92:93], v[92:93], v[228:229], v[220:221]
  v_pk_fma_f32 v[94:95], v[94:95], v[230:231], v[222:223]
  v_cvt_pk_bf16_f32 v180, v88, v89
  v_cvt_pk_bf16_f32 v181, v90, v91
  v_cvt_pk_bf16_f32 v182, v92, v93
  v_cvt_pk_bf16_f32 v183, v94, v95
  s_waitcnt lgkmcnt(10)
  v_lshlrev_b32 v216, 16, v96
  v_and_b32 v217, v8, v96
  v_mfma_f32_16x16x32_bf16 v[232:235], v[244:247], v[180:183], v[232:235]
  v_lshlrev_b32 v218, 16, v97
  v_and_b32 v219, v8, v97
  v_lshlrev_b32 v220, 16, v98
  v_mfma_f32_16x16x32_bf16 v[236:239], v[180:183], v[180:183], v[236:239]
  v_and_b32 v221, v8, v98
  v_lshlrev_b32 v222, 16, v99
  v_and_b32 v223, v8, v99
  v_lshlrev_b32 v224, 16, v100
  v_and_b32 v225, v8, v100
  v_lshlrev_b32 v226, 16, v101
  v_and_b32 v227, v8, v101
  v_lshlrev_b32 v228, 16, v102
  v_and_b32 v229, v8, v102
  v_lshlrev_b32 v230, 16, v103
  v_and_b32 v231, v8, v103
  v_pk_fma_f32 v[96:97], v[216:217], v[252:253], v[254:255]
  v_pk_fma_f32 v[98:99], v[218:219], v[252:253], v[254:255]
  v_pk_fma_f32 v[100:101], v[220:221], v[252:253], v[254:255]
  v_pk_fma_f32 v[102:103], v[222:223], v[252:253], v[254:255]
  buffer_load_dwordx4 a[144:147], v6, s[28:31], s15 offen offset:0 sc1
  buffer_load_dwordx4 a[148:151], v6, s[28:31], s15 offen offset:1024 sc1
  v_pk_fma_f32 v[96:97], v[96:97], v[224:225], v[216:217]
  v_pk_fma_f32 v[98:99], v[98:99], v[226:227], v[218:219]
  v_pk_fma_f32 v[100:101], v[100:101], v[228:229], v[220:221]
  v_pk_fma_f32 v[102:103], v[102:103], v[230:231], v[222:223]
  v_cvt_pk_bf16_f32 v184, v96, v97
  v_cvt_pk_bf16_f32 v185, v98, v99
  v_cvt_pk_bf16_f32 v186, v100, v101
  v_cvt_pk_bf16_f32 v187, v102, v103
  s_waitcnt lgkmcnt(8)
  v_lshlrev_b32 v216, 16, v104
  v_and_b32 v217, v8, v104
  v_mfma_f32_16x16x32_bf16 v[232:235], v[244:247], v[184:187], v[232:235]
  v_lshlrev_b32 v218, 16, v105
  v_and_b32 v219, v8, v105
  v_lshlrev_b32 v220, 16, v106
  v_mfma_f32_16x16x32_bf16 v[236:239], v[184:187], v[184:187], v[236:239]
  v_and_b32 v221, v8, v106
  v_lshlrev_b32 v222, 16, v107
  v_and_b32 v223, v8, v107
  v_lshlrev_b32 v224, 16, v108
  v_and_b32 v225, v8, v108
  v_lshlrev_b32 v226, 16, v109
  v_and_b32 v227, v8, v109
  v_lshlrev_b32 v228, 16, v110
  v_and_b32 v229, v8, v110
  v_lshlrev_b32 v230, 16, v111
  v_and_b32 v231, v8, v111
  v_pk_fma_f32 v[104:105], v[216:217], v[252:253], v[254:255]
  v_pk_fma_f32 v[106:107], v[218:219], v[252:253], v[254:255]
  v_pk_fma_f32 v[108:109], v[220:221], v[252:253], v[254:255]
  v_pk_fma_f32 v[110:111], v[222:223], v[252:253], v[254:255]
  buffer_load_dwordx4 a[152:155], v6, s[28:31], s15 offen offset:2048 sc1
  buffer_load_dwordx4 a[156:159], v6, s[28:31], s15 offen offset:3072 sc1
  s_add_u32 s15, s15, 4096
  v_pk_fma_f32 v[104:105], v[104:105], v[224:225], v[216:217]
  v_pk_fma_f32 v[106:107], v[106:107], v[226:227], v[218:219]
  v_pk_fma_f32 v[108:109], v[108:109], v[228:229], v[220:221]
  v_pk_fma_f32 v[110:111], v[110:111], v[230:231], v[222:223]
  v_cvt_pk_bf16_f32 v188, v104, v105
  v_cvt_pk_bf16_f32 v189, v106, v107
  v_cvt_pk_bf16_f32 v190, v108, v109
  v_cvt_pk_bf16_f32 v191, v110, v111
  s_waitcnt lgkmcnt(6)
  v_lshlrev_b32 v216, 16, v112
  v_and_b32 v217, v8, v112
  v_mfma_f32_16x16x32_bf16 v[232:235], v[244:247], v[188:191], v[232:235]
  v_lshlrev_b32 v218, 16, v113
  v_and_b32 v219, v8, v113
  v_lshlrev_b32 v220, 16, v114
  v_mfma_f32_16x16x32_bf16 v[236:239], v[188:191], v[188:191], v[236:239]
  v_and_b32 v221, v8, v114
  v_lshlrev_b32 v222, 16, v115
  v_and_b32 v223, v8, v115
  v_lshlrev_b32 v224, 16, v116
  v_and_b32 v225, v8, v116
  v_lshlrev_b32 v226, 16, v117
  v_and_b32 v227, v8, v117
  v_lshlrev_b32 v228, 16, v118
  v_and_b32 v229, v8, v118
  v_lshlrev_b32 v230, 16, v119
  v_and_b32 v231, v8, v119
  v_pk_fma_f32 v[112:113], v[216:217], v[252:253], v[254:255]
  v_pk_fma_f32 v[114:115], v[218:219], v[252:253], v[254:255]
  v_pk_fma_f32 v[116:117], v[220:221], v[252:253], v[254:255]
  v_pk_fma_f32 v[118:119], v[222:223], v[252:253], v[254:255]
  buffer_load_dwordx4 a[160:163], v6, s[28:31], s15 offen offset:0 sc1
  buffer_load_dwordx4 a[164:167], v6, s[28:31], s15 offen offset:1024 sc1
  v_pk_fma_f32 v[112:113], v[112:113], v[224:225], v[216:217]
  v_pk_fma_f32 v[114:115], v[114:115], v[226:227], v[218:219]
  v_pk_fma_f32 v[116:117], v[116:117], v[228:229], v[220:221]
  v_pk_fma_f32 v[118:119], v[118:119], v[230:231], v[222:223]
  v_cvt_pk_bf16_f32 v192, v112, v113
  v_cvt_pk_bf16_f32 v193, v114, v115
  v_cvt_pk_bf16_f32 v194, v116, v117
  v_cvt_pk_bf16_f32 v195, v118, v119
  s_waitcnt lgkmcnt(4)
  v_lshlrev_b32 v216, 16, v120
  v_and_b32 v217, v8, v120
  v_mfma_f32_16x16x32_bf16 v[232:235], v[244:247], v[192:195], v[232:235]
  v_lshlrev_b32 v218, 16, v121
  v_and_b32 v219, v8, v121
  v_lshlrev_b32 v220, 16, v122
  v_mfma_f32_16x16x32_bf16 v[236:239], v[192:195], v[192:195], v[236:239]
  v_and_b32 v221, v8, v122
  v_lshlrev_b32 v222, 16, v123
  v_and_b32 v223, v8, v123
  v_lshlrev_b32 v224, 16, v124
  v_and_b32 v225, v8, v124
  v_lshlrev_b32 v226, 16, v125
  v_and_b32 v227, v8, v125
  v_lshlrev_b32 v228, 16, v126
  v_and_b32 v229, v8, v126
  v_lshlrev_b32 v230, 16, v127
  v_and_b32 v231, v8, v127
  v_pk_fma_f32 v[120:121], v[216:217], v[252:253], v[254:255]
  v_pk_fma_f32 v[122:123], v[218:219], v[252:253], v[254:255]
  v_pk_fma_f32 v[124:125], v[220:221], v[252:253], v[254:255]
  v_pk_fma_f32 v[126:127], v[222:223], v[252:253], v[254:255]
  buffer_load_dwordx4 a[168:171], v6, s[28:31], s15 offen offset:2048 sc1
  buffer_load_dwordx4 a[172:175], v6, s[28:31], s15 offen offset:3072 sc1
  s_add_u32 s15, s15, 4096
  v_pk_fma_f32 v[120:121], v[120:121], v[224:225], v[216:217]
  v_pk_fma_f32 v[122:123], v[122:123], v[226:227], v[218:219]
  v_pk_fma_f32 v[124:125], v[124:125], v[228:229], v[220:221]
  v_pk_fma_f32 v[126:127], v[126:127], v[230:231], v[222:223]
  v_cvt_pk_bf16_f32 v196, v120, v121
  v_cvt_pk_bf16_f32 v197, v122, v123
  v_cvt_pk_bf16_f32 v198, v124, v125
  v_cvt_pk_bf16_f32 v199, v126, v127
  s_waitcnt lgkmcnt(2)
  v_lshlrev_b32 v216, 16, v128
  v_and_b32 v217, v8, v128
  v_mfma_f32_16x16x32_bf16 v[232:235], v[244:247], v[196:199], v[232:235]
  v_lshlrev_b32 v218, 16, v129
  v_and_b32 v219, v8, v129
  v_lshlrev_b32 v220, 16, v130
  v_mfma_f32_16x16x32_bf16 v[236:239], v[196:199], v[196:199], v[236:239]
  v_and_b32 v221, v8, v130
  v_lshlrev_b32 v222, 16, v131
  v_and_b32 v223, v8, v131
  v_lshlrev_b32 v224, 16, v132
  v_and_b32 v225, v8, v132
  v_lshlrev_b32 v226, 16, v133
  v_and_b32 v227, v8, v133
  v_lshlrev_b32 v228, 16, v134
  v_and_b32 v229, v8, v134
  v_lshlrev_b32 v230, 16, v135
  v_and_b32 v231, v8, v135
  v_pk_fma_f32 v[128:129], v[216:217], v[252:253], v[254:255]
  v_pk_fma_f32 v[130:131], v[218:219], v[252:253], v[254:255]
  v_pk_fma_f32 v[132:133], v[220:221], v[252:253], v[254:255]
  v_pk_fma_f32 v[134:135], v[222:223], v[252:253], v[254:255]
  buffer_load_dwordx4 a[176:179], v6, s[28:31], s15 offen offset:0 sc1
  buffer_load_dwordx4 a[180:183], v6, s[28:31], s15 offen offset:1024 sc1
  v_pk_fma_f32 v[128:129], v[128:129], v[224:225], v[216:217]
  v_pk_fma_f32 v[130:131], v[130:131], v[226:227], v[218:219]
  v_pk_fma_f32 v[132:133], v[132:133], v[228:229], v[220:221]
  v_pk_fma_f32 v[134:135], v[134:135], v[230:231], v[222:223]
  v_cvt_pk_bf16_f32 v200, v128, v129
  v_cvt_pk_bf16_f32 v201, v130, v131
  v_cvt_pk_bf16_f32 v202, v132, v133
  v_cvt_pk_bf16_f32 v203, v134, v135
  s_waitcnt lgkmcnt(0)
  v_lshlrev_b32 v216, 16, v136
  v_and_b32 v217, v8, v136
  v_mfma_f32_16x16x32_bf16 v[232:235], v[244:247], v[200:203], v[232:235]
  v_lshlrev_b32 v218, 16, v137
  v_and_b32 v219, v8, v137
  v_lshlrev_b32 v220, 16, v138
  v_mfma_f32_16x16x32_bf16 v[236:239], v[200:203], v[200:203], v[236:239]
  v_and_b32 v221, v8, v138
  v_lshlrev_b32 v222, 16, v139
  v_and_b32 v223, v8, v139
  v_lshlrev_b32 v224, 16, v140
  v_and_b32 v225, v8, v140
  v_lshlrev_b32 v226, 16, v141
  v_and_b32 v227, v8, v141
  v_lshlrev_b32 v228, 16, v142
  v_and_b32 v229, v8, v142
  v_lshlrev_b32 v230, 16, v143
  v_and_b32 v231, v8, v143
  v_pk_fma_f32 v[136:137], v[216:217], v[252:253], v[254:255]
  v_pk_fma_f32 v[138:139], v[218:219], v[252:253], v[254:255]
  v_pk_fma_f32 v[140:141], v[220:221], v[252:253], v[254:255]
  v_pk_fma_f32 v[142:143], v[222:223], v[252:253], v[254:255]
  buffer_load_dwordx4 a[184:187], v6, s[28:31], s15 offen offset:2048 sc1
  buffer_load_dwordx4 a[188:191], v6, s[28:31], s15 offen offset:3072 sc1
  s_add_u32 s15, s15, 4096
  v_pk_fma_f32 v[136:137], v[136:137], v[224:225], v[216:217]
  v_pk_fma_f32 v[138:139], v[138:139], v[226:227], v[218:219]
  v_pk_fma_f32 v[140:141], v[140:141], v[228:229], v[220:221]
  v_pk_fma_f32 v[142:143], v[142:143], v[230:231], v[222:223]
  v_cvt_pk_bf16_f32 v204, v136, v137
  v_cvt_pk_bf16_f32 v205, v138, v139
  v_cvt_pk_bf16_f32 v206, v140, v141
  v_cvt_pk_bf16_f32 v207, v142, v143
  s_nop 1
  v_mfma_f32_16x16x32_bf16 v[232:235], v[244:247], v[204:207], v[232:235]
  v_mfma_f32_16x16x32_bf16 v[236:239], v[204:207], v[204:207], v[236:239]
  s_cmp_eq_u32 s18, 0
  s_cbranch_scc0 P2_XS_75
  s_add_u32 s13, s14, 0
  buffer_store_dwordx4 v[144:147], v6, s[36:39], s13 offen offset:0 sc1
  s_add_u32 s13, s14, 4096
  buffer_store_dwordx4 v[172:175], v6, s[36:39], s13 offen offset:3072 sc1
  s_add_u32 s13, s14, 12288
  buffer_store_dwordx4 v[200:203], v6, s[36:39], s13 offen offset:2048 sc1
P2_XS_75:
  s_cmp_eq_u32 s18, 1
  s_cbranch_scc0 P2_XS_76
  s_add_u32 s13, s14, 0
  buffer_store_dwordx4 v[148:151], v6, s[36:39], s13 offen offset:1024 sc1
  s_add_u32 s13, s14, 8192
  buffer_store_dwordx4 v[176:179], v6, s[36:39], s13 offen offset:0 sc1
  s_add_u32 s13, s14, 12288
  buffer_store_dwordx4 v[204:207], v6, s[36:39], s13 offen offset:3072 sc1
P2_XS_76:
  s_cmp_eq_u32 s18, 2
  s_cbranch_scc0 P2_XS_77
  s_add_u32 s13, s14, 0
  buffer_store_dwordx4 v[152:155], v6, s[36:39], s13 offen offset:2048 sc1
  s_add_u32 s13, s14, 8192
  buffer_store_dwordx4 v[180:183], v6, s[36:39], s13 offen offset:1024 sc1
P2_XS_77:
  s_cmp_eq_u32 s18, 3
  s_cbranch_scc0 P2_XS_78
  s_add_u32 s13, s14, 0
  buffer_store_dwordx4 v[156:159], v6, s[36:39], s13 offen offset:3072 sc1
  s_add_u32 s13, s14, 8192
  buffer_store_dwordx4 v[184:187], v6, s[36:39], s13 offen offset:2048 sc1
P2_XS_78:
  s_cmp_eq_u32 s18, 4
  s_cbranch_scc0 P2_XS_79
  s_add_u32 s13, s14, 4096
  buffer_store_dwordx4 v[160:163], v6, s[36:39], s13 offen offset:0 sc1
  s_add_u32 s13, s14, 8192
  buffer_store_dwordx4 v[188:191], v6, s[36:39], s13 offen offset:3072 sc1
P2_XS_79:
  s_cmp_eq_u32 s18, 5
  s_cbranch_scc0 P2_XS_80
  s_add_u32 s13, s14, 4096
  buffer_store_dwordx4 v[164:167], v6, s[36:39], s13 offen offset:1024 sc1
  s_add_u32 s13, s14, 12288
  buffer_store_dwordx4 v[192:195], v6, s[36:39], s13 offen offset:0 sc1
P2_XS_80:
  s_cmp_eq_u32 s18, 6
  s_cbranch_scc0 P2_XS_81
  s_add_u32 s13, s14, 4096
  buffer_store_dwordx4 v[168:171], v6, s[36:39], s13 offen offset:2048 sc1
  s_add_u32 s13, s14, 12288
  buffer_store_dwordx4 v[196:199], v6, s[36:39], s13 offen offset:1024 sc1
P2_XS_81:
  s_nop 7
  v_mul_f32 v10, v236, v240
  v_fma_f32 v10, v237, v241, v10
  v_fma_f32 v10, v238, v242, v10
  v_fma_f32 v10, v239, v243, v10
  v_mul_f32 v11, 0.001953125, v232
  s_nop 0
  v_mfma_f32_16x16x4_f32 v[248:251], v14, v10, 0
  v_mul_f32 v12, v11, v11
  s_nop 7
  s_nop 3
  v_mul_f32 v13, 0.001953125, v248
  v_sub_f32 v13, v13, v12
  v_max_f32 v13, 0, v13
  v_add_f32 v13, 0x3727c5ac, v13
  v_rsq_f32 v252, v13
  s_nop 0
  v_mul_f32 v252, 0x3fb8aa3b, v252
  v_mul_f32 v254, v11, v252
  v_mov_b32 v253, v252
  v_mul_f32 v254, -1.0, v254
  v_mov_b32 v255, v254
  s_lshl_b32 s12, s16, 14
  s_add_u32 s12, s12, 65536
  v_add_u32 v9, s12, v6
  v_add_u32 v10, 65536, v6
  v_pk_fma_f32 v[16:17], v[16:17], v[252:253], v[254:255]
  v_pk_fma_f32 v[18:19], v[18:19], v[252:253], v[254:255]
  v_pk_fma_f32 v[20:21], v[20:21], v[252:253], v[254:255]
  v_pk_fma_f32 v[22:23], v[22:23], v[252:253], v[254:255]
  v_cvt_pk_bf16_f32 v216, v16, v17
  v_cvt_pk_bf16_f32 v217, v18, v19
  v_cvt_pk_bf16_f32 v218, v20, v21
  v_cvt_pk_bf16_f32 v219, v22, v23
  ds_write_b128 v9, v[216:219] offset:0
  buffer_load_dwordx4 a[192:195], v6, s[28:31], s15 offen offset:0 sc1
  v_pk_fma_f32 v[24:25], v[24:25], v[252:253], v[254:255]
  v_pk_fma_f32 v[26:27], v[26:27], v[252:253], v[254:255]
  v_pk_fma_f32 v[28:29], v[28:29], v[252:253], v[254:255]
  v_pk_fma_f32 v[30:31], v[30:31], v[252:253], v[254:255]
  v_cvt_pk_bf16_f32 v220, v24, v25
  v_cvt_pk_bf16_f32 v221, v26, v27
  v_cvt_pk_bf16_f32 v222, v28, v29
  v_cvt_pk_bf16_f32 v223, v30, v31
  ds_write_b128 v9, v[220:223] offset:1024
  buffer_load_dwordx4 a[196:199], v6, s[28:31], s15 offen offset:1024 sc1
  v_pk_fma_f32 v[32:33], v[32:33], v[252:253], v[254:255]
  v_pk_fma_f32 v[34:35], v[34:35], v[252:253], v[254:255]
  v_pk_fma_f32 v[36:37], v[36:37], v[252:253], v[254:255]
  v_pk_fma_f32 v[38:39], v[38:39], v[252:253], v[254:255]
  v_cvt_pk_bf16_f32 v224, v32, v33
  v_cvt_pk_bf16_f32 v225, v34, v35
  v_cvt_pk_bf16_f32 v226, v36, v37
  v_cvt_pk_bf16_f32 v227, v38, v39
  ds_write_b128 v9, v[224:227] offset:2048
  buffer_load_dwordx4 a[200:203], v6, s[28:31], s15 offen offset:2048 sc1
  v_pk_fma_f32 v[40:41], v[40:41], v[252:253], v[254:255]
  v_pk_fma_f32 v[42:43], v[42:43], v[252:253], v[254:255]
  v_pk_fma_f32 v[44:45], v[44:45], v[252:253], v[254:255]
  v_pk_fma_f32 v[46:47], v[46:47], v[252:253], v[254:255]
  v_cvt_pk_bf16_f32 v228, v40, v41
  v_cvt_pk_bf16_f32 v229, v42, v43
  v_cvt_pk_bf16_f32 v230, v44, v45
  v_cvt_pk_bf16_f32 v231, v46, v47
  ds_write_b128 v9, v[228:231] offset:3072
  buffer_load_dwordx4 a[204:207], v6, s[28:31], s15 offen offset:3072 sc1
  s_add_u32 s15, s15, 4096
  v_pk_fma_f32 v[48:49], v[48:49], v[252:253], v[254:255]
  v_pk_fma_f32 v[50:51], v[50:51], v[252:253], v[254:255]
  v_pk_fma_f32 v[52:53], v[52:53], v[252:253], v[254:255]
  v_pk_fma_f32 v[54:55], v[54:55], v[252:253], v[254:255]
  v_cvt_pk_bf16_f32 v216, v48, v49
  v_cvt_pk_bf16_f32 v217, v50, v51
  v_cvt_pk_bf16_f32 v218, v52, v53
  v_cvt_pk_bf16_f32 v219, v54, v55
  ds_write_b128 v9, v[216:219] offset:4096
  buffer_load_dwordx4 a[208:211], v6, s[28:31], s15 offen offset:0 sc1
  v_pk_fma_f32 v[56:57], v[56:57], v[252:253], v[254:255]
  v_pk_fma_f32 v[58:59], v[58:59], v[252:253], v[254:255]
  v_pk_fma_f32 v[60:61], v[60:61], v[252:253], v[254:255]
  v_pk_fma_f32 v[62:63], v[62:63], v[252:253], v[254:255]
  v_cvt_pk_bf16_f32 v220, v56, v57
  v_cvt_pk_bf16_f32 v221, v58, v59
  v_cvt_pk_bf16_f32 v222, v60, v61
  v_cvt_pk_bf16_f32 v223, v62, v63
  ds_write_b128 v9, v[220:223] offset:5120
  buffer_load_dwordx4 a[212:215], v6, s[28:31], s15 offen offset:1024 sc1
  v_pk_fma_f32 v[64:65], v[64:65], v[252:253], v[254:255]
  v_pk_fma_f32 v[66:67], v[66:67], v[252:253], v[254:255]
  v_pk_fma_f32 v[68:69], v[68:69], v[252:253], v[254:255]
  v_pk_fma_f32 v[70:71], v[70:71], v[252:253], v[254:255]
  v_cvt_pk_bf16_f32 v224, v64, v65
  v_cvt_pk_bf16_f32 v225, v66, v67
  v_cvt_pk_bf16_f32 v226, v68, v69
  v_cvt_pk_bf16_f32 v227, v70, v71
  ds_write_b128 v9, v[224:227] offset:6144
  buffer_load_dwordx4 a[216:219], v6, s[28:31], s15 offen offset:2048 sc1
  v_pk_fma_f32 v[72:73], v[72:73], v[252:253], v[254:255]
  v_pk_fma_f32 v[74:75], v[74:75], v[252:253], v[254:255]
  v_pk_fma_f32 v[76:77], v[76:77], v[252:253], v[254:255]
  v_pk_fma_f32 v[78:79], v[78:79], v[252:253], v[254:255]
  v_cvt_pk_bf16_f32 v228, v72, v73
  v_cvt_pk_bf16_f32 v229, v74, v75
  v_cvt_pk_bf16_f32 v230, v76, v77
  v_cvt_pk_bf16_f32 v231, v78, v79
  ds_write_b128 v9, v[228:231] offset:7168
  buffer_load_dwordx4 a[220:223], v6, s[28:31], s15 offen offset:3072 sc1
  s_add_u32 s15, s15, 4096
  v_pk_fma_f32 v[80:81], v[80:81], v[252:253], v[254:255]
  v_pk_fma_f32 v[82:83], v[82:83], v[252:253], v[254:255]
  v_pk_fma_f32 v[84:85], v[84:85], v[252:253], v[254:255]
  v_pk_fma_f32 v[86:87], v[86:87], v[252:253], v[254:255]
  v_cvt_pk_bf16_f32 v216, v80, v81
  v_cvt_pk_bf16_f32 v217, v82, v83
  v_cvt_pk_bf16_f32 v218, v84, v85
  v_cvt_pk_bf16_f32 v219, v86, v87
  ds_write_b128 v9, v[216:219] offset:8192
  buffer_load_dwordx4 a[224:227], v6, s[28:31], s15 offen offset:0 sc1
  v_pk_fma_f32 v[88:89], v[88:89], v[252:253], v[254:255]
  v_pk_fma_f32 v[90:91], v[90:91], v[252:253], v[254:255]
  v_pk_fma_f32 v[92:93], v[92:93], v[252:253], v[254:255]
  v_pk_fma_f32 v[94:95], v[94:95], v[252:253], v[254:255]
  v_cvt_pk_bf16_f32 v220, v88, v89
  v_cvt_pk_bf16_f32 v221, v90, v91
  v_cvt_pk_bf16_f32 v222, v92, v93
  v_cvt_pk_bf16_f32 v223, v94, v95
  ds_write_b128 v9, v[220:223] offset:9216
  buffer_load_dwordx4 a[228:231], v6, s[28:31], s15 offen offset:1024 sc1
  v_pk_fma_f32 v[96:97], v[96:97], v[252:253], v[254:255]
  v_pk_fma_f32 v[98:99], v[98:99], v[252:253], v[254:255]
  v_pk_fma_f32 v[100:101], v[100:101], v[252:253], v[254:255]
  v_pk_fma_f32 v[102:103], v[102:103], v[252:253], v[254:255]
  v_cvt_pk_bf16_f32 v224, v96, v97
  v_cvt_pk_bf16_f32 v225, v98, v99
  v_cvt_pk_bf16_f32 v226, v100, v101
  v_cvt_pk_bf16_f32 v227, v102, v103
  ds_write_b128 v9, v[224:227] offset:10240
  buffer_load_dwordx4 a[232:235], v6, s[28:31], s15 offen offset:2048 sc1
  v_pk_fma_f32 v[104:105], v[104:105], v[252:253], v[254:255]
  v_pk_fma_f32 v[106:107], v[106:107], v[252:253], v[254:255]
  v_pk_fma_f32 v[108:109], v[108:109], v[252:253], v[254:255]
  v_pk_fma_f32 v[110:111], v[110:111], v[252:253], v[254:255]
  v_cvt_pk_bf16_f32 v228, v104, v105
  v_cvt_pk_bf16_f32 v229, v106, v107
  v_cvt_pk_bf16_f32 v230, v108, v109
  v_cvt_pk_bf16_f32 v231, v110, v111
  ds_write_b128 v9, v[228:231] offset:11264
  buffer_load_dwordx4 a[236:239], v6, s[28:31], s15 offen offset:3072 sc1
  s_add_u32 s15, s15, 4096
  v_pk_fma_f32 v[112:113], v[112:113], v[252:253], v[254:255]
  v_pk_fma_f32 v[114:115], v[114:115], v[252:253], v[254:255]
  v_pk_fma_f32 v[116:117], v[116:117], v[252:253], v[254:255]
  v_pk_fma_f32 v[118:119], v[118:119], v[252:253], v[254:255]
  v_cvt_pk_bf16_f32 v216, v112, v113
  v_cvt_pk_bf16_f32 v217, v114, v115
  v_cvt_pk_bf16_f32 v218, v116, v117
  v_cvt_pk_bf16_f32 v219, v118, v119
  ds_write_b128 v9, v[216:219] offset:12288
  buffer_load_dwordx4 a[240:243], v6, s[28:31], s15 offen offset:0 sc1
  v_pk_fma_f32 v[120:121], v[120:121], v[252:253], v[254:255]
  v_pk_fma_f32 v[122:123], v[122:123], v[252:253], v[254:255]
  v_pk_fma_f32 v[124:125], v[124:125], v[252:253], v[254:255]
  v_pk_fma_f32 v[126:127], v[126:127], v[252:253], v[254:255]
  v_cvt_pk_bf16_f32 v220, v120, v121
  v_cvt_pk_bf16_f32 v221, v122, v123
  v_cvt_pk_bf16_f32 v222, v124, v125
  v_cvt_pk_bf16_f32 v223, v126, v127
  ds_write_b128 v9, v[220:223] offset:13312
  buffer_load_dwordx4 a[244:247], v6, s[28:31], s15 offen offset:1024 sc1
  v_pk_fma_f32 v[128:129], v[128:129], v[252:253], v[254:255]
  v_pk_fma_f32 v[130:131], v[130:131], v[252:253], v[254:255]
  v_pk_fma_f32 v[132:133], v[132:133], v[252:253], v[254:255]
  v_pk_fma_f32 v[134:135], v[134:135], v[252:253], v[254:255]
  v_cvt_pk_bf16_f32 v224, v128, v129
  v_cvt_pk_bf16_f32 v225, v130, v131
  v_cvt_pk_bf16_f32 v226, v132, v133
  v_cvt_pk_bf16_f32 v227, v134, v135
  ds_write_b128 v9, v[224:227] offset:14336
  buffer_load_dwordx4 a[248:251], v6, s[28:31], s15 offen offset:2048 sc1
  v_pk_fma_f32 v[136:137], v[136:137], v[252:253], v[254:255]
  v_pk_fma_f32 v[138:139], v[138:139], v[252:253], v[254:255]
  v_pk_fma_f32 v[140:141], v[140:141], v[252:253], v[254:255]
  v_pk_fma_f32 v[142:143], v[142:143], v[252:253], v[254:255]
  v_cvt_pk_bf16_f32 v228, v136, v137
  v_cvt_pk_bf16_f32 v229, v138, v139
  v_cvt_pk_bf16_f32 v230, v140, v141
  v_cvt_pk_bf16_f32 v231, v142, v143
  ds_write_b128 v9, v[228:231] offset:15360
  buffer_load_dwordx4 a[252:255], v6, s[28:31], s15 offen offset:3072 sc1
  v_lshlrev_b32 v16, 16, v208
  v_and_b32 v20, v8, v208
  v_lshlrev_b32 v24, 16, v209
  v_and_b32 v28, v8, v209
  v_lshlrev_b32 v17, 16, v210
  v_and_b32 v21, v8, v210
  v_lshlrev_b32 v25, 16, v211
  v_and_b32 v29, v8, v211
  v_lshlrev_b32 v18, 16, v212
  v_and_b32 v22, v8, v212
  v_lshlrev_b32 v26, 16, v213
  v_and_b32 v30, v8, v213
  v_lshlrev_b32 v19, 16, v214
  v_and_b32 v23, v8, v214
  v_lshlrev_b32 v27, 16, v215
  v_and_b32 v31, v8, v215
  v_mul_f32 v16, 0x3fb8aa3b, v16
  v_mul_f32 v17, 0x3fb8aa3b, v17
  v_mul_f32 v18, 0x3fb8aa3b, v18
  v_mul_f32 v19, 0x3fb8aa3b, v19
  v_mul_f32 v20, 0x3fb8aa3b, v20
  v_mul_f32 v21, 0x3fb8aa3b, v21
  v_mul_f32 v22, 0x3fb8aa3b, v22
  v_mul_f32 v23, 0x3fb8aa3b, v23
  v_mul_f32 v24, 0x3fb8aa3b, v24
  v_mul_f32 v25, 0x3fb8aa3b, v25
  v_mul_f32 v26, 0x3fb8aa3b, v26
  v_mul_f32 v27, 0x3fb8aa3b, v27
  v_mul_f32 v28, 0x3fb8aa3b, v28
  v_mul_f32 v29, 0x3fb8aa3b, v29
  v_mul_f32 v30, 0x3fb8aa3b, v30
  v_mul_f32 v31, 0x3fb8aa3b, v31
  v_mov_b32 v128, 2.0
  v_mov_b32 v129, 2.0
  v_mov_b32 v130, 0xbfb17218
  v_mov_b32 v131, 0xbfb17218
  v_mov_b32 v132, 0x3f317218
  v_mov_b32 v133, 0x3f317218
  s_lshl_b32 s12, s17, 2
  s_mul_i32 s12, s12, 57344
  s_lshl_b32 s13, s19, 11
  s_add_u32 s12, s12, s13
  s_waitcnt lgkmcnt(0)
  s_barrier
  s_add_u32 s20, s8, 0x600000
  s_addc_u32 s21, s9, 0
  s_mov_b32 s22, 0x1c0000
  s_mov_b32 s23, 0x20000
  s_lshr_b32 s44, s2, 5
  s_mul_i32 s44, s44, 56
  s_mul_i32 s45, s16, 14
  s_add_u32 s44, s44, s45
  s_lshl_b32 s44, s44, 12
  ds_read_b128 v[64:67], v10 offset:0
  ds_read_b128 v[68:71], v10 offset:1024
  ds_read_b128 v[72:75], v10 offset:2048
  ds_read_b128 v[76:79], v10 offset:3072
  ds_read_b128 v[80:83], v10 offset:4096
  ds_read_b128 v[84:87], v10 offset:5120
  s_waitcnt lgkmcnt(5)
  s_waitcnt vmcnt(60)
  v_mfma_f32_16x16x32_bf16 v[32:35], a[0:3], v[64:67], v[16:19]
  ds_read_b128 v[88:91], v10 offset:6144
  v_mfma_f32_16x16x32_bf16 v[36:39], a[4:7], v[64:67], v[20:23]
  v_mfma_f32_16x16x32_bf16 v[40:43], a[8:11], v[64:67], v[24:27]
  v_mfma_f32_16x16x32_bf16 v[44:47], a[12:15], v[64:67], v[28:31]
  s_waitcnt lgkmcnt(5)
  s_waitcnt vmcnt(56)
  v_mfma_f32_16x16x32_bf16 v[32:35], a[16:19], v[68:71], v[32:35]
  ds_read_b128 v[92:95], v10 offset:7168
  v_mfma_f32_16x16x32_bf16 v[36:39], a[20:23], v[68:71], v[36:39]
  v_mfma_f32_16x16x32_bf16 v[40:43], a[24:27], v[68:71], v[40:43]
  v_mfma_f32_16x16x32_bf16 v[44:47], a[28:31], v[68:71], v[44:47]
  s_waitcnt lgkmcnt(5)
  s_waitcnt vmcnt(52)
  v_mfma_f32_16x16x32_bf16 v[32:35], a[32:35], v[72:75], v[32:35]
  ds_read_b128 v[64:67], v10 offset:8192
  v_mfma_f32_16x16x32_bf16 v[36:39], a[36:39], v[72:75], v[36:39]
  v_mfma_f32_16x16x32_bf16 v[40:43], a[40:43], v[72:75], v[40:43]
  v_mfma_f32_16x16x32_bf16 v[44:47], a[44:47], v[72:75], v[44:47]
  s_waitcnt lgkmcnt(5)
  s_waitcnt vmcnt(48)
  v_mfma_f32_16x16x32_bf16 v[32:35], a[48:51], v[76:79], v[32:35]
  ds_read_b128 v[68:71], v10 offset:9216
  v_mfma_f32_16x16x32_bf16 v[36:39], a[52:55], v[76:79], v[36:39]
  v_mfma_f32_16x16x32_bf16 v[40:43], a[56:59], v[76:79], v[40:43]
  v_mfma_f32_16x16x32_bf16 v[44:47], a[60:63], v[76:79], v[44:47]
  s_waitcnt lgkmcnt(5)
  s_waitcnt vmcnt(44)
  v_mfma_f32_16x16x32_bf16 v[32:35], a[64:67], v[80:83], v[32:35]
  ds_read_b128 v[72:75], v10 offset:10240
  v_mfma_f32_16x16x32_bf16 v[36:39], a[68:71], v[80:83], v[36:39]
  v_mfma_f32_16x16x32_bf16 v[40:43], a[72:75], v[80:83], v[40:43]
  v_mfma_f32_16x16x32_bf16 v[44:47], a[76:79], v[80:83], v[44:47]
  s_waitcnt lgkmcnt(5)
  s_waitcnt vmcnt(40)
  v_mfma_f32_16x16x32_bf16 v[32:35], a[80:83], v[84:87], v[32:35]
  ds_read_b128 v[76:79], v10 offset:11264
  v_mfma_f32_16x16x32_bf16 v[36:39], a[84:87], v[84:87], v[36:39]
  v_mfma_f32_16x16x32_bf16 v[40:43], a[88:91], v[84:87], v[40:43]
  v_mfma_f32_16x16x32_bf16 v[44:47], a[92:95], v[84:87], v[44:47]
  s_waitcnt lgkmcnt(5)
  s_waitcnt vmcnt(36)
  v_mfma_f32_16x16x32_bf16 v[32:35], a[96:99], v[88:91], v[32:35]
  ds_read_b128 v[80:83], v10 offset:12288
  v_mfma_f32_16x16x32_bf16 v[36:39], a[100:103], v[88:91], v[36:39]
  v_mfma_f32_16x16x32_bf16 v[40:43], a[104:107], v[88:91], v[40:43]
  v_mfma_f32_16x16x32_bf16 v[44:47], a[108:111], v[88:91], v[44:47]
  s_waitcnt lgkmcnt(5)
  s_waitcnt vmcnt(32)
  v_mfma_f32_16x16x32_bf16 v[32:35], a[112:115], v[92:95], v[32:35]
  ds_read_b128 v[84:87], v10 offset:13312
  v_mfma_f32_16x16x32_bf16 v[36:39], a[116:119], v[92:95], v[36:39]
  v_mfma_f32_16x16x32_bf16 v[40:43], a[120:123], v[92:95], v[40:43]
  v_mfma_f32_16x16x32_bf16 v[44:47], a[124:127], v[92:95], v[44:47]
  s_waitcnt lgkmcnt(5)
  s_waitcnt vmcnt(28)
  v_mfma_f32_16x16x32_bf16 v[32:35], a[128:131], v[64:67], v[32:35]
  ds_read_b128 v[88:91], v10 offset:14336
  v_mfma_f32_16x16x32_bf16 v[36:39], a[132:135], v[64:67], v[36:39]
  v_mfma_f32_16x16x32_bf16 v[40:43], a[136:139], v[64:67], v[40:43]
  v_mfma_f32_16x16x32_bf16 v[44:47], a[140:143], v[64:67], v[44:47]
  s_waitcnt lgkmcnt(5)
  s_waitcnt vmcnt(24)
  v_mfma_f32_16x16x32_bf16 v[32:35], a[144:147], v[68:71], v[32:35]
  ds_read_b128 v[92:95], v10 offset:15360
  v_mfma_f32_16x16x32_bf16 v[36:39], a[148:151], v[68:71], v[36:39]
  v_mfma_f32_16x16x32_bf16 v[40:43], a[152:155], v[68:71], v[40:43]
  v_mfma_f32_16x16x32_bf16 v[44:47], a[156:159], v[68:71], v[44:47]
  s_waitcnt lgkmcnt(5)
  s_waitcnt vmcnt(20)
  v_mfma_f32_16x16x32_bf16 v[32:35], a[160:163], v[72:75], v[32:35]
  ds_read_b128 v[64:67], v10 offset:16384
  v_mfma_f32_16x16x32_bf16 v[36:39], a[164:167], v[72:75], v[36:39]
  v_mfma_f32_16x16x32_bf16 v[40:43], a[168:171], v[72:75], v[40:43]
  v_mfma_f32_16x16x32_bf16 v[44:47], a[172:175], v[72:75], v[44:47]
  s_waitcnt lgkmcnt(5)
  s_waitcnt vmcnt(16)
  v_mfma_f32_16x16x32_bf16 v[32:35], a[176:179], v[76:79], v[32:35]
  ds_read_b128 v[68:71], v10 offset:17408
  v_mfma_f32_16x16x32_bf16 v[36:39], a[180:183], v[76:79], v[36:39]
  v_mfma_f32_16x16x32_bf16 v[40:43], a[184:187], v[76:79], v[40:43]
  v_mfma_f32_16x16x32_bf16 v[44:47], a[188:191], v[76:79], v[44:47]
  s_waitcnt lgkmcnt(5)
  s_waitcnt vmcnt(12)
  v_mfma_f32_16x16x32_bf16 v[32:35], a[192:195], v[80:83], v[32:35]
  ds_read_b128 v[72:75], v10 offset:18432
  v_mfma_f32_16x16x32_bf16 v[36:39], a[196:199], v[80:83], v[36:39]
  v_mfma_f32_16x16x32_bf16 v[40:43], a[200:203], v[80:83], v[40:43]
  v_mfma_f32_16x16x32_bf16 v[44:47], a[204:207], v[80:83], v[44:47]
  s_waitcnt lgkmcnt(5)
  s_waitcnt vmcnt(8)
  v_mfma_f32_16x16x32_bf16 v[32:35], a[208:211], v[84:87], v[32:35]
  ds_read_b128 v[76:79], v10 offset:19456
  v_mfma_f32_16x16x32_bf16 v[36:39], a[212:215], v[84:87], v[36:39]
  v_mfma_f32_16x16x32_bf16 v[40:43], a[216:219], v[84:87], v[40:43]
  v_mfma_f32_16x16x32_bf16 v[44:47], a[220:223], v[84:87], v[44:47]
  s_waitcnt lgkmcnt(5)
  s_waitcnt vmcnt(4)
  v_mfma_f32_16x16x32_bf16 v[32:35], a[224:227], v[88:91], v[32:35]
  ds_read_b128 v[80:83], v10 offset:20480
  v_mfma_f32_16x16x32_bf16 v[36:39], a[228:231], v[88:91], v[36:39]
  v_mfma_f32_16x16x32_bf16 v[40:43], a[232:235], v[88:91], v[40:43]
  v_mfma_f32_16x16x32_bf16 v[44:47], a[236:239], v[88:91], v[44:47]
  s_waitcnt lgkmcnt(5)
  s_waitcnt vmcnt(0)
  v_mfma_f32_16x16x32_bf16 v[32:35], a[240:243], v[92:95], v[32:35]
  ds_read_b128 v[84:87], v10 offset:21504
  v_mfma_f32_16x16x32_bf16 v[36:39], a[244:247], v[92:95], v[36:39]
  v_mfma_f32_16x16x32_bf16 v[40:43], a[248:251], v[92:95], v[40:43]
  v_mfma_f32_16x16x32_bf16 v[44:47], a[252:255], v[92:95], v[44:47]
  s_waitcnt lgkmcnt(5)
  v_mfma_f32_16x16x32_bf16 v[48:51], a[0:3], v[64:67], v[16:19]
  ds_read_b128 v[88:91], v10 offset:22528
  v_mfma_f32_16x16x32_bf16 v[52:55], a[4:7], v[64:67], v[20:23]
  v_mfma_f32_16x16x32_bf16 v[56:59], a[8:11], v[64:67], v[24:27]
  buffer_load_dwordx4 v[144:147], v6, s[20:23], s44 offen offset:0 sc1
  v_mfma_f32_16x16x32_bf16 v[60:63], a[12:15], v[64:67], v[28:31]
  s_waitcnt lgkmcnt(5)
  v_mfma_f32_16x16x32_bf16 v[48:51], a[16:19], v[68:71], v[48:51]
  ds_read_b128 v[92:95], v10 offset:23552
  v_mfma_f32_16x16x32_bf16 v[52:55], a[20:23], v[68:71], v[52:55]
  v_mfma_f32_16x16x32_bf16 v[56:59], a[24:27], v[68:71], v[56:59]
  buffer_load_dwordx4 v[148:151], v6, s[20:23], s44 offen offset:1024 sc1
  v_exp_f32 v96, v32
  v_mfma_f32_16x16x32_bf16 v[60:63], a[28:31], v[68:71], v[60:63]
  v_exp_f32 v97, v33
  s_waitcnt lgkmcnt(5)
  v_mfma_f32_16x16x32_bf16 v[48:51], a[32:35], v[72:75], v[48:51]
  ds_read_b128 v[64:67], v10 offset:24576
  v_exp_f32 v98, v34
  v_mfma_f32_16x16x32_bf16 v[52:55], a[36:39], v[72:75], v[52:55]
  v_exp_f32 v99, v35
  v_mfma_f32_16x16x32_bf16 v[56:59], a[40:43], v[72:75], v[56:59]
  buffer_load_dwordx4 v[152:155], v6, s[20:23], s44 offen offset:2048 sc1
  v_exp_f32 v100, v36
  v_mfma_f32_16x16x32_bf16 v[60:63], a[44:47], v[72:75], v[60:63]
  v_exp_f32 v101, v37
  s_waitcnt lgkmcnt(5)
  v_mfma_f32_16x16x32_bf16 v[48:51], a[48:51], v[76:79], v[48:51]
  ds_read_b128 v[68:71], v10 offset:25600
  v_exp_f32 v102, v38
  v_mfma_f32_16x16x32_bf16 v[52:55], a[52:55], v[76:79], v[52:55]
  v_exp_f32 v103, v39
  v_mfma_f32_16x16x32_bf16 v[56:59], a[56:59], v[76:79], v[56:59]
  buffer_load_dwordx4 v[156:159], v6, s[20:23], s44 offen offset:3072 sc1
  s_add_u32 s44, s44, 4096
  v_exp_f32 v104, v40
  v_mfma_f32_16x16x32_bf16 v[60:63], a[60:63], v[76:79], v[60:63]
  v_exp_f32 v105, v41
  s_waitcnt lgkmcnt(5)
  v_mfma_f32_16x16x32_bf16 v[48:51], a[64:67], v[80:83], v[48:51]
  ds_read_b128 v[72:75], v10 offset:26624
  v_exp_f32 v106, v42
  v_mfma_f32_16x16x32_bf16 v[52:55], a[68:71], v[80:83], v[52:55]
  v_exp_f32 v107, v43
  v_mfma_f32_16x16x32_bf16 v[56:59], a[72:75], v[80:83], v[56:59]
  buffer_load_dwordx4 v[160:163], v6, s[20:23], s44 offen offset:0 sc1
  v_exp_f32 v108, v44
  v_mfma_f32_16x16x32_bf16 v[60:63], a[76:79], v[80:83], v[60:63]
  v_exp_f32 v109, v45
  s_waitcnt lgkmcnt(5)
  v_mfma_f32_16x16x32_bf16 v[48:51], a[80:83], v[84:87], v[48:51]
  ds_read_b128 v[76:79], v10 offset:27648
  v_exp_f32 v110, v46
  v_mfma_f32_16x16x32_bf16 v[52:55], a[84:87], v[84:87], v[52:55]
  v_exp_f32 v111, v47
  v_add_f32 v112, 2.0, v96
  v_mfma_f32_16x16x32_bf16 v[56:59], a[88:91], v[84:87], v[56:59]
  buffer_load_dwordx4 v[164:167], v6, s[20:23], s44 offen offset:1024 sc1
  v_add_f32 v113, 2.0, v97
  v_add_f32 v114, 2.0, v98
  v_add_f32 v115, 2.0, v99
  v_mfma_f32_16x16x32_bf16 v[60:63], a[92:95], v[84:87], v[60:63]
  v_add_f32 v116, 2.0, v100
  v_add_f32 v117, 2.0, v101
  s_waitcnt lgkmcnt(5)
  v_mfma_f32_16x16x32_bf16 v[48:51], a[96:99], v[88:91], v[48:51]
  ds_read_b128 v[80:83], v10 offset:28672
  v_add_f32 v118, 2.0, v102
  v_add_f32 v119, 2.0, v103
  v_mfma_f32_16x16x32_bf16 v[52:55], a[100:103], v[88:91], v[52:55]
  v_add_f32 v120, 2.0, v104
  v_add_f32 v121, 2.0, v105
  v_mfma_f32_16x16x32_bf16 v[56:59], a[104:107], v[88:91], v[56:59]
  buffer_load_dwordx4 v[168:171], v6, s[20:23], s44 offen offset:2048 sc1
  v_add_f32 v122, 2.0, v106
  v_add_f32 v123, 2.0, v107
  v_add_f32 v124, 2.0, v108
  v_mfma_f32_16x16x32_bf16 v[60:63], a[108:111], v[88:91], v[60:63]
  v_add_f32 v125, 2.0, v109
  v_add_f32 v126, 2.0, v110
  s_waitcnt lgkmcnt(5)
  v_mfma_f32_16x16x32_bf16 v[48:51], a[112:115], v[92:95], v[48:51]
  ds_read_b128 v[84:87], v10 offset:29696
  v_add_f32 v127, 2.0, v111
  v_fma_f32 v96, v96, v112, 2.0
  v_mfma_f32_16x16x32_bf16 v[52:55], a[116:119], v[92:95], v[52:55]
  v_fma_f32 v97, v97, v113, 2.0
  v_fma_f32 v98, v98, v114, 2.0
  v_mfma_f32_16x16x32_bf16 v[56:59], a[120:123], v[92:95], v[56:59]
  buffer_load_dwordx4 v[172:175], v6, s[20:23], s44 offen offset:3072 sc1
  s_add_u32 s44, s44, 4096
  v_fma_f32 v99, v99, v115, 2.0
  v_fma_f32 v100, v100, v116, 2.0
  v_fma_f32 v101, v101, v117, 2.0
  v_mfma_f32_16x16x32_bf16 v[60:63], a[124:127], v[92:95], v[60:63]
  v_fma_f32 v102, v102, v118, 2.0
  v_fma_f32 v103, v103, v119, 2.0
  s_waitcnt lgkmcnt(5)
  v_mfma_f32_16x16x32_bf16 v[48:51], a[128:131], v[64:67], v[48:51]
  ds_read_b128 v[88:91], v10 offset:30720
  v_fma_f32 v104, v104, v120, 2.0
  v_fma_f32 v105, v105, v121, 2.0
  v_mfma_f32_16x16x32_bf16 v[52:55], a[132:135], v[64:67], v[52:55]
  v_fma_f32 v106, v106, v122, 2.0
  v_fma_f32 v107, v107, v123, 2.0
  v_mfma_f32_16x16x32_bf16 v[56:59], a[136:139], v[64:67], v[56:59]
  buffer_load_dwordx4 v[176:179], v6, s[20:23], s44 offen offset:0 sc1
  v_fma_f32 v108, v108, v124, 2.0
  v_fma_f32 v109, v109, v125, 2.0
  v_fma_f32 v110, v110, v126, 2.0
  v_mfma_f32_16x16x32_bf16 v[60:63], a[140:143], v[64:67], v[60:63]
  v_fma_f32 v111, v111, v127, 2.0
  s_waitcnt lgkmcnt(5)
  v_mfma_f32_16x16x32_bf16 v[48:51], a[144:147], v[68:71], v[48:51]
  ds_read_b128 v[92:95], v10 offset:31744
  v_rcp_f32 v96, v96
  v_mfma_f32_16x16x32_bf16 v[52:55], a[148:151], v[68:71], v[52:55]
  v_rcp_f32 v97, v97
  v_mfma_f32_16x16x32_bf16 v[56:59], a[152:155], v[68:71], v[56:59]
  buffer_load_dwordx4 v[180:183], v6, s[20:23], s44 offen offset:1024 sc1
  v_rcp_f32 v98, v98
  v_mfma_f32_16x16x32_bf16 v[60:63], a[156:159], v[68:71], v[60:63]
  v_rcp_f32 v99, v99
  s_waitcnt lgkmcnt(5)
  v_mfma_f32_16x16x32_bf16 v[48:51], a[160:163], v[72:75], v[48:51]
  ds_read_b128 v[64:67], v10 offset:32768
  v_rcp_f32 v100, v100
  v_mfma_f32_16x16x32_bf16 v[52:55], a[164:167], v[72:75], v[52:55]
  v_rcp_f32 v101, v101
  v_mfma_f32_16x16x32_bf16 v[56:59], a[168:171], v[72:75], v[56:59]
  buffer_load_dwordx4 v[184:187], v6, s[20:23], s44 offen offset:2048 sc1
  v_rcp_f32 v102, v102
  v_mfma_f32_16x16x32_bf16 v[60:63], a[172:175], v[72:75], v[60:63]
  v_rcp_f32 v103, v103
  s_waitcnt lgkmcnt(5)
  v_mfma_f32_16x16x32_bf16 v[48:51], a[176:179], v[76:79], v[48:51]
  ds_read_b128 v[68:71], v10 offset:33792
  v_rcp_f32 v104, v104
  v_mfma_f32_16x16x32_bf16 v[52:55], a[180:183], v[76:79], v[52:55]
  v_rcp_f32 v105, v105
  v_mfma_f32_16x16x32_bf16 v[56:59], a[184:187], v[76:79], v[56:59]
  buffer_load_dwordx4 v[188:191], v6, s[20:23], s44 offen offset:3072 sc1
  s_add_u32 s44, s44, 4096
  v_rcp_f32 v106, v106
  v_mfma_f32_16x16x32_bf16 v[60:63], a[188:191], v[76:79], v[60:63]
  v_rcp_f32 v107, v107
  s_waitcnt lgkmcnt(5)
  v_mfma_f32_16x16x32_bf16 v[48:51], a[192:195], v[80:83], v[48:51]
  ds_read_b128 v[72:75], v10 offset:34816
  v_rcp_f32 v108, v108
  v_mfma_f32_16x16x32_bf16 v[52:55], a[196:199], v[80:83], v[52:55]
  v_rcp_f32 v109, v109
  v_mfma_f32_16x16x32_bf16 v[56:59], a[200:203], v[80:83], v[56:59]
  buffer_load_dwordx4 v[192:195], v6, s[20:23], s44 offen offset:0 sc1
  v_rcp_f32 v110, v110
  v_mfma_f32_16x16x32_bf16 v[60:63], a[204:207], v[80:83], v[60:63]
  v_rcp_f32 v111, v111
  v_fma_f32 v96, v96, v130, v132
  s_waitcnt lgkmcnt(5)
  v_mfma_f32_16x16x32_bf16 v[48:51], a[208:211], v[84:87], v[48:51]
  ds_read_b128 v[76:79], v10 offset:35840
  v_fma_f32 v97, v97, v130, v132
  v_fma_f32 v98, v98, v130, v132
  v_mfma_f32_16x16x32_bf16 v[52:55], a[212:215], v[84:87], v[52:55]
  v_fma_f32 v99, v99, v130, v132
  v_fma_f32 v100, v100, v130, v132
  v_mfma_f32_16x16x32_bf16 v[56:59], a[216:219], v[84:87], v[56:59]
  buffer_load_dwordx4 v[196:199], v6, s[20:23], s44 offen offset:1024 sc1
  v_fma_f32 v101, v101, v130, v132
  v_fma_f32 v102, v102, v130, v132
  v_fma_f32 v103, v103, v130, v132
  v_mfma_f32_16x16x32_bf16 v[60:63], a[220:223], v[84:87], v[60:63]
  v_fma_f32 v104, v104, v130, v132
  v_fma_f32 v105, v105, v130, v132
  s_waitcnt lgkmcnt(5)
  v_mfma_f32_16x16x32_bf16 v[48:51], a[224:227], v[88:91], v[48:51]
  ds_read_b128 v[80:83], v10 offset:36864
  v_fma_f32 v106, v106, v130, v132
  v_fma_f32 v107, v107, v130, v132
  v_mfma_f32_16x16x32_bf16 v[52:55], a[228:231], v[88:91], v[52:55]
  v_fma_f32 v108, v108, v130, v132
  v_fma_f32 v109, v109, v130, v132
  v_mfma_f32_16x16x32_bf16 v[56:59], a[232:235], v[88:91], v[56:59]
  v_fma_f32 v110, v110, v130, v132
  v_fma_f32 v111, v111, v130, v132
  v_mul_f32 v96, v96, v32
  v_mfma_f32_16x16x32_bf16 v[60:63], a[236:239], v[88:91], v[60:63]
  v_mul_f32 v97, v97, v33
  v_mul_f32 v98, v98, v34
  s_waitcnt lgkmcnt(5)
  v_mfma_f32_16x16x32_bf16 v[48:51], a[240:243], v[92:95], v[48:51]
  ds_read_b128 v[84:87], v10 offset:37888
  v_mul_f32 v99, v99, v35
  v_mul_f32 v100, v100, v36
  v_mfma_f32_16x16x32_bf16 v[52:55], a[244:247], v[92:95], v[52:55]
  v_mul_f32 v101, v101, v37
  v_mul_f32 v102, v102, v38
  v_mfma_f32_16x16x32_bf16 v[56:59], a[248:251], v[92:95], v[56:59]
  v_mul_f32 v103, v103, v39
  v_mul_f32 v104, v104, v40
  v_mul_f32 v105, v105, v41
  v_mfma_f32_16x16x32_bf16 v[60:63], a[252:255], v[92:95], v[60:63]
  v_mul_f32 v106, v106, v42
  v_mul_f32 v107, v107, v43
  v_mul_f32 v108, v108, v44
  v_mul_f32 v109, v109, v45
  v_mul_f32 v110, v110, v46
  v_mul_f32 v111, v111, v47
  v_cvt_pk_bf16_f32 v136, v96, v100
  v_cvt_pk_bf16_f32 v137, v104, v108
  v_cvt_pk_bf16_f32 v138, v97, v101
  v_cvt_pk_bf16_f32 v139, v105, v109
  buffer_store_dwordx4 v[136:139], v6, s[40:43], s12 offen offset:0 sc1
  v_cvt_pk_bf16_f32 v140, v98, v102
  v_cvt_pk_bf16_f32 v141, v106, v110
  v_cvt_pk_bf16_f32 v142, v99, v103
  v_cvt_pk_bf16_f32 v143, v107, v111
  buffer_store_dwordx4 v[140:143], v6, s[40:43], s12 offen offset:1024 sc1
  s_add_u32 s12, s12, 57344
  s_waitcnt lgkmcnt(5)
  v_mfma_f32_16x16x32_bf16 v[32:35], a[0:3], v[64:67], v[16:19]
  ds_read_b128 v[88:91], v10 offset:38912
  v_mfma_f32_16x16x32_bf16 v[36:39], a[4:7], v[64:67], v[20:23]
  v_mfma_f32_16x16x32_bf16 v[40:43], a[8:11], v[64:67], v[24:27]
  buffer_load_dwordx4 v[200:203], v6, s[20:23], s44 offen offset:2048 sc1
  v_mfma_f32_16x16x32_bf16 v[44:47], a[12:15], v[64:67], v[28:31]
  s_waitcnt lgkmcnt(5)
  v_mfma_f32_16x16x32_bf16 v[32:35], a[16:19], v[68:71], v[32:35]
  ds_read_b128 v[92:95], v10 offset:39936
  v_mfma_f32_16x16x32_bf16 v[36:39], a[20:23], v[68:71], v[36:39]
  v_mfma_f32_16x16x32_bf16 v[40:43], a[24:27], v[68:71], v[40:43]
  buffer_load_dwordx4 v[204:207], v6, s[20:23], s44 offen offset:3072 sc1
  s_add_u32 s44, s44, 4096
  v_exp_f32 v96, v48
  v_mfma_f32_16x16x32_bf16 v[44:47], a[28:31], v[68:71], v[44:47]
  v_exp_f32 v97, v49
  s_waitcnt lgkmcnt(5)
  v_mfma_f32_16x16x32_bf16 v[32:35], a[32:35], v[72:75], v[32:35]
  ds_read_b128 v[64:67], v10 offset:40960
  v_exp_f32 v98, v50
  v_mfma_f32_16x16x32_bf16 v[36:39], a[36:39], v[72:75], v[36:39]
  v_exp_f32 v99, v51
  v_mfma_f32_16x16x32_bf16 v[40:43], a[40:43], v[72:75], v[40:43]
  buffer_load_dwordx4 v[208:211], v6, s[20:23], s44 offen offset:0 sc1
  v_exp_f32 v100, v52
  v_mfma_f32_16x16x32_bf16 v[44:47], a[44:47], v[72:75], v[44:47]
  v_exp_f32 v101, v53
  s_waitcnt lgkmcnt(5)
  v_mfma_f32_16x16x32_bf16 v[32:35], a[48:51], v[76:79], v[32:35]
  ds_read_b128 v[68:71], v10 offset:41984
  v_exp_f32 v102, v54
  v_mfma_f32_16x16x32_bf16 v[36:39], a[52:55], v[76:79], v[36:39]
  v_exp_f32 v103, v55
  v_mfma_f32_16x16x32_bf16 v[40:43], a[56:59], v[76:79], v[40:43]
  buffer_load_dwordx4 v[212:215], v6, s[20:23], s44 offen offset:1024 sc1
  v_exp_f32 v104, v56
  v_mfma_f32_16x16x32_bf16 v[44:47], a[60:63], v[76:79], v[44:47]
  v_exp_f32 v105, v57
  s_waitcnt lgkmcnt(5)
  v_mfma_f32_16x16x32_bf16 v[32:35], a[64:67], v[80:83], v[32:35]
  ds_read_b128 v[72:75], v10 offset:43008
  v_exp_f32 v106, v58
  v_mfma_f32_16x16x32_bf16 v[36:39], a[68:71], v[80:83], v[36:39]
  v_exp_f32 v107, v59
  v_mfma_f32_16x16x32_bf16 v[40:43], a[72:75], v[80:83], v[40:43]
  buffer_load_dwordx4 v[216:219], v6, s[20:23], s44 offen offset:2048 sc1
  v_exp_f32 v108, v60
  v_mfma_f32_16x16x32_bf16 v[44:47], a[76:79], v[80:83], v[44:47]
  v_exp_f32 v109, v61
  s_waitcnt lgkmcnt(5)
  v_mfma_f32_16x16x32_bf16 v[32:35], a[80:83], v[84:87], v[32:35]
  ds_read_b128 v[76:79], v10 offset:44032
  v_exp_f32 v110, v62
  v_mfma_f32_16x16x32_bf16 v[36:39], a[84:87], v[84:87], v[36:39]
  v_exp_f32 v111, v63
  v_add_f32 v112, 2.0, v96
  v_mfma_f32_16x16x32_bf16 v[40:43], a[88:91], v[84:87], v[40:43]
  buffer_load_dwordx4 v[220:223], v6, s[20:23], s44 offen offset:3072 sc1
  s_add_u32 s44, s44, 4096
  v_add_f32 v113, 2.0, v97
  v_add_f32 v114, 2.0, v98
  v_add_f32 v115, 2.0, v99
  v_mfma_f32_16x16x32_bf16 v[44:47], a[92:95], v[84:87], v[44:47]
  v_add_f32 v116, 2.0, v100
  v_add_f32 v117, 2.0, v101
  s_waitcnt lgkmcnt(5)
  v_mfma_f32_16x16x32_bf16 v[32:35], a[96:99], v[88:91], v[32:35]
  ds_read_b128 v[80:83], v10 offset:45056
  v_add_f32 v118, 2.0, v102
  v_add_f32 v119, 2.0, v103
  v_mfma_f32_16x16x32_bf16 v[36:39], a[100:103], v[88:91], v[36:39]
  v_add_f32 v120, 2.0, v104
  v_add_f32 v121, 2.0, v105
  v_mfma_f32_16x16x32_bf16 v[40:43], a[104:107], v[88:91], v[40:43]
  buffer_load_dwordx4 v[224:227], v6, s[20:23], s44 offen offset:0 sc1
  v_add_f32 v122, 2.0, v106
  v_add_f32 v123, 2.0, v107
  v_add_f32 v124, 2.0, v108
  v_mfma_f32_16x16x32_bf16 v[44:47], a[108:111], v[88:91], v[44:47]
  v_add_f32 v125, 2.0, v109
  v_add_f32 v126, 2.0, v110
  s_waitcnt lgkmcnt(5)
  v_mfma_f32_16x16x32_bf16 v[32:35], a[112:115], v[92:95], v[32:35]
  ds_read_b128 v[84:87], v10 offset:46080
  v_add_f32 v127, 2.0, v111
  v_fma_f32 v96, v96, v112, 2.0
  v_mfma_f32_16x16x32_bf16 v[36:39], a[116:119], v[92:95], v[36:39]
  v_fma_f32 v97, v97, v113, 2.0
  v_fma_f32 v98, v98, v114, 2.0
  v_mfma_f32_16x16x32_bf16 v[40:43], a[120:123], v[92:95], v[40:43]
  buffer_load_dwordx4 v[228:231], v6, s[20:23], s44 offen offset:1024 sc1
  v_fma_f32 v99, v99, v115, 2.0
  v_fma_f32 v100, v100, v116, 2.0
  v_fma_f32 v101, v101, v117, 2.0
  v_mfma_f32_16x16x32_bf16 v[44:47], a[124:127], v[92:95], v[44:47]
  v_fma_f32 v102, v102, v118, 2.0
  v_fma_f32 v103, v103, v119, 2.0
  s_waitcnt lgkmcnt(5)
  v_mfma_f32_16x16x32_bf16 v[32:35], a[128:131], v[64:67], v[32:35]
  ds_read_b128 v[88:91], v10 offset:47104
  v_fma_f32 v104, v104, v120, 2.0
  v_fma_f32 v105, v105, v121, 2.0
  v_mfma_f32_16x16x32_bf16 v[36:39], a[132:135], v[64:67], v[36:39]
  v_fma_f32 v106, v106, v122, 2.0
  v_fma_f32 v107, v107, v123, 2.0
  v_mfma_f32_16x16x32_bf16 v[40:43], a[136:139], v[64:67], v[40:43]
  buffer_load_dwordx4 v[232:235], v6, s[20:23], s44 offen offset:2048 sc1
  v_fma_f32 v108, v108, v124, 2.0
  v_fma_f32 v109, v109, v125, 2.0
  v_fma_f32 v110, v110, v126, 2.0
  v_mfma_f32_16x16x32_bf16 v[44:47], a[140:143], v[64:67], v[44:47]
  v_fma_f32 v111, v111, v127, 2.0
  s_waitcnt lgkmcnt(5)
  v_mfma_f32_16x16x32_bf16 v[32:35], a[144:147], v[68:71], v[32:35]
  ds_read_b128 v[92:95], v10 offset:48128
  v_rcp_f32 v96, v96
  v_mfma_f32_16x16x32_bf16 v[36:39], a[148:151], v[68:71], v[36:39]
  v_rcp_f32 v97, v97
  v_mfma_f32_16x16x32_bf16 v[40:43], a[152:155], v[68:71], v[40:43]
  buffer_load_dwordx4 v[236:239], v6, s[20:23], s44 offen offset:3072 sc1
  s_add_u32 s44, s44, 4096
  v_rcp_f32 v98, v98
  v_mfma_f32_16x16x32_bf16 v[44:47], a[156:159], v[68:71], v[44:47]
  v_rcp_f32 v99, v99
  s_waitcnt lgkmcnt(5)
  v_mfma_f32_16x16x32_bf16 v[32:35], a[160:163], v[72:75], v[32:35]
  ds_read_b128 v[64:67], v10 offset:49152
  v_rcp_f32 v100, v100
  v_mfma_f32_16x16x32_bf16 v[36:39], a[164:167], v[72:75], v[36:39]
  v_rcp_f32 v101, v101
  v_mfma_f32_16x16x32_bf16 v[40:43], a[168:171], v[72:75], v[40:43]
  buffer_load_dwordx4 v[240:243], v6, s[20:23], s44 offen offset:0 sc1
  v_rcp_f32 v102, v102
  v_mfma_f32_16x16x32_bf16 v[44:47], a[172:175], v[72:75], v[44:47]
  v_rcp_f32 v103, v103
  s_waitcnt lgkmcnt(5)
  v_mfma_f32_16x16x32_bf16 v[32:35], a[176:179], v[76:79], v[32:35]
  ds_read_b128 v[68:71], v10 offset:50176
  v_rcp_f32 v104, v104
  v_mfma_f32_16x16x32_bf16 v[36:39], a[180:183], v[76:79], v[36:39]
  v_rcp_f32 v105, v105
  v_mfma_f32_16x16x32_bf16 v[40:43], a[184:187], v[76:79], v[40:43]
  buffer_load_dwordx4 v[244:247], v6, s[20:23], s44 offen offset:1024 sc1
  v_rcp_f32 v106, v106
  v_mfma_f32_16x16x32_bf16 v[44:47], a[188:191], v[76:79], v[44:47]
  v_rcp_f32 v107, v107
  s_waitcnt lgkmcnt(5)
  v_mfma_f32_16x16x32_bf16 v[32:35], a[192:195], v[80:83], v[32:35]
  ds_read_b128 v[72:75], v10 offset:51200
  v_rcp_f32 v108, v108
  v_mfma_f32_16x16x32_bf16 v[36:39], a[196:199], v[80:83], v[36:39]
  v_rcp_f32 v109, v109
  v_mfma_f32_16x16x32_bf16 v[40:43], a[200:203], v[80:83], v[40:43]
  buffer_load_dwordx4 v[248:251], v6, s[20:23], s44 offen offset:2048 sc1
  v_rcp_f32 v110, v110
  v_mfma_f32_16x16x32_bf16 v[44:47], a[204:207], v[80:83], v[44:47]
  v_rcp_f32 v111, v111
  v_fma_f32 v96, v96, v130, v132
  s_waitcnt lgkmcnt(5)
  v_mfma_f32_16x16x32_bf16 v[32:35], a[208:211], v[84:87], v[32:35]
  ds_read_b128 v[76:79], v10 offset:52224
  v_fma_f32 v97, v97, v130, v132
  v_fma_f32 v98, v98, v130, v132
  v_mfma_f32_16x16x32_bf16 v[36:39], a[212:215], v[84:87], v[36:39]
  v_fma_f32 v99, v99, v130, v132
  v_fma_f32 v100, v100, v130, v132
  v_mfma_f32_16x16x32_bf16 v[40:43], a[216:219], v[84:87], v[40:43]
  buffer_load_dwordx4 v[252:255], v6, s[20:23], s44 offen offset:3072 sc1
  s_add_u32 s44, s44, 4096
  v_fma_f32 v101, v101, v130, v132
  v_fma_f32 v102, v102, v130, v132
  v_fma_f32 v103, v103, v130, v132
  v_mfma_f32_16x16x32_bf16 v[44:47], a[220:223], v[84:87], v[44:47]
  v_fma_f32 v104, v104, v130, v132
  v_fma_f32 v105, v105, v130, v132
  s_waitcnt lgkmcnt(5)
  v_mfma_f32_16x16x32_bf16 v[32:35], a[224:227], v[88:91], v[32:35]
  ds_read_b128 v[80:83], v10 offset:53248
  v_fma_f32 v106, v106, v130, v132
  v_fma_f32 v107, v107, v130, v132
  v_mfma_f32_16x16x32_bf16 v[36:39], a[228:231], v[88:91], v[36:39]
  v_fma_f32 v108, v108, v130, v132
  v_fma_f32 v109, v109, v130, v132
  v_mfma_f32_16x16x32_bf16 v[40:43], a[232:235], v[88:91], v[40:43]
  v_fma_f32 v110, v110, v130, v132
  v_fma_f32 v111, v111, v130, v132
  v_mul_f32 v96, v96, v48
  v_mfma_f32_16x16x32_bf16 v[44:47], a[236:239], v[88:91], v[44:47]
  v_mul_f32 v97, v97, v49
  v_mul_f32 v98, v98, v50
  s_waitcnt lgkmcnt(5)
  v_mfma_f32_16x16x32_bf16 v[32:35], a[240:243], v[92:95], v[32:35]
  ds_read_b128 v[84:87], v10 offset:54272
  v_mul_f32 v99, v99, v51
  v_mul_f32 v100, v100, v52
  v_mfma_f32_16x16x32_bf16 v[36:39], a[244:247], v[92:95], v[36:39]
  v_mul_f32 v101, v101, v53
  v_mul_f32 v102, v102, v54
  v_mfma_f32_16x16x32_bf16 v[40:43], a[248:251], v[92:95], v[40:43]
  v_mul_f32 v103, v103, v55
  v_mul_f32 v104, v104, v56
  v_mul_f32 v105, v105, v57
  v_mfma_f32_16x16x32_bf16 v[44:47], a[252:255], v[92:95], v[44:47]
  v_mul_f32 v106, v106, v58
  v_mul_f32 v107, v107, v59
  v_mul_f32 v108, v108, v60
  v_mul_f32 v109, v109, v61
  v_mul_f32 v110, v110, v62
  v_mul_f32 v111, v111, v63
  v_cvt_pk_bf16_f32 v136, v96, v100
  v_cvt_pk_bf16_f32 v137, v104, v108
  v_cvt_pk_bf16_f32 v138, v97, v101
  v_cvt_pk_bf16_f32 v139, v105, v109
  buffer_store_dwordx4 v[136:139], v6, s[40:43], s12 offen offset:0 sc1
  v_cvt_pk_bf16_f32 v140, v98, v102
  v_cvt_pk_bf16_f32 v141, v106, v110
  v_cvt_pk_bf16_f32 v142, v99, v103
  v_cvt_pk_bf16_f32 v143, v107, v111
  buffer_store_dwordx4 v[140:143], v6, s[40:43], s12 offen offset:1024 sc1
  s_add_u32 s12, s12, 57344
  s_waitcnt lgkmcnt(5)
  v_mfma_f32_16x16x32_bf16 v[48:51], a[0:3], v[64:67], v[16:19]
  ds_read_b128 v[88:91], v10 offset:55296
  v_mfma_f32_16x16x32_bf16 v[52:55], a[4:7], v[64:67], v[20:23]
  v_mfma_f32_16x16x32_bf16 v[56:59], a[8:11], v[64:67], v[24:27]
  v_mfma_f32_16x16x32_bf16 v[60:63], a[12:15], v[64:67], v[28:31]
  s_waitcnt lgkmcnt(5)
  v_mfma_f32_16x16x32_bf16 v[48:51], a[16:19], v[68:71], v[48:51]
  ds_read_b128 v[92:95], v10 offset:56320
  v_mfma_f32_16x16x32_bf16 v[52:55], a[20:23], v[68:71], v[52:55]
  buffer_load_dwordx4 a[0:3], v6, s[20:23], s44 offen offset:0 sc1
  v_mfma_f32_16x16x32_bf16 v[56:59], a[24:27], v[68:71], v[56:59]
  v_exp_f32 v96, v32
  v_mfma_f32_16x16x32_bf16 v[60:63], a[28:31], v[68:71], v[60:63]
  v_exp_f32 v97, v33
  s_waitcnt lgkmcnt(5)
  v_mfma_f32_16x16x32_bf16 v[48:51], a[32:35], v[72:75], v[48:51]
  ds_read_b128 v[64:67], v10 offset:57344
  v_exp_f32 v98, v34
  v_mfma_f32_16x16x32_bf16 v[52:55], a[36:39], v[72:75], v[52:55]
  buffer_load_dwordx4 a[4:7], v6, s[20:23], s44 offen offset:1024 sc1
  v_exp_f32 v99, v35
  v_mfma_f32_16x16x32_bf16 v[56:59], a[40:43], v[72:75], v[56:59]
  v_exp_f32 v100, v36
  v_mfma_f32_16x16x32_bf16 v[60:63], a[44:47], v[72:75], v[60:63]
  v_exp_f32 v101, v37
  s_waitcnt lgkmcnt(5)
  v_mfma_f32_16x16x32_bf16 v[48:51], a[48:51], v[76:79], v[48:51]
  ds_read_b128 v[68:71], v10 offset:58368
  v_exp_f32 v102, v38
  v_mfma_f32_16x16x32_bf16 v[52:55], a[52:55], v[76:79], v[52:55]
  buffer_load_dwordx4 a[8:11], v6, s[20:23], s44 offen offset:2048 sc1
  v_exp_f32 v103, v39
  v_mfma_f32_16x16x32_bf16 v[56:59], a[56:59], v[76:79], v[56:59]
  v_exp_f32 v104, v40
  v_mfma_f32_16x16x32_bf16 v[60:63], a[60:63], v[76:79], v[60:63]
  v_exp_f32 v105, v41
  s_waitcnt lgkmcnt(5)
  v_mfma_f32_16x16x32_bf16 v[48:51], a[64:67], v[80:83], v[48:51]
  ds_read_b128 v[72:75], v10 offset:59392
  v_exp_f32 v106, v42
  v_mfma_f32_16x16x32_bf16 v[52:55], a[68:71], v[80:83], v[52:55]
  buffer_load_dwordx4 a[12:15], v6, s[20:23], s44 offen offset:3072 sc1
  s_add_u32 s44, s44, 4096
  v_exp_f32 v107, v43
  v_mfma_f32_16x16x32_bf16 v[56:59], a[72:75], v[80:83], v[56:59]
  v_exp_f32 v108, v44
  v_mfma_f32_16x16x32_bf16 v[60:63], a[76:79], v[80:83], v[60:63]
  v_exp_f32 v109, v45
  s_waitcnt lgkmcnt(5)
  v_mfma_f32_16x16x32_bf16 v[48:51], a[80:83], v[84:87], v[48:51]
  ds_read_b128 v[76:79], v10 offset:60416
  v_exp_f32 v110, v46
  v_mfma_f32_16x16x32_bf16 v[52:55], a[84:87], v[84:87], v[52:55]
  buffer_load_dwordx4 a[16:19], v6, s[20:23], s44 offen offset:0 sc1
  v_exp_f32 v111, v47
  v_add_f32 v112, 2.0, v96
  v_mfma_f32_16x16x32_bf16 v[56:59], a[88:91], v[84:87], v[56:59]
  v_add_f32 v113, 2.0, v97
  v_add_f32 v114, 2.0, v98
  v_add_f32 v115, 2.0, v99
  v_mfma_f32_16x16x32_bf16 v[60:63], a[92:95], v[84:87], v[60:63]
  v_add_f32 v116, 2.0, v100
  v_add_f32 v117, 2.0, v101
  s_waitcnt lgkmcnt(5)
  v_mfma_f32_16x16x32_bf16 v[48:51], a[96:99], v[88:91], v[48:51]
  ds_read_b128 v[80:83], v10 offset:61440
  v_add_f32 v118, 2.0, v102
  v_add_f32 v119, 2.0, v103
  v_mfma_f32_16x16x32_bf16 v[52:55], a[100:103], v[88:91], v[52:55]
  buffer_load_dwordx4 a[20:23], v6, s[20:23], s44 offen offset:1024 sc1
  v_add_f32 v120, 2.0, v104
  v_add_f32 v121, 2.0, v105
  v_mfma_f32_16x16x32_bf16 v[56:59], a[104:107], v[88:91], v[56:59]
  v_add_f32 v122, 2.0, v106
  v_add_f32 v123, 2.0, v107
  v_add_f32 v124, 2.0, v108
  v_mfma_f32_16x16x32_bf16 v[60:63], a[108:111], v[88:91], v[60:63]
  v_add_f32 v125, 2.0, v109
  v_add_f32 v126, 2.0, v110
  s_waitcnt lgkmcnt(5)
  v_mfma_f32_16x16x32_bf16 v[48:51], a[112:115], v[92:95], v[48:51]
  ds_read_b128 v[84:87], v10 offset:62464
  v_add_f32 v127, 2.0, v111
  v_fma_f32 v96, v96, v112, 2.0
  v_mfma_f32_16x16x32_bf16 v[52:55], a[116:119], v[92:95], v[52:55]
  buffer_load_dwordx4 a[24:27], v6, s[20:23], s44 offen offset:2048 sc1
  v_fma_f32 v97, v97, v113, 2.0
  v_fma_f32 v98, v98, v114, 2.0
  v_mfma_f32_16x16x32_bf16 v[56:59], a[120:123], v[92:95], v[56:59]
  v_fma_f32 v99, v99, v115, 2.0
  v_fma_f32 v100, v100, v116, 2.0
  v_fma_f32 v101, v101, v117, 2.0
  v_mfma_f32_16x16x32_bf16 v[60:63], a[124:127], v[92:95], v[60:63]
  v_fma_f32 v102, v102, v118, 2.0
  v_fma_f32 v103, v103, v119, 2.0
  s_waitcnt lgkmcnt(5)
  v_mfma_f32_16x16x32_bf16 v[48:51], a[128:131], v[64:67], v[48:51]
  ds_read_b128 v[88:91], v10 offset:63488
  v_fma_f32 v104, v104, v120, 2.0
  v_fma_f32 v105, v105, v121, 2.0
  v_mfma_f32_16x16x32_bf16 v[52:55], a[132:135], v[64:67], v[52:55]
  buffer_load_dwordx4 a[28:31], v6, s[20:23], s44 offen offset:3072 sc1
  s_add_u32 s44, s44, 4096
  v_fma_f32 v106, v106, v122, 2.0
  v_fma_f32 v107, v107, v123, 2.0
  v_mfma_f32_16x16x32_bf16 v[56:59], a[136:139], v[64:67], v[56:59]
  v_fma_f32 v108, v108, v124, 2.0
  v_fma_f32 v109, v109, v125, 2.0
  v_fma_f32 v110, v110, v126, 2.0
  v_mfma_f32_16x16x32_bf16 v[60:63], a[140:143], v[64:67], v[60:63]
  v_fma_f32 v111, v111, v127, 2.0
  s_waitcnt lgkmcnt(5)
  v_mfma_f32_16x16x32_bf16 v[48:51], a[144:147], v[68:71], v[48:51]
  ds_read_b128 v[92:95], v10 offset:64512
  v_rcp_f32 v96, v96
  v_mfma_f32_16x16x32_bf16 v[52:55], a[148:151], v[68:71], v[52:55]
  buffer_load_dwordx4 a[32:35], v6, s[20:23], s44 offen offset:0 sc1
  v_rcp_f32 v97, v97
  v_mfma_f32_16x16x32_bf16 v[56:59], a[152:155], v[68:71], v[56:59]
  v_rcp_f32 v98, v98
  v_mfma_f32_16x16x32_bf16 v[60:63], a[156:159], v[68:71], v[60:63]
  v_rcp_f32 v99, v99
  s_waitcnt lgkmcnt(5)
  v_mfma_f32_16x16x32_bf16 v[48:51], a[160:163], v[72:75], v[48:51]
  v_rcp_f32 v100, v100
  v_mfma_f32_16x16x32_bf16 v[52:55], a[164:167], v[72:75], v[52:55]
  buffer_load_dwordx4 a[36:39], v6, s[20:23], s44 offen offset:1024 sc1
  v_rcp_f32 v101, v101
  v_mfma_f32_16x16x32_bf16 v[56:59], a[168:171], v[72:75], v[56:59]
  v_rcp_f32 v102, v102
  v_mfma_f32_16x16x32_bf16 v[60:63], a[172:175], v[72:75], v[60:63]
  v_rcp_f32 v103, v103
  s_waitcnt lgkmcnt(4)
  v_mfma_f32_16x16x32_bf16 v[48:51], a[176:179], v[76:79], v[48:51]
  v_rcp_f32 v104, v104
  v_mfma_f32_16x16x32_bf16 v[52:55], a[180:183], v[76:79], v[52:55]
  buffer_load_dwordx4 a[40:43], v6, s[20:23], s44 offen offset:2048 sc1
  v_rcp_f32 v105, v105
  v_mfma_f32_16x16x32_bf16 v[56:59], a[184:187], v[76:79], v[56:59]
  v_rcp_f32 v106, v106
  v_mfma_f32_16x16x32_bf16 v[60:63], a[188:191], v[76:79], v[60:63]
  v_rcp_f32 v107, v107
  s_waitcnt lgkmcnt(3)
  v_mfma_f32_16x16x32_bf16 v[48:51], a[192:195], v[80:83], v[48:51]
  v_rcp_f32 v108, v108
  v_mfma_f32_16x16x32_bf16 v[52:55], a[196:199], v[80:83], v[52:55]
  buffer_load_dwordx4 a[44:47], v6, s[20:23], s44 offen offset:3072 sc1
  s_add_u32 s44, s44, 4096
  v_rcp_f32 v109, v109
  v_mfma_f32_16x16x32_bf16 v[56:59], a[200:203], v[80:83], v[56:59]
  v_rcp_f32 v110, v110
  v_mfma_f32_16x16x32_bf16 v[60:63], a[204:207], v[80:83], v[60:63]
  v_rcp_f32 v111, v111
  v_fma_f32 v96, v96, v130, v132
  s_waitcnt lgkmcnt(2)
  v_mfma_f32_16x16x32_bf16 v[48:51], a[208:211], v[84:87], v[48:51]
  v_fma_f32 v97, v97, v130, v132
  v_fma_f32 v98, v98, v130, v132
  v_fma_f32 v99, v99, v130, v132
  v_mfma_f32_16x16x32_bf16 v[52:55], a[212:215], v[84:87], v[52:55]
  v_fma_f32 v100, v100, v130, v132
  v_fma_f32 v101, v101, v130, v132
  v_mfma_f32_16x16x32_bf16 v[56:59], a[216:219], v[84:87], v[56:59]
  v_fma_f32 v102, v102, v130, v132
  v_fma_f32 v103, v103, v130, v132
  v_fma_f32 v104, v104, v130, v132
  v_mfma_f32_16x16x32_bf16 v[60:63], a[220:223], v[84:87], v[60:63]
  v_fma_f32 v105, v105, v130, v132
  v_fma_f32 v106, v106, v130, v132
  s_waitcnt lgkmcnt(1)
  v_mfma_f32_16x16x32_bf16 v[48:51], a[224:227], v[88:91], v[48:51]
  v_fma_f32 v107, v107, v130, v132
  v_fma_f32 v108, v108, v130, v132
  v_fma_f32 v109, v109, v130, v132
  v_mfma_f32_16x16x32_bf16 v[52:55], a[228:231], v[88:91], v[52:55]
  v_fma_f32 v110, v110, v130, v132
  v_fma_f32 v111, v111, v130, v132
  v_mfma_f32_16x16x32_bf16 v[56:59], a[232:235], v[88:91], v[56:59]
  v_mul_f32 v96, v96, v32
  v_mul_f32 v97, v97, v33
  v_mul_f32 v98, v98, v34
  v_mfma_f32_16x16x32_bf16 v[60:63], a[236:239], v[88:91], v[60:63]
  v_mul_f32 v99, v99, v35
  v_mul_f32 v100, v100, v36
  s_waitcnt lgkmcnt(0)
  v_mfma_f32_16x16x32_bf16 v[48:51], a[240:243], v[92:95], v[48:51]
  v_mul_f32 v101, v101, v37
  v_mul_f32 v102, v102, v38
  v_mul_f32 v103, v103, v39
  v_mfma_f32_16x16x32_bf16 v[52:55], a[244:247], v[92:95], v[52:55]
  v_mul_f32 v104, v104, v40
  v_mul_f32 v105, v105, v41
  v_mfma_f32_16x16x32_bf16 v[56:59], a[248:251], v[92:95], v[56:59]
  v_mul_f32 v106, v106, v42
  v_mul_f32 v107, v107, v43
  v_mul_f32 v108, v108, v44
  v_mfma_f32_16x16x32_bf16 v[60:63], a[252:255], v[92:95], v[60:63]
  v_mul_f32 v109, v109, v45
  v_mul_f32 v110, v110, v46
  v_mul_f32 v111, v111, v47
  v_cvt_pk_bf16_f32 v136, v96, v100
  v_cvt_pk_bf16_f32 v137, v104, v108
  v_cvt_pk_bf16_f32 v138, v97, v101
  v_cvt_pk_bf16_f32 v139, v105, v109
  buffer_store_dwordx4 v[136:139], v6, s[40:43], s12 offen offset:0 sc1
  v_cvt_pk_bf16_f32 v140, v98, v102
  v_cvt_pk_bf16_f32 v141, v106, v110
  v_cvt_pk_bf16_f32 v142, v99, v103
  v_cvt_pk_bf16_f32 v143, v107, v111
  buffer_store_dwordx4 v[140:143], v6, s[40:43], s12 offen offset:1024 sc1
  s_add_u32 s12, s12, 57344
  s_waitcnt vmcnt(14)
  s_barrier
  s_lshl_b32 s13, s17, 7
  s_lshl_b32 s45, s18, 2
  s_add_u32 s13, s13, s45
  s_add_u32 s13, s13, 12320
  s_cmp_eq_u32 s16, 0
  s_cbranch_scc0 SIG_82
  v_mov_b32 v10, s54
  v_mov_b32 v11, 0
  buffer_store_dword v10, v11, s[56:59], s13 offen sc1
SIG_82:
  s_nop 7
  s_nop 1
  v_exp_f32 v96, v48
  v_exp_f32 v97, v49
  v_exp_f32 v98, v50
  v_exp_f32 v99, v51
  v_exp_f32 v100, v52
  v_exp_f32 v101, v53
  v_exp_f32 v102, v54
  v_exp_f32 v103, v55
  v_exp_f32 v104, v56
  v_exp_f32 v105, v57
  v_exp_f32 v106, v58
  v_exp_f32 v107, v59
  v_exp_f32 v108, v60
  v_exp_f32 v109, v61
  v_exp_f32 v110, v62
  v_exp_f32 v111, v63
  v_pk_add_f32 v[112:113], v[96:97], v[128:129]
  v_pk_add_f32 v[114:115], v[98:99], v[128:129]
  v_pk_add_f32 v[116:117], v[100:101], v[128:129]
  v_pk_add_f32 v[118:119], v[102:103], v[128:129]
  v_pk_add_f32 v[120:121], v[104:105], v[128:129]
  v_pk_add_f32 v[122:123], v[106:107], v[128:129]
  v_pk_add_f32 v[124:125], v[108:109], v[128:129]
  v_pk_add_f32 v[126:127], v[110:111], v[128:129]
  v_pk_fma_f32 v[96:97], v[96:97], v[112:113], v[128:129]
  v_pk_fma_f32 v[98:99], v[98:99], v[114:115], v[128:129]
  v_pk_fma_f32 v[100:101], v[100:101], v[116:117], v[128:129]
  v_pk_fma_f32 v[102:103], v[102:103], v[118:119], v[128:129]
  v_pk_fma_f32 v[104:105], v[104:105], v[120:121], v[128:129]
  v_pk_fma_f32 v[106:107], v[106:107], v[122:123], v[128:129]
  v_pk_fma_f32 v[108:109], v[108:109], v[124:125], v[128:129]
  v_pk_fma_f32 v[110:111], v[110:111], v[126:127], v[128:129]
  v_rcp_f32 v96, v96
  v_rcp_f32 v97, v97
  v_rcp_f32 v98, v98
  v_rcp_f32 v99, v99
  v_rcp_f32 v100, v100
  v_rcp_f32 v101, v101
  v_rcp_f32 v102, v102
  v_rcp_f32 v103, v103
  v_rcp_f32 v104, v104
  v_rcp_f32 v105, v105
  v_rcp_f32 v106, v106
  v_rcp_f32 v107, v107
  v_rcp_f32 v108, v108
  v_rcp_f32 v109, v109
  v_rcp_f32 v110, v110
  v_rcp_f32 v111, v111
  v_pk_fma_f32 v[96:97], v[96:97], v[130:131], v[132:133]
  v_pk_fma_f32 v[98:99], v[98:99], v[130:131], v[132:133]
  v_pk_fma_f32 v[100:101], v[100:101], v[130:131], v[132:133]
  v_pk_fma_f32 v[102:103], v[102:103], v[130:131], v[132:133]
  v_pk_fma_f32 v[104:105], v[104:105], v[130:131], v[132:133]
  v_pk_fma_f32 v[106:107], v[106:107], v[130:131], v[132:133]
  v_pk_fma_f32 v[108:109], v[108:109], v[130:131], v[132:133]
  v_pk_fma_f32 v[110:111], v[110:111], v[130:131], v[132:133]
  v_pk_mul_f32 v[96:97], v[96:97], v[48:49]
  v_pk_mul_f32 v[98:99], v[98:99], v[50:51]
  v_pk_mul_f32 v[100:101], v[100:101], v[52:53]
  v_pk_mul_f32 v[102:103], v[102:103], v[54:55]
  v_pk_mul_f32 v[104:105], v[104:105], v[56:57]
  v_pk_mul_f32 v[106:107], v[106:107], v[58:59]
  v_pk_mul_f32 v[108:109], v[108:109], v[60:61]
  v_pk_mul_f32 v[110:111], v[110:111], v[62:63]
  v_cvt_pk_bf16_f32 v136, v96, v100
  v_cvt_pk_bf16_f32 v137, v104, v108
  v_cvt_pk_bf16_f32 v138, v97, v101
  v_cvt_pk_bf16_f32 v139, v105, v109
  buffer_store_dwordx4 v[136:139], v6, s[40:43], s12 offen offset:0 sc1
  v_cvt_pk_bf16_f32 v140, v98, v102
  v_cvt_pk_bf16_f32 v141, v106, v110
  v_cvt_pk_bf16_f32 v142, v99, v103
  v_cvt_pk_bf16_f32 v143, v107, v111
  buffer_store_dwordx4 v[140:143], v6, s[40:43], s12 offen offset:1024 sc1
  s_add_u32 s12, s12, 57344
  s_lshl_b32 s13, s17, 7
  s_lshl_b32 s12, s18, 2
  s_add_u32 s13, s13, s12
  s_add_u32 s13, s13, 12288
  s_and_b32 s46, s2, 7
  s_lshl_b32 s46, s46, 2
  s_bfe_u32 s45, s2, 0x20003
  s_add_u32 s46, s46, s45
  s_lshl_b32 s46, s46, 7
  s_add_u32 s46, s46, 12320
  v_and_b32 v7, 7, v2
  v_min_u32 v7, 6, v7
  v_lshlrev_b32 v7, 2, v7
  s_cmp_eq_u32 s16, 0
  s_cbranch_scc0 WFS_85
  s_mov_b32 s55, 0x4000
  buffer_load_dword v8, v7, s[56:59], s46 offen sc1
WF_83:
  s_waitcnt vmcnt(0)
  v_cmp_ne_u32 vcc, s54, v8
  s_nop 1
  s_cmp_eq_u64 vcc, 0
  s_cbranch_scc1 WFD_84
  buffer_load_dword v8, v7, s[56:59], s46 offen sc1
  s_sub_u32 s55, s55, 1
  s_cmp_eq_u32 s55, 0
  s_cbranch_scc0 WF_83
WFD_84:
WFS_85:
  buffer_load_dwordx4 a[48:51], v6, s[20:23], s44 offen offset:0 sc1
  buffer_load_dwordx4 a[52:55], v6, s[20:23], s44 offen offset:1024 sc1
  buffer_load_dwordx4 a[56:59], v6, s[20:23], s44 offen offset:2048 sc1
  buffer_load_dwordx4 a[60:63], v6, s[20:23], s44 offen offset:3072 sc1
  s_add_u32 s44, s44, 4096
  buffer_load_dwordx4 a[64:67], v6, s[20:23], s44 offen offset:0 sc1
  buffer_load_dwordx4 a[68:71], v6, s[20:23], s44 offen offset:1024 sc1
  buffer_load_dwordx4 a[72:75], v6, s[20:23], s44 offen offset:2048 sc1
  buffer_load_dwordx4 a[76:79], v6, s[20:23], s44 offen offset:3072 sc1
  s_add_u32 s44, s44, 4096
  buffer_load_dwordx4 a[80:83], v6, s[20:23], s44 offen offset:0 sc1
  buffer_load_dwordx4 a[84:87], v6, s[20:23], s44 offen offset:1024 sc1
  buffer_load_dwordx4 a[88:91], v6, s[20:23], s44 offen offset:2048 sc1
  buffer_load_dwordx4 a[92:95], v6, s[20:23], s44 offen offset:3072 sc1
  s_add_u32 s44, s44, 4096
  buffer_load_dwordx4 a[96:99], v6, s[20:23], s44 offen offset:0 sc1
  buffer_load_dwordx4 a[100:103], v6, s[20:23], s44 offen offset:1024 sc1
  buffer_load_dwordx4 a[104:107], v6, s[20:23], s44 offen offset:2048 sc1
  buffer_load_dwordx4 a[108:111], v6, s[20:23], s44 offen offset:3072 sc1
  s_add_u32 s44, s44, 4096
  s_waitcnt vmcnt(16) lgkmcnt(0)
  s_barrier
  s_cmp_eq_u32 s16, 0
  s_cbranch_scc0 SIG_86
  v_mov_b32 v1, s54
  v_mov_b32 v2, 0
  buffer_store_dword v1, v2, s[56:59], s13 offen sc1
SIG_86:
SKIP_G1_67:
  s_load_dwordx2 s[4:5], s[0:1], 96
  s_load_dwordx2 s[6:7], s[0:1], 80
  v_lshrrev_b32 v1, 6, v0
  v_and_b32 v2, 63, v0
  s_and_b32 s17, s2, 7
  v_readfirstlane_b32 s16, v1
  s_lshl_b32 s17, s17, 2
  s_bfe_u32 s12, s2, 0x20003
  s_add_u32 s17, s17, s12
  s_lshr_b32 s18, s2, 5
  v_lshlrev_b32 v3, 4, v2
  s_waitcnt lgkmcnt(0)
  s_add_u32 s20, s4, 0x600000
  s_addc_u32 s21, s5, 0
  s_mov_b32 s22, 0x1c0000
  s_mov_b32 s23, 0x20000
  s_add_u32 s24, s4, 0x1800000
  s_addc_u32 s25, s5, 0
  s_mov_b32 s26, 0x700000
  s_mov_b32 s27, 0x20000
  s_add_u32 s28, s4, 0x1400000
  s_addc_u32 s29, s5, 0
  s_mov_b32 s30, 0x200000
  s_mov_b32 s31, 0x20000
  s_mov_b32 s32, s6
  s_mov_b32 s33, s7
  s_mov_b32 s34, 0x200000
  s_mov_b32 s35, 0x20000
  s_mul_i32 s12, s18, 56
  s_mul_i32 s13, s16, 14
  s_add_u32 s12, s12, s13
  s_lshl_b32 s12, s12, 12
  s_mul_i32 s14, s17, 229376
  s_lshl_b32 s13, s13, 10
  s_add_u32 s14, s14, s13
  s_add_u32 s15, s14, 57344
  s_add_u32 s40, s15, 57344
  s_add_u32 s41, s40, 57344
  v_and_b32 v4, 15, v2
  v_lshrrev_b32 v5, 4, v2
  v_lshlrev_b32 v6, 4, v4
  v_lshl_add_u32 v6, v5, 9, v6
  s_lshl_b32 s42, s17, 2
  s_add_u32 s42, s42, s16
  s_lshl_b32 s42, s42, 14
  s_lshl_b32 s43, s18, 11
  s_add_u32 s43, s43, s42
  s_cmp_ge_u32 s2, 224
  s_cbranch_scc0 G2_PRE_87
  buffer_load_dwordx4 v[144:147], v3, s[20:23], s12 offen offset:0 sc1
  buffer_load_dwordx4 v[148:151], v3, s[20:23], s12 offen offset:1024 sc1
  buffer_load_dwordx4 v[152:155], v3, s[20:23], s12 offen offset:2048 sc1
  buffer_load_dwordx4 v[156:159], v3, s[20:23], s12 offen offset:3072 sc1
  s_add_u32 s12, s12, 4096
  buffer_load_dwordx4 v[160:163], v3, s[20:23], s12 offen offset:0 sc1
  buffer_load_dwordx4 v[164:167], v3, s[20:23], s12 offen offset:1024 sc1
  buffer_load_dwordx4 v[168:171], v3, s[20:23], s12 offen offset:2048 sc1
  buffer_load_dwordx4 v[172:175], v3, s[20:23], s12 offen offset:3072 sc1
  s_add_u32 s12, s12, 4096
  buffer_load_dwordx4 v[176:179], v3, s[20:23], s12 offen offset:0 sc1
  buffer_load_dwordx4 v[180:183], v3, s[20:23], s12 offen offset:1024 sc1
  buffer_load_dwordx4 v[184:187], v3, s[20:23], s12 offen offset:2048 sc1
  buffer_load_dwordx4 v[188:191], v3, s[20:23], s12 offen offset:3072 sc1
  s_add_u32 s12, s12, 4096
  buffer_load_dwordx4 v[192:195], v3, s[20:23], s12 offen offset:0 sc1
  buffer_load_dwordx4 v[196:199], v3, s[20:23], s12 offen offset:1024 sc1
  buffer_load_dwordx4 v[200:203], v3, s[20:23], s12 offen offset:2048 sc1
  buffer_load_dwordx4 v[204:207], v3, s[20:23], s12 offen offset:3072 sc1
  s_add_u32 s12, s12, 4096
  buffer_load_dwordx4 v[208:211], v3, s[20:23], s12 offen offset:0 sc1
  buffer_load_dwordx4 v[212:215], v3, s[20:23], s12 offen offset:1024 sc1
  buffer_load_dwordx4 v[216:219], v3, s[20:23], s12 offen offset:2048 sc1
  buffer_load_dwordx4 v[220:223], v3, s[20:23], s12 offen offset:3072 sc1
  s_add_u32 s12, s12, 4096
  buffer_load_dwordx4 v[224:227], v3, s[20:23], s12 offen offset:0 sc1
  buffer_load_dwordx4 v[228:231], v3, s[20:23], s12 offen offset:1024 sc1
  buffer_load_dwordx4 v[232:235], v3, s[20:23], s12 offen offset:2048 sc1
  buffer_load_dwordx4 v[236:239], v3, s[20:23], s12 offen offset:3072 sc1
  s_add_u32 s12, s12, 4096
  buffer_load_dwordx4 v[240:243], v3, s[20:23], s12 offen offset:0 sc1
  buffer_load_dwordx4 v[244:247], v3, s[20:23], s12 offen offset:1024 sc1
  buffer_load_dwordx4 v[248:251], v3, s[20:23], s12 offen offset:2048 sc1
  buffer_load_dwordx4 v[252:255], v3, s[20:23], s12 offen offset:3072 sc1
  s_add_u32 s12, s12, 4096
  buffer_load_dwordx4 a[0:3], v3, s[20:23], s12 offen offset:0 sc1
  buffer_load_dwordx4 a[4:7], v3, s[20:23], s12 offen offset:1024 sc1
  buffer_load_dwordx4 a[8:11], v3, s[20:23], s12 offen offset:2048 sc1
  buffer_load_dwordx4 a[12:15], v3, s[20:23], s12 offen offset:3072 sc1
  s_add_u32 s12, s12, 4096
  buffer_load_dwordx4 a[16:19], v3, s[20:23], s12 offen offset:0 sc1
  buffer_load_dwordx4 a[20:23], v3, s[20:23], s12 offen offset:1024 sc1
  buffer_load_dwordx4 a[24:27], v3, s[20:23], s12 offen offset:2048 sc1
  buffer_load_dwordx4 a[28:31], v3, s[20:23], s12 offen offset:3072 sc1
  s_add_u32 s12, s12, 4096
  buffer_load_dwordx4 a[32:35], v3, s[20:23], s12 offen offset:0 sc1
  buffer_load_dwordx4 a[36:39], v3, s[20:23], s12 offen offset:1024 sc1
  buffer_load_dwordx4 a[40:43], v3, s[20:23], s12 offen offset:2048 sc1
  buffer_load_dwordx4 a[44:47], v3, s[20:23], s12 offen offset:3072 sc1
  s_add_u32 s12, s12, 4096
  buffer_load_dwordx4 a[48:51], v3, s[20:23], s12 offen offset:0 sc1
  buffer_load_dwordx4 a[52:55], v3, s[20:23], s12 offen offset:1024 sc1
  buffer_load_dwordx4 a[56:59], v3, s[20:23], s12 offen offset:2048 sc1
  buffer_load_dwordx4 a[60:63], v3, s[20:23], s12 offen offset:3072 sc1
  s_add_u32 s12, s12, 4096
  buffer_load_dwordx4 a[64:67], v3, s[20:23], s12 offen offset:0 sc1
  buffer_load_dwordx4 a[68:71], v3, s[20:23], s12 offen offset:1024 sc1
  buffer_load_dwordx4 a[72:75], v3, s[20:23], s12 offen offset:2048 sc1
  buffer_load_dwordx4 a[76:79], v3, s[20:23], s12 offen offset:3072 sc1
  s_add_u32 s12, s12, 4096
  buffer_load_dwordx4 a[80:83], v3, s[20:23], s12 offen offset:0 sc1
  buffer_load_dwordx4 a[84:87], v3, s[20:23], s12 offen offset:1024 sc1
  buffer_load_dwordx4 a[88:91], v3, s[20:23], s12 offen offset:2048 sc1
  buffer_load_dwordx4 a[92:95], v3, s[20:23], s12 offen offset:3072 sc1
  s_add_u32 s12, s12, 4096
  buffer_load_dwordx4 a[96:99], v3, s[20:23], s12 offen offset:0 sc1
  buffer_load_dwordx4 a[100:103], v3, s[20:23], s12 offen offset:1024 sc1
  buffer_load_dwordx4 a[104:107], v3, s[20:23], s12 offen offset:2048 sc1
  buffer_load_dwordx4 a[108:111], v3, s[20:23], s12 offen offset:3072 sc1
  s_add_u32 s12, s12, 4096
G2_PRE_87:
  v_mov_b32 v16, 0
  v_mov_b32 v17, 0
  v_mov_b32 v18, 0
  v_mov_b32 v19, 0
  v_mov_b32 v20, 0
  v_mov_b32 v21, 0
  v_mov_b32 v22, 0
  v_mov_b32 v23, 0
  v_mov_b32 v24, 0
  v_mov_b32 v25, 0
  v_mov_b32 v26, 0
  v_mov_b32 v27, 0
  v_mov_b32 v28, 0
  v_mov_b32 v29, 0
  v_mov_b32 v30, 0
  v_mov_b32 v31, 0
  v_mov_b32 v32, 0
  v_mov_b32 v33, 0
  v_mov_b32 v34, 0
  v_mov_b32 v35, 0
  v_mov_b32 v36, 0
  v_mov_b32 v37, 0
  v_mov_b32 v38, 0
  v_mov_b32 v39, 0
  v_mov_b32 v40, 0
  v_mov_b32 v41, 0
  v_mov_b32 v42, 0
  v_mov_b32 v43, 0
  v_mov_b32 v44, 0
  v_mov_b32 v45, 0
  v_mov_b32 v46, 0
  v_mov_b32 v47, 0
  v_mov_b32 v48, 0
  v_mov_b32 v49, 0
  v_mov_b32 v50, 0
  v_mov_b32 v51, 0
  v_mov_b32 v52, 0
  v_mov_b32 v53, 0
  v_mov_b32 v54, 0
  v_mov_b32 v55, 0
  v_mov_b32 v56, 0
  v_mov_b32 v57, 0
  v_mov_b32 v58, 0
  v_mov_b32 v59, 0
  v_mov_b32 v60, 0
  v_mov_b32 v61, 0
  v_mov_b32 v62, 0
  v_mov_b32 v63, 0
  v_mov_b32 v64, 0
  v_mov_b32 v65, 0
  v_mov_b32 v66, 0
  v_mov_b32 v67, 0
  v_mov_b32 v68, 0
  v_mov_b32 v69, 0
  v_mov_b32 v70, 0
  v_mov_b32 v71, 0
  v_mov_b32 v72, 0
  v_mov_b32 v73, 0
  v_mov_b32 v74, 0
  v_mov_b32 v75, 0
  v_mov_b32 v76, 0
  v_mov_b32 v77, 0
  v_mov_b32 v78, 0
  v_mov_b32 v79, 0
  v_and_b32 v7, 7, v2
  v_min_u32 v7, 6, v7
  v_lshlrev_b32 v7, 2, v7
  s_lshl_b32 s13, s17, 7
  s_add_u32 s13, s13, 12288
  s_cmp_ge_u32 s2, 224
  s_cbranch_scc0 G2_A_88
  s_add_u32 s44, s13, 32
  s_cmp_eq_u32 s16, 0
  s_cbranch_scc0 WFS_91
  s_mov_b32 s55, 0x4000
  buffer_load_dword v80, v7, s[56:59], s44 offen sc1
WF_89:
  s_waitcnt vmcnt(0)
  v_cmp_ne_u32 vcc, s54, v80
  s_nop 1
  s_cmp_eq_u64 vcc, 0
  s_cbranch_scc1 WFD_90
  buffer_load_dword v80, v7, s[56:59], s44 offen sc1
  s_sub_u32 s55, s55, 1
  s_cmp_eq_u32 s55, 0
  s_cbranch_scc0 WF_89
WFD_90:
WFS_91:
  s_barrier
G2_A_88:
  buffer_load_dwordx4 v[8:11], v6, s[28:31], s43 offen sc1
  buffer_load_dwordx4 v[12:15], v6, s[28:31], s43 offen offset:256 sc1
  buffer_load_dwordx4 a[112:115], v3, s[24:27], s14 offen sc1
  s_add_u32 s14, s14, 1024
  buffer_load_dwordx4 a[116:119], v3, s[24:27], s15 offen sc1
  s_add_u32 s15, s15, 1024
  buffer_load_dwordx4 a[120:123], v3, s[24:27], s14 offen sc1
  s_add_u32 s14, s14, 1024
  buffer_load_dwordx4 a[124:127], v3, s[24:27], s15 offen sc1
  s_add_u32 s15, s15, 1024
  buffer_load_dwordx4 a[128:131], v3, s[24:27], s14 offen sc1
  s_add_u32 s14, s14, 1024
  buffer_load_dwordx4 a[132:135], v3, s[24:27], s15 offen sc1
  s_add_u32 s15, s15, 1024
  buffer_load_dwordx4 a[136:139], v3, s[24:27], s14 offen sc1
  s_add_u32 s14, s14, 1024
  buffer_load_dwordx4 a[140:143], v3, s[24:27], s15 offen sc1
  s_add_u32 s15, s15, 1024
  buffer_load_dwordx4 a[144:147], v3, s[24:27], s14 offen sc1
  s_add_u32 s14, s14, 1024
  buffer_load_dwordx4 a[148:151], v3, s[24:27], s15 offen sc1
  s_add_u32 s15, s15, 1024
  buffer_load_dwordx4 a[152:155], v3, s[24:27], s14 offen sc1
  s_add_u32 s14, s14, 1024
  buffer_load_dwordx4 a[156:159], v3, s[24:27], s15 offen sc1
  s_add_u32 s15, s15, 1024
  buffer_load_dwordx4 a[160:163], v3, s[24:27], s14 offen sc1
  s_add_u32 s14, s14, 1024
  buffer_load_dwordx4 a[164:167], v3, s[24:27], s15 offen sc1
  s_add_u32 s15, s15, 1024
  buffer_load_dwordx4 a[168:171], v3, s[24:27], s14 offen sc1
  s_add_u32 s14, s14, 1024
  buffer_load_dwordx4 a[172:175], v3, s[24:27], s15 offen sc1
  s_add_u32 s15, s15, 1024
  s_waitcnt vmcnt(14)
  v_mfma_f32_16x16x32_bf16 v[16:19], v[144:147], a[112:115], v[16:19]
  v_mfma_f32_16x16x32_bf16 v[20:23], v[148:151], a[112:115], v[20:23]
  v_mfma_f32_16x16x32_bf16 v[24:27], v[152:155], a[112:115], v[24:27]
  v_mfma_f32_16x16x32_bf16 v[28:31], v[156:159], a[112:115], v[28:31]
  buffer_load_dwordx4 a[176:179], v3, s[24:27], s14 offen sc1
  s_add_u32 s14, s14, 1024
  v_mfma_f32_16x16x32_bf16 v[32:35], v[144:147], a[116:119], v[32:35]
  v_mfma_f32_16x16x32_bf16 v[36:39], v[148:151], a[116:119], v[36:39]
  v_mfma_f32_16x16x32_bf16 v[40:43], v[152:155], a[116:119], v[40:43]
  v_mfma_f32_16x16x32_bf16 v[44:47], v[156:159], a[116:119], v[44:47]
  buffer_load_dwordx4 a[180:183], v3, s[24:27], s15 offen sc1
  s_add_u32 s15, s15, 1024
  s_waitcnt vmcnt(14)
  v_mfma_f32_16x16x32_bf16 v[16:19], v[160:163], a[120:123], v[16:19]
  v_mfma_f32_16x16x32_bf16 v[20:23], v[164:167], a[120:123], v[20:23]
  v_mfma_f32_16x16x32_bf16 v[24:27], v[168:171], a[120:123], v[24:27]
  v_mfma_f32_16x16x32_bf16 v[28:31], v[172:175], a[120:123], v[28:31]
  buffer_load_dwordx4 a[184:187], v3, s[24:27], s14 offen sc1
  s_add_u32 s14, s14, 1024
  v_mfma_f32_16x16x32_bf16 v[32:35], v[160:163], a[124:127], v[32:35]
  v_mfma_f32_16x16x32_bf16 v[36:39], v[164:167], a[124:127], v[36:39]
  v_mfma_f32_16x16x32_bf16 v[40:43], v[168:171], a[124:127], v[40:43]
  v_mfma_f32_16x16x32_bf16 v[44:47], v[172:175], a[124:127], v[44:47]
  buffer_load_dwordx4 a[188:191], v3, s[24:27], s15 offen sc1
  s_add_u32 s15, s15, 1024
  s_waitcnt vmcnt(14)
  v_mfma_f32_16x16x32_bf16 v[16:19], v[176:179], a[128:131], v[16:19]
  v_mfma_f32_16x16x32_bf16 v[20:23], v[180:183], a[128:131], v[20:23]
  v_mfma_f32_16x16x32_bf16 v[24:27], v[184:187], a[128:131], v[24:27]
  v_mfma_f32_16x16x32_bf16 v[28:31], v[188:191], a[128:131], v[28:31]
  buffer_load_dwordx4 a[192:195], v3, s[24:27], s14 offen sc1
  s_add_u32 s14, s14, 1024
  v_mfma_f32_16x16x32_bf16 v[32:35], v[176:179], a[132:135], v[32:35]
  v_mfma_f32_16x16x32_bf16 v[36:39], v[180:183], a[132:135], v[36:39]
  v_mfma_f32_16x16x32_bf16 v[40:43], v[184:187], a[132:135], v[40:43]
  v_mfma_f32_16x16x32_bf16 v[44:47], v[188:191], a[132:135], v[44:47]
  buffer_load_dwordx4 a[196:199], v3, s[24:27], s15 offen sc1
  s_add_u32 s15, s15, 1024
  s_waitcnt vmcnt(14)
  v_mfma_f32_16x16x32_bf16 v[16:19], v[192:195], a[136:139], v[16:19]
  v_mfma_f32_16x16x32_bf16 v[20:23], v[196:199], a[136:139], v[20:23]
  v_mfma_f32_16x16x32_bf16 v[24:27], v[200:203], a[136:139], v[24:27]
  v_mfma_f32_16x16x32_bf16 v[28:31], v[204:207], a[136:139], v[28:31]
  buffer_load_dwordx4 a[200:203], v3, s[24:27], s14 offen sc1
  s_add_u32 s14, s14, 1024
  v_mfma_f32_16x16x32_bf16 v[32:35], v[192:195], a[140:143], v[32:35]
  v_mfma_f32_16x16x32_bf16 v[36:39], v[196:199], a[140:143], v[36:39]
  v_mfma_f32_16x16x32_bf16 v[40:43], v[200:203], a[140:143], v[40:43]
  v_mfma_f32_16x16x32_bf16 v[44:47], v[204:207], a[140:143], v[44:47]
  buffer_load_dwordx4 a[204:207], v3, s[24:27], s15 offen sc1
  s_add_u32 s15, s15, 1024
  s_waitcnt vmcnt(14)
  v_mfma_f32_16x16x32_bf16 v[16:19], v[208:211], a[144:147], v[16:19]
  v_mfma_f32_16x16x32_bf16 v[20:23], v[212:215], a[144:147], v[20:23]
  v_mfma_f32_16x16x32_bf16 v[24:27], v[216:219], a[144:147], v[24:27]
  v_mfma_f32_16x16x32_bf16 v[28:31], v[220:223], a[144:147], v[28:31]
  buffer_load_dwordx4 a[208:211], v3, s[24:27], s14 offen sc1
  s_add_u32 s14, s14, 1024
  v_mfma_f32_16x16x32_bf16 v[32:35], v[208:211], a[148:151], v[32:35]
  v_mfma_f32_16x16x32_bf16 v[36:39], v[212:215], a[148:151], v[36:39]
  v_mfma_f32_16x16x32_bf16 v[40:43], v[216:219], a[148:151], v[40:43]
  v_mfma_f32_16x16x32_bf16 v[44:47], v[220:223], a[148:151], v[44:47]
  buffer_load_dwordx4 a[212:215], v3, s[24:27], s15 offen sc1
  s_add_u32 s15, s15, 1024
  s_waitcnt vmcnt(14)
  v_mfma_f32_16x16x32_bf16 v[16:19], v[224:227], a[152:155], v[16:19]
  v_mfma_f32_16x16x32_bf16 v[20:23], v[228:231], a[152:155], v[20:23]
  v_mfma_f32_16x16x32_bf16 v[24:27], v[232:235], a[152:155], v[24:27]
  v_mfma_f32_16x16x32_bf16 v[28:31], v[236:239], a[152:155], v[28:31]
  buffer_load_dwordx4 a[216:219], v3, s[24:27], s14 offen sc1
  s_add_u32 s14, s14, 1024
  v_mfma_f32_16x16x32_bf16 v[32:35], v[224:227], a[156:159], v[32:35]
  v_mfma_f32_16x16x32_bf16 v[36:39], v[228:231], a[156:159], v[36:39]
  v_mfma_f32_16x16x32_bf16 v[40:43], v[232:235], a[156:159], v[40:43]
  v_mfma_f32_16x16x32_bf16 v[44:47], v[236:239], a[156:159], v[44:47]
  buffer_load_dwordx4 a[220:223], v3, s[24:27], s15 offen sc1
  s_add_u32 s15, s15, 1024
  s_waitcnt vmcnt(14)
  v_mfma_f32_16x16x32_bf16 v[16:19], v[240:243], a[160:163], v[16:19]
  v_mfma_f32_16x16x32_bf16 v[20:23], v[244:247], a[160:163], v[20:23]
  v_mfma_f32_16x16x32_bf16 v[24:27], v[248:251], a[160:163], v[24:27]
  v_mfma_f32_16x16x32_bf16 v[28:31], v[252:255], a[160:163], v[28:31]
  v_mfma_f32_16x16x32_bf16 v[32:35], v[240:243], a[164:167], v[32:35]
  v_mfma_f32_16x16x32_bf16 v[36:39], v[244:247], a[164:167], v[36:39]
  v_mfma_f32_16x16x32_bf16 v[40:43], v[248:251], a[164:167], v[40:43]
  v_mfma_f32_16x16x32_bf16 v[44:47], v[252:255], a[164:167], v[44:47]
  s_cmp_eq_u32 s16, 0
  s_cbranch_scc0 G2_BI_92
  buffer_load_dword v80, v7, s[56:59], s13 offen sc1
G2_BI_92:
  s_waitcnt vmcnt(12)
  v_mfma_f32_16x16x32_bf16 v[16:19], a[0:3], a[168:171], v[16:19]
  v_mfma_f32_16x16x32_bf16 v[20:23], a[4:7], a[168:171], v[20:23]
  v_mfma_f32_16x16x32_bf16 v[24:27], a[8:11], a[168:171], v[24:27]
  v_mfma_f32_16x16x32_bf16 v[28:31], a[12:15], a[168:171], v[28:31]
  v_mfma_f32_16x16x32_bf16 v[32:35], a[0:3], a[172:175], v[32:35]
  v_mfma_f32_16x16x32_bf16 v[36:39], a[4:7], a[172:175], v[36:39]
  v_mfma_f32_16x16x32_bf16 v[40:43], a[8:11], a[172:175], v[40:43]
  v_mfma_f32_16x16x32_bf16 v[44:47], a[12:15], a[172:175], v[44:47]
  s_waitcnt vmcnt(10)
  v_mfma_f32_16x16x32_bf16 v[16:19], a[16:19], a[176:179], v[16:19]
  v_mfma_f32_16x16x32_bf16 v[20:23], a[20:23], a[176:179], v[20:23]
  v_mfma_f32_16x16x32_bf16 v[24:27], a[24:27], a[176:179], v[24:27]
  v_mfma_f32_16x16x32_bf16 v[28:31], a[28:31], a[176:179], v[28:31]
  v_mfma_f32_16x16x32_bf16 v[32:35], a[16:19], a[180:183], v[32:35]
  v_mfma_f32_16x16x32_bf16 v[36:39], a[20:23], a[180:183], v[36:39]
  v_mfma_f32_16x16x32_bf16 v[40:43], a[24:27], a[180:183], v[40:43]
  v_mfma_f32_16x16x32_bf16 v[44:47], a[28:31], a[180:183], v[44:47]
  s_waitcnt vmcnt(8)
  v_mfma_f32_16x16x32_bf16 v[16:19], a[32:35], a[184:187], v[16:19]
  v_mfma_f32_16x16x32_bf16 v[20:23], a[36:39], a[184:187], v[20:23]
  v_mfma_f32_16x16x32_bf16 v[24:27], a[40:43], a[184:187], v[24:27]
  v_mfma_f32_16x16x32_bf16 v[28:31], a[44:47], a[184:187], v[28:31]
  v_mfma_f32_16x16x32_bf16 v[32:35], a[32:35], a[188:191], v[32:35]
  v_mfma_f32_16x16x32_bf16 v[36:39], a[36:39], a[188:191], v[36:39]
  v_mfma_f32_16x16x32_bf16 v[40:43], a[40:43], a[188:191], v[40:43]
  v_mfma_f32_16x16x32_bf16 v[44:47], a[44:47], a[188:191], v[44:47]
  s_waitcnt vmcnt(0)
  s_cmp_eq_u32 s16, 0
  s_cbranch_scc0 G2_B_93
  v_cmp_ne_u32 vcc, s54, v80
  s_nop 1
  s_cmp_eq_u64 vcc, 0
  s_cbranch_scc1 G2_B_93
  s_cmp_eq_u32 s16, 0
  s_cbranch_scc0 WFS_96
  s_mov_b32 s55, 0x4000
  buffer_load_dword v80, v7, s[56:59], s13 offen sc1
WF_94:
  s_waitcnt vmcnt(0)
  v_cmp_ne_u32 vcc, s54, v80
  s_nop 1
  s_cmp_eq_u64 vcc, 0
  s_cbranch_scc1 WFD_95
  buffer_load_dword v80, v7, s[56:59], s13 offen sc1
  s_sub_u32 s55, s55, 1
  s_cmp_eq_u32 s55, 0
  s_cbranch_scc0 WF_94
WFD_95:
WFS_96:
G2_B_93:
  s_barrier
  buffer_load_dwordx4 a[224:227], v3, s[24:27], s40 offen sc1
  s_add_u32 s40, s40, 1024
  buffer_load_dwordx4 a[228:231], v3, s[24:27], s41 offen sc1
  s_add_u32 s41, s41, 1024
  buffer_load_dwordx4 a[232:235], v3, s[24:27], s40 offen sc1
  s_add_u32 s40, s40, 1024
  buffer_load_dwordx4 a[236:239], v3, s[24:27], s41 offen sc1
  s_add_u32 s41, s41, 1024
  buffer_load_dwordx4 a[240:243], v3, s[24:27], s40 offen sc1
  s_add_u32 s40, s40, 1024
  buffer_load_dwordx4 a[244:247], v3, s[24:27], s41 offen sc1
  s_add_u32 s41, s41, 1024
  buffer_load_dwordx4 a[248:251], v3, s[24:27], s40 offen sc1
  s_add_u32 s40, s40, 1024
  buffer_load_dwordx4 a[252:255], v3, s[24:27], s41 offen sc1
  s_add_u32 s41, s41, 1024
  v_mfma_f32_16x16x32_bf16 v[16:19], a[48:51], a[192:195], v[16:19]
  v_mfma_f32_16x16x32_bf16 v[20:23], a[52:55], a[192:195], v[20:23]
  v_mfma_f32_16x16x32_bf16 v[24:27], a[56:59], a[192:195], v[24:27]
  v_mfma_f32_16x16x32_bf16 v[28:31], a[60:63], a[192:195], v[28:31]
  buffer_load_dwordx4 a[112:115], v3, s[24:27], s40 offen sc1
  s_add_u32 s40, s40, 1024
  v_mfma_f32_16x16x32_bf16 v[32:35], a[48:51], a[196:199], v[32:35]
  v_mfma_f32_16x16x32_bf16 v[36:39], a[52:55], a[196:199], v[36:39]
  v_mfma_f32_16x16x32_bf16 v[40:43], a[56:59], a[196:199], v[40:43]
  v_mfma_f32_16x16x32_bf16 v[44:47], a[60:63], a[196:199], v[44:47]
  buffer_load_dwordx4 a[116:119], v3, s[24:27], s41 offen sc1
  s_add_u32 s41, s41, 1024
  v_mfma_f32_16x16x32_bf16 v[16:19], a[64:67], a[200:203], v[16:19]
  v_mfma_f32_16x16x32_bf16 v[20:23], a[68:71], a[200:203], v[20:23]
  v_mfma_f32_16x16x32_bf16 v[24:27], a[72:75], a[200:203], v[24:27]
  v_mfma_f32_16x16x32_bf16 v[28:31], a[76:79], a[200:203], v[28:31]
  buffer_load_dwordx4 a[120:123], v3, s[24:27], s40 offen sc1
  s_add_u32 s40, s40, 1024
  v_mfma_f32_16x16x32_bf16 v[32:35], a[64:67], a[204:207], v[32:35]
  v_mfma_f32_16x16x32_bf16 v[36:39], a[68:71], a[204:207], v[36:39]
  v_mfma_f32_16x16x32_bf16 v[40:43], a[72:75], a[204:207], v[40:43]
  v_mfma_f32_16x16x32_bf16 v[44:47], a[76:79], a[204:207], v[44:47]
  buffer_load_dwordx4 a[124:127], v3, s[24:27], s41 offen sc1
  s_add_u32 s41, s41, 1024
  v_mfma_f32_16x16x32_bf16 v[16:19], a[80:83], a[208:211], v[16:19]
  v_mfma_f32_16x16x32_bf16 v[20:23], a[84:87], a[208:211], v[20:23]
  v_mfma_f32_16x16x32_bf16 v[24:27], a[88:91], a[208:211], v[24:27]
  v_mfma_f32_16x16x32_bf16 v[28:31], a[92:95], a[208:211], v[28:31]
  buffer_load_dwordx4 a[128:131], v3, s[24:27], s40 offen sc1
  s_add_u32 s40, s40, 1024
  v_mfma_f32_16x16x32_bf16 v[32:35], a[80:83], a[212:215], v[32:35]
  v_mfma_f32_16x16x32_bf16 v[36:39], a[84:87], a[212:215], v[36:39]
  v_mfma_f32_16x16x32_bf16 v[40:43], a[88:91], a[212:215], v[40:43]
  v_mfma_f32_16x16x32_bf16 v[44:47], a[92:95], a[212:215], v[44:47]
  buffer_load_dwordx4 a[132:135], v3, s[24:27], s41 offen sc1
  s_add_u32 s41, s41, 1024
  v_mfma_f32_16x16x32_bf16 v[16:19], a[96:99], a[216:219], v[16:19]
  v_mfma_f32_16x16x32_bf16 v[20:23], a[100:103], a[216:219], v[20:23]
  v_mfma_f32_16x16x32_bf16 v[24:27], a[104:107], a[216:219], v[24:27]
  v_mfma_f32_16x16x32_bf16 v[28:31], a[108:111], a[216:219], v[28:31]
  buffer_load_dwordx4 a[136:139], v3, s[24:27], s40 offen sc1
  s_add_u32 s40, s40, 1024
  v_mfma_f32_16x16x32_bf16 v[32:35], a[96:99], a[220:223], v[32:35]
  v_mfma_f32_16x16x32_bf16 v[36:39], a[100:103], a[220:223], v[36:39]
  v_mfma_f32_16x16x32_bf16 v[40:43], a[104:107], a[220:223], v[40:43]
  v_mfma_f32_16x16x32_bf16 v[44:47], a[108:111], a[220:223], v[44:47]
  buffer_load_dwordx4 a[140:143], v3, s[24:27], s41 offen sc1
  s_add_u32 s41, s41, 1024
  s_waitcnt vmcnt(14)
  v_mfma_f32_16x16x32_bf16 v[48:51], v[144:147], a[224:227], v[48:51]
  v_mfma_f32_16x16x32_bf16 v[52:55], v[148:151], a[224:227], v[52:55]
  v_mfma_f32_16x16x32_bf16 v[56:59], v[152:155], a[224:227], v[56:59]
  v_mfma_f32_16x16x32_bf16 v[60:63], v[156:159], a[224:227], v[60:63]
  buffer_load_dwordx4 a[144:147], v3, s[24:27], s40 offen sc1
  s_add_u32 s40, s40, 1024
  v_mfma_f32_16x16x32_bf16 v[64:67], v[144:147], a[228:231], v[64:67]
  v_mfma_f32_16x16x32_bf16 v[68:71], v[148:151], a[228:231], v[68:71]
  v_mfma_f32_16x16x32_bf16 v[72:75], v[152:155], a[228:231], v[72:75]
  v_mfma_f32_16x16x32_bf16 v[76:79], v[156:159], a[228:231], v[76:79]
  buffer_load_dwordx4 a[148:151], v3, s[24:27], s41 offen sc1
  s_add_u32 s41, s41, 1024
  s_waitcnt vmcnt(14)
  v_mfma_f32_16x16x32_bf16 v[48:51], v[160:163], a[232:235], v[48:51]
  v_mfma_f32_16x16x32_bf16 v[52:55], v[164:167], a[232:235], v[52:55]
  v_mfma_f32_16x16x32_bf16 v[56:59], v[168:171], a[232:235], v[56:59]
  v_mfma_f32_16x16x32_bf16 v[60:63], v[172:175], a[232:235], v[60:63]
  buffer_load_dwordx4 a[152:155], v3, s[24:27], s40 offen sc1
  s_add_u32 s40, s40, 1024
  v_mfma_f32_16x16x32_bf16 v[64:67], v[160:163], a[236:239], v[64:67]
  v_mfma_f32_16x16x32_bf16 v[68:71], v[164:167], a[236:239], v[68:71]
  v_mfma_f32_16x16x32_bf16 v[72:75], v[168:171], a[236:239], v[72:75]
  v_mfma_f32_16x16x32_bf16 v[76:79], v[172:175], a[236:239], v[76:79]
  buffer_load_dwordx4 a[156:159], v3, s[24:27], s41 offen sc1
  s_add_u32 s41, s41, 1024
  s_waitcnt vmcnt(14)
  v_mfma_f32_16x16x32_bf16 v[48:51], v[176:179], a[240:243], v[48:51]
  v_mfma_f32_16x16x32_bf16 v[52:55], v[180:183], a[240:243], v[52:55]
  v_mfma_f32_16x16x32_bf16 v[56:59], v[184:187], a[240:243], v[56:59]
  v_mfma_f32_16x16x32_bf16 v[60:63], v[188:191], a[240:243], v[60:63]
  buffer_load_dwordx4 a[160:163], v3, s[24:27], s40 offen sc1
  s_add_u32 s40, s40, 1024
  v_mfma_f32_16x16x32_bf16 v[64:67], v[176:179], a[244:247], v[64:67]
  v_mfma_f32_16x16x32_bf16 v[68:71], v[180:183], a[244:247], v[68:71]
  v_mfma_f32_16x16x32_bf16 v[72:75], v[184:187], a[244:247], v[72:75]
  v_mfma_f32_16x16x32_bf16 v[76:79], v[188:191], a[244:247], v[76:79]
  buffer_load_dwordx4 a[164:167], v3, s[24:27], s41 offen sc1
  s_add_u32 s41, s41, 1024
  s_waitcnt vmcnt(14)
  v_mfma_f32_16x16x32_bf16 v[48:51], v[192:195], a[248:251], v[48:51]
  v_mfma_f32_16x16x32_bf16 v[52:55], v[196:199], a[248:251], v[52:55]
  v_mfma_f32_16x16x32_bf16 v[56:59], v[200:203], a[248:251], v[56:59]
  v_mfma_f32_16x16x32_bf16 v[60:63], v[204:207], a[248:251], v[60:63]
  buffer_load_dwordx4 a[168:171], v3, s[24:27], s40 offen sc1
  s_add_u32 s40, s40, 1024
  v_mfma_f32_16x16x32_bf16 v[64:67], v[192:195], a[252:255], v[64:67]
  v_mfma_f32_16x16x32_bf16 v[68:71], v[196:199], a[252:255], v[68:71]
  v_mfma_f32_16x16x32_bf16 v[72:75], v[200:203], a[252:255], v[72:75]
  v_mfma_f32_16x16x32_bf16 v[76:79], v[204:207], a[252:255], v[76:79]
  buffer_load_dwordx4 a[172:175], v3, s[24:27], s41 offen sc1
  s_add_u32 s41, s41, 1024
  s_waitcnt vmcnt(14)
  v_mfma_f32_16x16x32_bf16 v[48:51], v[208:211], a[112:115], v[48:51]
  v_mfma_f32_16x16x32_bf16 v[52:55], v[212:215], a[112:115], v[52:55]
  v_mfma_f32_16x16x32_bf16 v[56:59], v[216:219], a[112:115], v[56:59]
  v_mfma_f32_16x16x32_bf16 v[60:63], v[220:223], a[112:115], v[60:63]
  buffer_load_dwordx4 a[176:179], v3, s[24:27], s40 offen sc1
  s_add_u32 s40, s40, 1024
  v_mfma_f32_16x16x32_bf16 v[64:67], v[208:211], a[116:119], v[64:67]
  v_mfma_f32_16x16x32_bf16 v[68:71], v[212:215], a[116:119], v[68:71]
  v_mfma_f32_16x16x32_bf16 v[72:75], v[216:219], a[116:119], v[72:75]
  v_mfma_f32_16x16x32_bf16 v[76:79], v[220:223], a[116:119], v[76:79]
  buffer_load_dwordx4 a[180:183], v3, s[24:27], s41 offen sc1
  s_add_u32 s41, s41, 1024
  s_waitcnt vmcnt(14)
  v_mfma_f32_16x16x32_bf16 v[48:51], v[224:227], a[120:123], v[48:51]
  v_mfma_f32_16x16x32_bf16 v[52:55], v[228:231], a[120:123], v[52:55]
  v_mfma_f32_16x16x32_bf16 v[56:59], v[232:235], a[120:123], v[56:59]
  v_mfma_f32_16x16x32_bf16 v[60:63], v[236:239], a[120:123], v[60:63]
  buffer_load_dwordx4 a[184:187], v3, s[24:27], s40 offen sc1
  s_add_u32 s40, s40, 1024
  v_mfma_f32_16x16x32_bf16 v[64:67], v[224:227], a[124:127], v[64:67]
  v_mfma_f32_16x16x32_bf16 v[68:71], v[228:231], a[124:127], v[68:71]
  v_mfma_f32_16x16x32_bf16 v[72:75], v[232:235], a[124:127], v[72:75]
  v_mfma_f32_16x16x32_bf16 v[76:79], v[236:239], a[124:127], v[76:79]
  buffer_load_dwordx4 a[188:191], v3, s[24:27], s41 offen sc1
  s_add_u32 s41, s41, 1024
  s_waitcnt vmcnt(14)
  v_mfma_f32_16x16x32_bf16 v[48:51], v[240:243], a[128:131], v[48:51]
  v_mfma_f32_16x16x32_bf16 v[52:55], v[244:247], a[128:131], v[52:55]
  v_mfma_f32_16x16x32_bf16 v[56:59], v[248:251], a[128:131], v[56:59]
  v_mfma_f32_16x16x32_bf16 v[60:63], v[252:255], a[128:131], v[60:63]
  v_mfma_f32_16x16x32_bf16 v[64:67], v[240:243], a[132:135], v[64:67]
  v_mfma_f32_16x16x32_bf16 v[68:71], v[244:247], a[132:135], v[68:71]
  v_mfma_f32_16x16x32_bf16 v[72:75], v[248:251], a[132:135], v[72:75]
  v_mfma_f32_16x16x32_bf16 v[76:79], v[252:255], a[132:135], v[76:79]
  s_waitcnt vmcnt(12)
  v_mfma_f32_16x16x32_bf16 v[48:51], a[0:3], a[136:139], v[48:51]
  v_mfma_f32_16x16x32_bf16 v[52:55], a[4:7], a[136:139], v[52:55]
  v_mfma_f32_16x16x32_bf16 v[56:59], a[8:11], a[136:139], v[56:59]
  v_mfma_f32_16x16x32_bf16 v[60:63], a[12:15], a[136:139], v[60:63]
  v_mfma_f32_16x16x32_bf16 v[64:67], a[0:3], a[140:143], v[64:67]
  v_mfma_f32_16x16x32_bf16 v[68:71], a[4:7], a[140:143], v[68:71]
  v_mfma_f32_16x16x32_bf16 v[72:75], a[8:11], a[140:143], v[72:75]
  v_mfma_f32_16x16x32_bf16 v[76:79], a[12:15], a[140:143], v[76:79]
  s_waitcnt vmcnt(10)
  v_mfma_f32_16x16x32_bf16 v[48:51], a[16:19], a[144:147], v[48:51]
  v_mfma_f32_16x16x32_bf16 v[52:55], a[20:23], a[144:147], v[52:55]
  v_mfma_f32_16x16x32_bf16 v[56:59], a[24:27], a[144:147], v[56:59]
  v_mfma_f32_16x16x32_bf16 v[60:63], a[28:31], a[144:147], v[60:63]
  v_mfma_f32_16x16x32_bf16 v[64:67], a[16:19], a[148:151], v[64:67]
  v_mfma_f32_16x16x32_bf16 v[68:71], a[20:23], a[148:151], v[68:71]
  v_mfma_f32_16x16x32_bf16 v[72:75], a[24:27], a[148:151], v[72:75]
  v_mfma_f32_16x16x32_bf16 v[76:79], a[28:31], a[148:151], v[76:79]
  s_waitcnt vmcnt(8)
  v_mfma_f32_16x16x32_bf16 v[48:51], a[32:35], a[152:155], v[48:51]
  v_mfma_f32_16x16x32_bf16 v[52:55], a[36:39], a[152:155], v[52:55]
  v_mfma_f32_16x16x32_bf16 v[56:59], a[40:43], a[152:155], v[56:59]
  v_mfma_f32_16x16x32_bf16 v[60:63], a[44:47], a[152:155], v[60:63]
  v_mfma_f32_16x16x32_bf16 v[64:67], a[32:35], a[156:159], v[64:67]
  v_mfma_f32_16x16x32_bf16 v[68:71], a[36:39], a[156:159], v[68:71]
  v_mfma_f32_16x16x32_bf16 v[72:75], a[40:43], a[156:159], v[72:75]
  v_mfma_f32_16x16x32_bf16 v[76:79], a[44:47], a[156:159], v[76:79]
  s_waitcnt vmcnt(6)
  v_mfma_f32_16x16x32_bf16 v[48:51], a[48:51], a[160:163], v[48:51]
  v_mfma_f32_16x16x32_bf16 v[52:55], a[52:55], a[160:163], v[52:55]
  v_mfma_f32_16x16x32_bf16 v[56:59], a[56:59], a[160:163], v[56:59]
  v_mfma_f32_16x16x32_bf16 v[60:63], a[60:63], a[160:163], v[60:63]
  v_mfma_f32_16x16x32_bf16 v[64:67], a[48:51], a[164:167], v[64:67]
  v_mfma_f32_16x16x32_bf16 v[68:71], a[52:55], a[164:167], v[68:71]
  v_mfma_f32_16x16x32_bf16 v[72:75], a[56:59], a[164:167], v[72:75]
  v_mfma_f32_16x16x32_bf16 v[76:79], a[60:63], a[164:167], v[76:79]
  s_waitcnt vmcnt(4)
  v_mfma_f32_16x16x32_bf16 v[48:51], a[64:67], a[168:171], v[48:51]
  v_mfma_f32_16x16x32_bf16 v[52:55], a[68:71], a[168:171], v[52:55]
  v_mfma_f32_16x16x32_bf16 v[56:59], a[72:75], a[168:171], v[56:59]
  v_mfma_f32_16x16x32_bf16 v[60:63], a[76:79], a[168:171], v[60:63]
  v_mfma_f32_16x16x32_bf16 v[64:67], a[64:67], a[172:175], v[64:67]
  v_mfma_f32_16x16x32_bf16 v[68:71], a[68:71], a[172:175], v[68:71]
  v_mfma_f32_16x16x32_bf16 v[72:75], a[72:75], a[172:175], v[72:75]
  v_mfma_f32_16x16x32_bf16 v[76:79], a[76:79], a[172:175], v[76:79]
  s_waitcnt vmcnt(2)
  v_mfma_f32_16x16x32_bf16 v[48:51], a[80:83], a[176:179], v[48:51]
  v_mfma_f32_16x16x32_bf16 v[52:55], a[84:87], a[176:179], v[52:55]
  v_mfma_f32_16x16x32_bf16 v[56:59], a[88:91], a[176:179], v[56:59]
  v_mfma_f32_16x16x32_bf16 v[60:63], a[92:95], a[176:179], v[60:63]
  v_mfma_f32_16x16x32_bf16 v[64:67], a[80:83], a[180:183], v[64:67]
  v_mfma_f32_16x16x32_bf16 v[68:71], a[84:87], a[180:183], v[68:71]
  v_mfma_f32_16x16x32_bf16 v[72:75], a[88:91], a[180:183], v[72:75]
  v_mfma_f32_16x16x32_bf16 v[76:79], a[92:95], a[180:183], v[76:79]
  s_waitcnt vmcnt(0)
  v_mfma_f32_16x16x32_bf16 v[48:51], a[96:99], a[184:187], v[48:51]
  v_mfma_f32_16x16x32_bf16 v[52:55], a[100:103], a[184:187], v[52:55]
  v_mfma_f32_16x16x32_bf16 v[56:59], a[104:107], a[184:187], v[56:59]
  v_mfma_f32_16x16x32_bf16 v[60:63], a[108:111], a[184:187], v[60:63]
  v_mfma_f32_16x16x32_bf16 v[64:67], a[96:99], a[188:191], v[64:67]
  v_mfma_f32_16x16x32_bf16 v[68:71], a[100:103], a[188:191], v[68:71]
  v_mfma_f32_16x16x32_bf16 v[72:75], a[104:107], a[188:191], v[72:75]
  v_mfma_f32_16x16x32_bf16 v[76:79], a[108:111], a[188:191], v[76:79]
  s_mul_i32 s12, s16, 12288
  s_add_u32 s12, s12, 65536
  v_add_u32 v1, s12, v3
  s_nop 7
  s_cmp_eq_u32 s16, 0
  s_cbranch_scc0 P3_W_97
  ds_write_b128 v1, v[32:35] offset:0
  ds_write_b128 v1, v[36:39] offset:1024
  ds_write_b128 v1, v[40:43] offset:2048
  ds_write_b128 v1, v[44:47] offset:3072
  ds_write_b128 v1, v[48:51] offset:4096
  ds_write_b128 v1, v[52:55] offset:5120
  ds_write_b128 v1, v[56:59] offset:6144
  ds_write_b128 v1, v[60:63] offset:7168
  ds_write_b128 v1, v[64:67] offset:8192
  ds_write_b128 v1, v[68:71] offset:9216
  ds_write_b128 v1, v[72:75] offset:10240
  ds_write_b128 v1, v[76:79] offset:11264
P3_W_97:
  s_cmp_eq_u32 s16, 1
  s_cbranch_scc0 P3_W_98
  ds_write_b128 v1, v[16:19] offset:0
  ds_write_b128 v1, v[20:23] offset:1024
  ds_write_b128 v1, v[24:27] offset:2048
  ds_write_b128 v1, v[28:31] offset:3072
  ds_write_b128 v1, v[48:51] offset:4096
  ds_write_b128 v1, v[52:55] offset:5120
  ds_write_b128 v1, v[56:59] offset:6144
  ds_write_b128 v1, v[60:63] offset:7168
  ds_write_b128 v1, v[64:67] offset:8192
  ds_write_b128 v1, v[68:71] offset:9216
  ds_write_b128 v1, v[72:75] offset:10240
  ds_write_b128 v1, v[76:79] offset:11264
  v_mov_b32 v16, v32
  v_mov_b32 v17, v33
  v_mov_b32 v18, v34
  v_mov_b32 v19, v35
  v_mov_b32 v20, v36
  v_mov_b32 v21, v37
  v_mov_b32 v22, v38
  v_mov_b32 v23, v39
  v_mov_b32 v24, v40
  v_mov_b32 v25, v41
  v_mov_b32 v26, v42
  v_mov_b32 v27, v43
  v_mov_b32 v28, v44
  v_mov_b32 v29, v45
  v_mov_b32 v30, v46
  v_mov_b32 v31, v47
P3_W_98:
  s_cmp_eq_u32 s16, 2
  s_cbranch_scc0 P3_W_99
  ds_write_b128 v1, v[16:19] offset:0
  ds_write_b128 v1, v[20:23] offset:1024
  ds_write_b128 v1, v[24:27] offset:2048
  ds_write_b128 v1, v[28:31] offset:3072
  ds_write_b128 v1, v[32:35] offset:4096
  ds_write_b128 v1, v[36:39] offset:5120
  ds_write_b128 v1, v[40:43] offset:6144
  ds_write_b128 v1, v[44:47] offset:7168
  ds_write_b128 v1, v[64:67] offset:8192
  ds_write_b128 v1, v[68:71] offset:9216
  ds_write_b128 v1, v[72:75] offset:10240
  ds_write_b128 v1, v[76:79] offset:11264
  v_mov_b32 v16, v48
  v_mov_b32 v17, v49
  v_mov_b32 v18, v50
  v_mov_b32 v19, v51
  v_mov_b32 v20, v52
  v_mov_b32 v21, v53
  v_mov_b32 v22, v54
  v_mov_b32 v23, v55
  v_mov_b32 v24, v56
  v_mov_b32 v25, v57
  v_mov_b32 v26, v58
  v_mov_b32 v27, v59
  v_mov_b32 v28, v60
  v_mov_b32 v29, v61
  v_mov_b32 v30, v62
  v_mov_b32 v31, v63
P3_W_99:
  s_cmp_eq_u32 s16, 3
  s_cbranch_scc0 P3_W_100
  ds_write_b128 v1, v[16:19] offset:0
  ds_write_b128 v1, v[20:23] offset:1024
  ds_write_b128 v1, v[24:27] offset:2048
  ds_write_b128 v1, v[28:31] offset:3072
  ds_write_b128 v1, v[32:35] offset:4096
  ds_write_b128 v1, v[36:39] offset:5120
  ds_write_b128 v1, v[40:43] offset:6144
  ds_write_b128 v1, v[44:47] offset:7168
  ds_write_b128 v1, v[48:51] offset:8192
  ds_write_b128 v1, v[52:55] offset:9216
  ds_write_b128 v1, v[56:59] offset:10240
  ds_write_b128 v1, v[60:63] offset:11264
  v_mov_b32 v16, v64
  v_mov_b32 v17, v65
  v_mov_b32 v18, v66
  v_mov_b32 v19, v67
  v_mov_b32 v20, v68
  v_mov_b32 v21, v69
  v_mov_b32 v22, v70
  v_mov_b32 v23, v71
  v_mov_b32 v24, v72
  v_mov_b32 v25, v73
  v_mov_b32 v26, v74
  v_mov_b32 v27, v75
  v_mov_b32 v28, v76
  v_mov_b32 v29, v77
  v_mov_b32 v30, v78
  v_mov_b32 v31, v79
P3_W_100:
  v_mov_b32 v7, 0xffff0000
  v_lshlrev_b32 v80, 16, v8
  v_and_b32 v84, v7, v8
  v_lshlrev_b32 v88, 16, v9
  v_and_b32 v92, v7, v9
  v_lshlrev_b32 v81, 16, v10
  v_and_b32 v85, v7, v10
  v_lshlrev_b32 v89, 16, v11
  v_and_b32 v93, v7, v11
  v_lshlrev_b32 v82, 16, v12
  v_and_b32 v86, v7, v12
  v_lshlrev_b32 v90, 16, v13
  v_and_b32 v94, v7, v13
  v_lshlrev_b32 v83, 16, v14
  v_and_b32 v87, v7, v14
  v_lshlrev_b32 v91, 16, v15
  v_and_b32 v95, v7, v15
  v_add_f32 v16, v16, v80
  v_add_f32 v17, v17, v81
  v_add_f32 v18, v18, v82
  v_add_f32 v19, v19, v83
  v_add_f32 v20, v20, v84
  v_add_f32 v21, v21, v85
  v_add_f32 v22, v22, v86
  v_add_f32 v23, v23, v87
  v_add_f32 v24, v24, v88
  v_add_f32 v25, v25, v89
  v_add_f32 v26, v26, v90
  v_add_f32 v27, v27, v91
  v_add_f32 v28, v28, v92
  v_add_f32 v29, v29, v93
  v_add_f32 v30, v30, v94
  v_add_f32 v31, v31, v95
  v_add_u32 v13, 65536, v3
  s_waitcnt lgkmcnt(0)
  s_barrier
  s_cmp_eq_u32 s16, 0
  s_cbranch_scc0 P3_R_101
  ds_read_b128 v[96:99], v13 offset:12288
  ds_read_b128 v[100:103], v13 offset:13312
  ds_read_b128 v[104:107], v13 offset:14336
  ds_read_b128 v[108:111], v13 offset:15360
  ds_read_b128 v[112:115], v13 offset:24576
  ds_read_b128 v[116:119], v13 offset:25600
  ds_read_b128 v[120:123], v13 offset:26624
  ds_read_b128 v[124:127], v13 offset:27648
  ds_read_b128 v[128:131], v13 offset:36864
  ds_read_b128 v[132:135], v13 offset:37888
  ds_read_b128 v[136:139], v13 offset:38912
  ds_read_b128 v[140:143], v13 offset:39936
P3_R_101:
  s_cmp_eq_u32 s16, 1
  s_cbranch_scc0 P3_R_102
  ds_read_b128 v[96:99], v13 offset:0
  ds_read_b128 v[100:103], v13 offset:1024
  ds_read_b128 v[104:107], v13 offset:2048
  ds_read_b128 v[108:111], v13 offset:3072
  ds_read_b128 v[112:115], v13 offset:28672
  ds_read_b128 v[116:119], v13 offset:29696
  ds_read_b128 v[120:123], v13 offset:30720
  ds_read_b128 v[124:127], v13 offset:31744
  ds_read_b128 v[128:131], v13 offset:40960
  ds_read_b128 v[132:135], v13 offset:41984
  ds_read_b128 v[136:139], v13 offset:43008
  ds_read_b128 v[140:143], v13 offset:44032
P3_R_102:
  s_cmp_eq_u32 s16, 2
  s_cbranch_scc0 P3_R_103
  ds_read_b128 v[96:99], v13 offset:4096
  ds_read_b128 v[100:103], v13 offset:5120
  ds_read_b128 v[104:107], v13 offset:6144
  ds_read_b128 v[108:111], v13 offset:7168
  ds_read_b128 v[112:115], v13 offset:16384
  ds_read_b128 v[116:119], v13 offset:17408
  ds_read_b128 v[120:123], v13 offset:18432
  ds_read_b128 v[124:127], v13 offset:19456
  ds_read_b128 v[128:131], v13 offset:45056
  ds_read_b128 v[132:135], v13 offset:46080
  ds_read_b128 v[136:139], v13 offset:47104
  ds_read_b128 v[140:143], v13 offset:48128
P3_R_103:
  s_cmp_eq_u32 s16, 3
  s_cbranch_scc0 P3_R_104
  ds_read_b128 v[96:99], v13 offset:8192
  ds_read_b128 v[100:103], v13 offset:9216
  ds_read_b128 v[104:107], v13 offset:10240
  ds_read_b128 v[108:111], v13 offset:11264
  ds_read_b128 v[112:115], v13 offset:20480
  ds_read_b128 v[116:119], v13 offset:21504
  ds_read_b128 v[120:123], v13 offset:22528
  ds_read_b128 v[124:127], v13 offset:23552
  ds_read_b128 v[128:131], v13 offset:32768
  ds_read_b128 v[132:135], v13 offset:33792
  ds_read_b128 v[136:139], v13 offset:34816
  ds_read_b128 v[140:143], v13 offset:35840
P3_R_104:
  s_waitcnt lgkmcnt(8)
  v_add_f32 v16, v16, v96
  v_add_f32 v17, v17, v97
  v_add_f32 v18, v18, v98
  v_add_f32 v19, v19, v99
  v_add_f32 v20, v20, v100
  v_add_f32 v21, v21, v101
  v_add_f32 v22, v22, v102
  v_add_f32 v23, v23, v103
  v_add_f32 v24, v24, v104
  v_add_f32 v25, v25, v105
  v_add_f32 v26, v26, v106
  v_add_f32 v27, v27, v107
  v_add_f32 v28, v28, v108
  v_add_f32 v29, v29, v109
  v_add_f32 v30, v30, v110
  v_add_f32 v31, v31, v111
  s_waitcnt lgkmcnt(4)
  v_add_f32 v16, v16, v112
  v_add_f32 v17, v17, v113
  v_add_f32 v18, v18, v114
  v_add_f32 v19, v19, v115
  v_add_f32 v20, v20, v116
  v_add_f32 v21, v21, v117
  v_add_f32 v22, v22, v118
  v_add_f32 v23, v23, v119
  v_add_f32 v24, v24, v120
  v_add_f32 v25, v25, v121
  v_add_f32 v26, v26, v122
  v_add_f32 v27, v27, v123
  v_add_f32 v28, v28, v124
  v_add_f32 v29, v29, v125
  v_add_f32 v30, v30, v126
  v_add_f32 v31, v31, v127
  s_waitcnt lgkmcnt(0)
  v_add_f32 v16, v16, v128
  v_add_f32 v17, v17, v129
  v_add_f32 v18, v18, v130
  v_add_f32 v19, v19, v131
  v_add_f32 v20, v20, v132
  v_add_f32 v21, v21, v133
  v_add_f32 v22, v22, v134
  v_add_f32 v23, v23, v135
  v_add_f32 v24, v24, v136
  v_add_f32 v25, v25, v137
  v_add_f32 v26, v26, v138
  v_add_f32 v27, v27, v139
  v_add_f32 v28, v28, v140
  v_add_f32 v29, v29, v141
  v_add_f32 v30, v30, v142
  v_add_f32 v31, v31, v143
  v_cvt_pk_bf16_f32 v144, v16, v20
  v_cvt_pk_bf16_f32 v145, v24, v28
  v_cvt_pk_bf16_f32 v146, v17, v21
  v_cvt_pk_bf16_f32 v147, v25, v29
  v_cvt_pk_bf16_f32 v148, v18, v22
  v_cvt_pk_bf16_f32 v149, v26, v30
  v_cvt_pk_bf16_f32 v150, v19, v23
  v_cvt_pk_bf16_f32 v151, v27, v31
  s_lshl_b32 s12, s16, 11
  s_add_u32 s12, s12, 114688
  v_lshlrev_b32 v8, 7, v4
  v_lshlrev_b32 v9, 1, v5
  v_and_b32 v10, 7, v4
  v_xor_b32 v11, v9, v10
  v_lshl_add_u32 v11, v11, 4, v8
  v_add_u32 v11, s12, v11
  v_xor_b32 v12, 16, v11
  ds_write_b128 v11, v[144:147]
  ds_write_b128 v12, v[148:151]
  v_lshrrev_b32 v8, 3, v2
  v_and_b32 v9, 7, v2
  v_xor_b32 v10, v9, v8
  v_lshlrev_b32 v10, 4, v10
  v_lshl_add_u32 v10, v8, 7, v10
  v_add_u32 v10, s12, v10
  s_waitcnt lgkmcnt(0)
  ds_read_b128 v[152:155], v10
  ds_read_b128 v[156:159], v10 offset:1024
  v_lshlrev_b32 v8, 10, v8
  v_lshl_add_u32 v8, v9, 4, v8
  s_lshl_b32 s13, s18, 7
  s_add_u32 s13, s13, s42
  s_add_u32 s14, s13, 8192
  s_waitcnt lgkmcnt(1)
  buffer_store_dwordx4 v[152:155], v8, s[32:35], s13 offen
  s_waitcnt lgkmcnt(0)
  buffer_store_dwordx4 v[156:159], v8, s[32:35], s14 offen
K_DONE:
  s_endpgm
.section .rodata,"a"
.p2align 6
.amdhsa_kernel interleave_layers__ssm_conv_h3__dense_activation_mish__prompt_kernel
  .amdhsa_next_free_vgpr 512
  .amdhsa_next_free_sgpr 100
  .amdhsa_accum_offset 256
  .amdhsa_group_segment_fixed_size 0
  .amdhsa_kernarg_size 104
  .amdhsa_user_sgpr_count 2
  .amdhsa_user_sgpr_kernarg_segment_ptr 1
  .amdhsa_system_sgpr_workgroup_id_x 1
.end_amdhsa_kernel
```
